```python
import torch

def _softmax(x, axis=-1):
    return torch.softmax(x, dim=axis)
def _gelu(x):
    return torch.nn.functional.gelu(x, approximate="tanh")
def _silu(x):
    return torch.nn.functional.silu(x)
def _sigmoid(x):
    return torch.sigmoid(x)
def _layernorm(x, axis=-1, eps=1e-5):
    m = x.mean(dim=axis, keepdim=True)
    v = x.var(dim=axis, keepdim=True, unbiased=False)
    return (x - m) / torch.sqrt(v + eps)
def _scatter_add(tgt, idx, src, axis=0):
    return tgt.clone().index_add_(axis, idx, src)
def _segment_sum(src, seg, n):
    out = torch.zeros((n,) + src.shape[1:], dtype=src.dtype)
    return out.index_add_(0, seg, src)
def _pad(x, pw):
    flat = tuple(v for pair in reversed(pw) for v in pair)
    return torch.nn.functional.pad(x, flat)

kernel_name = 'sequential_preLN__ssm_conv_s4d__geglu_ffn__prompt'

def setup_inputs():

    _w = (lambda a: (lambda t: t.to(torch.bfloat16) if t.is_floating_point() else t)(torch.as_tensor(a)))
    def _A_setup():
        Bsz, L, D, N = 1, 2048, 1024, 128
        return {
            "u": _w((lambda *s: torch.randn(*s, dtype=torch.bfloat16) * 0.05)(Bsz, L, D)),
            "log_A_real": _w((lambda *s: torch.randn(*s, dtype=torch.bfloat16) * 6.4)(D, N) * 0.5),
            "A_imag": _w((lambda *s: torch.randn(*s, dtype=torch.bfloat16) * 0.05)(D, N) * 3.14),
            "C_real": _w((lambda *s: torch.randn(*s, dtype=torch.bfloat16) * 0.05)(D, N) / N ** 0.5),
            "C_imag": _w((lambda *s: torch.randn(*s, dtype=torch.bfloat16) * 0.05)(D, N) / N ** 0.5),
            "log_dt": _w((lambda *s: torch.randn(*s, dtype=torch.bfloat16) * 0.05)(D) * 0.5 - 4.0),
            "D_skip": _w((lambda *s: torch.randn(*s, dtype=torch.bfloat16) * 0.05)(D)),
        }
    _A_in = _A_setup()

    def _B_setup():
        B, S, D, F = 1, 2048, 1024, 3584
        return {
            "x": _w((lambda *s: torch.randn(*s, dtype=torch.bfloat16) * 0.05)(B, S, D)),
            "w_gate": _w((lambda *s: torch.randn(*s, dtype=torch.bfloat16) * 0.05)(D, F)),
            "w_up": _w((lambda *s: torch.randn(*s, dtype=torch.bfloat16) * 0.05)(D, F)),
            "w_down": _w((lambda *s: torch.randn(*s, dtype=torch.bfloat16) * 0.05)(F, D)),
        }
    _B_in = _B_setup()

    return {
        "A_u": _A_in["u"],
        "A_log_A_real": _A_in["log_A_real"],
        "A_A_imag": _A_in["A_imag"],
        "A_C_real": _A_in["C_real"],
        "A_C_imag": _A_in["C_imag"],
        "A_log_dt": _A_in["log_dt"],
        "A_D_skip": _A_in["D_skip"],
        "B_x": _B_in["x"],
        "B_w_gate": _B_in["w_gate"],
        "B_w_up": _B_in["w_up"],
        "B_w_down": _B_in["w_down"],
    }

def reference(A_u, A_log_A_real, A_A_imag, A_C_real, A_C_imag, A_log_dt, A_D_skip, B_x, B_w_gate, B_w_up, B_w_down):
    def _A_ref(u, log_A_real, A_imag, C_real, C_imag, log_dt, D_skip):
        L = u.shape[1]
        dt = torch.exp(log_dt)
        A = -torch.exp(log_A_real) + 1j * A_imag
        C = (C_real + 1j * C_imag) * dt[:, None]
        pos = (lambda x, dt: x.to(dt))(torch.arange(L), log_dt.dtype)
        P = torch.exp((A * dt[:, None])[:, :, None] * pos[None, None, :])
        K = 2.0 * torch.einsum("dn,dnl->dl", C, P).real
        L2 = 2 * L
        u_t = (lambda x, *d: x.permute(*d))(u, 0, 2, 1)
        Kf = (lambda x, *a, **k: torch.fft.rfft(x.float(), *a, **k))(K, L2)
        Uf = (lambda x, *a, **k: torch.fft.rfft(x.float(), *a, **k))(u_t, L2)
        y = (lambda x, *a, **k: torch.fft.irfft(x, *a, **k).to(torch.bfloat16))(Uf * Kf[None, :, :], L2)[:, :, :L]
        y = (lambda x, *d: x.permute(*d))(y, 0, 2, 1)
        return y + u * D_skip[None, None, :]

    def _B_ref(x, w_gate, w_up, w_down):
        return (_gelu(x @ w_gate) * (x @ w_up)) @ w_down

    x = A_u
    h = x + _A_ref(_layernorm(x, axis=-1), A_log_A_real, A_A_imag, A_C_real, A_C_imag, A_log_dt, A_D_skip)
    h2 = h + _B_ref(_layernorm(h, axis=-1), B_w_gate, B_w_up, B_w_down)
    return h2
```

```asm
; @launch grid=(256,1,1) block=(256,1,1) lds=163840
.amdgcn_target "amdgcn-amd-amdhsa--gfx950"
.text
.globl sequential_preLN__ssm_conv_s4d__geglu_ffn__prompt_kernel
.p2align 8
.type sequential_preLN__ssm_conv_s4d__geglu_ffn__prompt_kernel,@function
sequential_preLN__ssm_conv_s4d__geglu_ffn__prompt_kernel:
    s_cmp_ge_u32 s2, 256
    s_cbranch_scc1 L_mk_end_1
    s_mov_b32 s3, 0xffff0000
    s_memrealtime s[50:51]
    s_load_dwordx16 s[64:79], s[0:1], 0
    s_load_dwordx8 s[80:87], s[0:1], 64
    s_load_dwordx4 s[88:91], s[0:1], 96
    v_lshrrev_b32 v2, 6, v0
    v_and_b32 v30, 63, v0
    v_readfirstlane_b32 s94, v2
    s_and_b32 s48, s2, 7
    s_lshl_b32 s48, s48, 5
    s_lshr_b32 s95, s2, 3
    s_add_u32 s95, s95, s48
    v_and_b32 v3, 3, v30
    v_lshrrev_b32 v4, 2, v30
    v_lshlrev_b32_e64 v5, 12, v3
    v_lshl_add_u32 v5, v4, 4, v5
    s_lshl_b32 s48, s2, 14
    s_lshl_b32 s49, s94, 9
    s_add_u32 s48, s48, s49
    v_mov_b32 v1, 0
    s_lshl_b32 s97, s95, 2
    s_add_u32 s97, s97, s94
    s_lshl_b32 s52, s97, 8
    v_lshlrev_b32 v2, 2, v30
    s_lshl_b32 s53, s97, 1
    v_lshlrev_b32 v29, 6, v0
    v_lshlrev_b32 v8, 4, v0
    s_getpc_b64 s[36:37]
    s_and_b32 s36, s36, 0xffffff00
    s_mov_b32 s38, 58688
    s_mov_b32 s39, 0x20000
    s_lshr_b32 s49, s2, 3
    s_and_b32 s49, s49, 3
    s_lshl_b32 s49, s49, 14
    buffer_load_dword a204, v29, s[36:39], s49 offen
    s_waitcnt lgkmcnt(0)
    s_mov_b32 s8, s88
    s_mov_b32 s9, s89
    s_mov_b32 s10, 256
    s_mov_b32 s11, 0x20000
    s_or_b32 s49, s2, s94
    s_cmp_lg_u32 s49, 0
    s_cbranch_scc1 L_mk_nn_2
    s_or_b32 s50, s50, 1
    v_mov_b32 v6, s50
    v_mov_b32_e64 v7, s51
    s_mov_b64 exec, 0xf
    buffer_store_dwordx2 v[6:7], v29, s[8:11], 0 offen sc1
    s_mov_b64 exec, -1
L_mk_nn_2:
    s_mov_b32 s12, s66
    s_mov_b32 s13, s67
    s_mov_b32 s14, 262144
    s_mov_b32 s15, 0x20000
    buffer_load_dword v24, v2, s[12:15], s52 offen
    s_mov_b32 s16, s68
    s_mov_b32 s17, s69
    s_mov_b32 s18, 262144
    s_mov_b32 s19, 0x20000
    buffer_load_dword v25, v2, s[16:19], s52 offen
    s_mov_b32 s20, s70
    s_mov_b32 s21, s71
    s_mov_b32 s22, 262144
    s_mov_b32 s23, 0x20000
    buffer_load_dword v26, v2, s[20:23], s52 offen
    s_mov_b32 s24, s72
    s_mov_b32 s25, s73
    s_mov_b32 s26, 262144
    s_mov_b32 s27, 0x20000
    buffer_load_dword v27, v2, s[24:27], s52 offen
    s_mov_b32 s28, s74
    s_mov_b32 s29, s75
    s_mov_b32 s30, 2048
    s_mov_b32 s31, 0x20000
    buffer_load_ushort v28, v1, s[28:31], s53 offen
    s_mov_b32 s36, s64
    s_mov_b32 s37, s65
    s_nop 0
    s_mov_b32 s38, 4194304
    s_mov_b32 s39, 0x20000
    buffer_load_dwordx4 v[32:35], v5, s[36:39], s48 offen offset:0
    buffer_load_dwordx4 v[36:39], v5, s[36:39], s48 offen offset:256
    buffer_load_dwordx4 v[40:43], v5, s[36:39], s48 offen offset:2048
    buffer_load_dwordx4 v[44:47], v5, s[36:39], s48 offen offset:2304
    s_and_b32 s48, s2, 7
    s_bfe_u32 s33, s2, 0x30003
    s_lshl_b32 s34, s48, 2
    s_lshr_b32 s50, s2, 6
    s_add_u32 s34, s34, s50
    s_lshl_b32 s26, s33, 8
    s_lshl_b32 s31, s34, 3
    s_add_u32 s31, s31, s26
    s_mul_i32 s27, s34, 112
    s_cmp_ge_u32 s94, 2
    s_cselect_b32 s4, s82, s80
    s_cselect_b32 s5, s83, s81
    s_mov_b32 s6, 7340032
    s_mov_b32 s7, 0x20000
    s_and_b32 s48, s94, 1
    s_mul_i32 s49, s48, 448
    s_lshl_b32 s50, s27, 1
    v_add_u32_e64 v240, s49, v30
    v_mul_u32_u24 v241, 4682, v240
    v_lshrrev_b32_e64 v241, 16, v241
    v_mul_u32_u24 v241, 6944, v241
    v_lshl_add_u32 v241, v240, 4, v241
    v_add_u32 v224, s50, v241
    v_add_u32 v240, s49, v30
    v_add_u32_e64 v240, 64, v240
    v_mul_u32_u24 v241, 4682, v240
    v_lshrrev_b32_e64 v241, 16, v241
    v_mul_u32_u24 v241, 6944, v241
    v_lshl_add_u32 v241, v240, 4, v241
    v_add_u32_e64 v225, s50, v241
    v_subrev_u32 v225, 1024, v225
    v_add_u32_e64 v240, s49, v30
    v_add_u32 v240, 128, v240
    v_mul_u32_u24 v241, 4682, v240
    v_lshrrev_b32_e64 v241, 16, v241
    v_mul_u32_u24 v241, 6944, v241
    v_lshl_add_u32 v241, v240, 4, v241
    v_add_u32_e64 v226, s50, v241
    v_subrev_u32 v226, 2048, v226
    v_add_u32_e64 v240, s49, v30
    v_add_u32 v240, 192, v240
    v_mul_u32_u24 v241, 4682, v240
    v_lshrrev_b32_e64 v241, 16, v241
    v_mul_u32_u24 v241, 6944, v241
    v_lshl_add_u32 v241, v240, 4, v241
    v_add_u32_e64 v227, s50, v241
    v_subrev_u32 v227, 3072, v227
    v_add_u32_e64 v240, s49, v30
    v_add_u32 v240, 256, v240
    v_mul_u32_u24 v241, 4682, v240
    v_lshrrev_b32_e64 v241, 16, v241
    v_mul_u32_u24 v241, 6944, v241
    v_lshl_add_u32 v241, v240, 4, v241
    v_add_u32 v228, s50, v241
    v_add_u32 v240, s49, v30
    v_add_u32 v240, 320, v240
    v_mul_u32_u24 v241, 4682, v240
    v_lshrrev_b32_e64 v241, 16, v241
    v_mul_u32_u24 v241, 6944, v241
    v_lshl_add_u32 v241, v240, 4, v241
    v_add_u32_e64 v229, s50, v241
    v_subrev_u32 v229, 1024, v229
    v_add_u32_e64 v240, s49, v30
    v_add_u32 v240, 384, v240
    v_mul_u32_u24 v241, 4682, v240
    v_lshrrev_b32_e64 v241, 16, v241
    v_mul_u32_u24 v241, 6944, v241
    v_lshl_add_u32 v241, v240, 4, v241
    v_add_u32_e64 v230, s50, v241
    v_subrev_u32 v230, 2048, v230
    v_and_b32_e64 v243, 3, v30
    s_mul_i32 s24, s48, 7168
    s_lshr_b32 s48, s94, 1
    s_mul_i32 s48, s48, 14464
    s_add_u32 s24, s24, s48
    s_mul_i32 s22, s33, 917504
    s_mov_b32 s19, s22
    s_add_u32 s18, s22, 917504
    s_lshl_b32 s48, s94, 6
    s_add_u32 s26, s26, s48
    v_and_b32 v240, 31, v30
    v_add_u32 v240, s26, v240
    v_lshlrev_b32 v240, 4, v240
    v_lshrrev_b32_e64 v241, 5, v30
    v_lshl_add_u32 v234, v241, 15, v240
    s_lshl_b32 s48, s27, 12
    v_add_u32 v234, s48, v234
    v_and_b32 v240, 15, v30
    v_add_u32 v240, s26, v240
    v_lshlrev_b32 v232, 4, v240
    v_lshrrev_b32 v241, 4, v30
    v_lshlrev_b32_e64 v231, 3, v240
    v_lshl_add_u32 v231, v241, 14, v231
    v_lshrrev_b32_e64 v242, 2, v30
    v_mul_u32_u24 v233, 224, v242
    v_lshl_add_u32 v233, v243, 3, v233
    v_lshrrev_b32 v235, 2, v30
    v_lshlrev_b32 v235, 14, v235
    v_lshl_add_u32 v235, v243, 4, v235
    s_lshl_b32 s35, s94, 20
    s_lshl_b32 s48, s31, 3
    s_add_u32 s35, s35, s48
    s_add_u32 s60, s90, 18939904
    s_addc_u32 s61, s91, 0
    s_mov_b32 s62, 393216
    s_mov_b32 s63, 0x20000
    s_add_u32 s40, s90, 19922944
    s_addc_u32 s41, s91, 0
    s_mov_b32 s42, 12582912
    s_mov_b32 s43, 0x20000
    s_mov_b32 s44, s90
    s_mov_b32 s45, s91
    s_mov_b32 s46, 4194304
    s_mov_b32 s47, 0x20000
    s_lshl_b32 s49, s95, 3
    s_load_dwordx2 s[58:59], s[76:77], s49
    v_lshlrev_b32_e64 v6, 15, v4
    v_lshl_add_u32 v6, v3, 4, v6
    v_and_b32 v9, 15, v30
    v_lshrrev_b32 v19, 4, v30
    s_mul_i32 s56, s94, 18048
    s_add_u32 s56, s56, 57600
    s_mul_i32 s57, s94, 8448
    s_add_u32 s57, s57, 129792
    s_add_u32 s55, s56, 12688
    v_lshlrev_b32 v16, 7, v19
    v_add_u32 v16, s56, v16
    v_bfe_u32 v17, v30, 2, 2
    v_mul_u32_u24 v10, 528, v17
    v_add_u32_e64 v10, v10, v16
    v_mul_u32_u24 v11, 528, v3
    v_bfe_u32 v17, v30, 3, 1
    v_lshlrev_b32 v12, v17, v11
    v_add_u32 v11, v11, v16
    v_add_u32 v12, v12, v16
    v_lshlrev_b32 v13, 3, v30
    v_add_u32_e64 v13, s56, v13
    v_mov_b32 v16, 0x3c00
    v_mov_b32 v17, 0x3c00
    ds_write_b64 v13, v[16:17] offset:0
    ds_write_b64 v13, v[16:17] offset:2112
    ds_write_b64 v13, v[16:17] offset:6336
    v_lshlrev_b32_e64 v15, 6, v9
    v_lshl_add_u32 v15, v19, 3, v15
    v_add_u32 v15, s55, v15
    v_lshlrev_b32 v22, 4, v9
    v_lshl_add_u32 v22, v19, 3, v22
    v_add_u32 v22, 1024, v22
    v_lshlrev_b32_e64 v23, 3, v9
    v_lshl_add_u32 v23, v19, 7, v23
    v_add_u32 v23, 1024, v23
    v_cmp_gt_u32 vcc, 32, v30
    s_nop 1
    v_cndmask_b32 v18, v23, v22, vcc
    v_add_u32 v18, s55, v18
    v_mov_b32 v184, 0x1000100
    v_mov_b32 v22, 0x1000302
    v_cndmask_b32_e64 v184, v184, v22, vcc
    v_mov_b32 v185, 0x1000504
    v_mov_b32 v22, 0x1000302
    v_cndmask_b32_e64 v185, v185, v22, vcc
    v_mov_b32 v186, 0x1000504
    v_mov_b32 v22, 0x3020504
    v_cndmask_b32_e64 v186, v186, v22, vcc
    v_mov_b32 v187, 0x5040504
    v_mov_b32 v22, 0x3020504
    v_cndmask_b32 v187, v187, v22, vcc
    v_mov_b32 v188, v187
    s_mov_b32 s51, 0x03020504
    v_writelane_b32 v188, s51, 32
    s_mov_b32 s50, 0x0c0c0504
    v_writelane_b32 v188, s50, 0
    v_lshlrev_b32 v22, 4, v30
    v_add_u32 v20, s57, v22
    v_add_u32 v21, v20, v22
    v_add_u32 v14, s56, v22
    v_mov_b32 v180, 0
    v_mov_b32 v181, 0
    v_mov_b32 v182, 0
    v_mov_b32 v183, 0
    s_mov_b64 exec, 0x7f
    ds_write_b128 v20, v[180:183]
    ds_write_b128 v20, v[180:183] offset:4224
    s_mov_b64 exec, -1
    v_and_b32 v22, 1, v30
    v_mul_u32_u24 v4, 4224, v22
    v_bfe_u32 v22, v30, 1, 3
    v_sub_u32 v22, v22, v19
    v_add_u32 v22, 3, v22
    v_lshl_add_u32 v4, v22, 4, v4
    v_add_u32_e64 v4, s57, v4
    v_mul_u32_u24 v5, 4512, v3
    v_bfe_u32 v22, v30, 2, 2
    v_lshl_add_u32 v23, v22, 3, v19
    v_lshl_add_u32 v5, v23, 4, v5
    v_add_u32 v5, s56, v5
    v_lshlrev_b32 v7, 5, v22
    v_lshl_add_u32 v7, v19, 3, v7
    v_add_u32 v7, v7, v3
    v_lshlrev_b32 v7, 2, v7
    v_add_u32 v7, s57, v7
    v_lshlrev_b32 v22, 2, v0
    v_add_u32 v190, 57996, v22
    v_add_u32 v191, 76044, v22
    v_add_u32 v192, 62504, v22
    v_add_u32 v193, 80552, v22
    v_add_u32 v194, 67012, v22
    v_add_u32 v195, 85060, v22
    v_add_u32 v196, 71520, v22
    v_add_u32 v197, 89568, v22
    s_waitcnt vmcnt(4)
    v_lshlrev_b32 v28, 16, v28
    v_lshlrev_b32 v72, 16, v24
    v_and_b32 v73, s3, v24
    v_mul_f32 v28, 0x3fb8aa3b, v28
    v_mul_f32 v72, 0x3fb8aa3b, v72
    v_mul_f32 v73, 0x3fb8aa3b, v73
    v_exp_f32 v28, v28
    v_exp_f32 v72, v72
    v_exp_f32 v73, v73
    v_lshlrev_b32 v65, 16, v25
    v_and_b32 v67, s3, v25
    v_lshlrev_b32 v68, 16, v26
    v_and_b32 v70, s3, v26
    v_lshlrev_b32 v69, 16, v27
    v_and_b32_e64 v71, s3, v27
    v_cvt_pk_bf16_f32 v28, v28, v28
    v_cvt_pk_bf16_f32 v24, v72, v73
    v_max3_f32 v60, |v68|, |v69|, |v70|
    v_max_f32 v60, |v71|, v60
    v_lshlrev_b32 v28, 16, v28
    v_lshlrev_b32 v64, 16, v24
    v_and_b32_e64 v66, s3, v24
    v_max_f32_dpp v60, v60, v60 quad_perm:[1,0,3,2] row_mask:0xf bank_mask:0xf
    v_mul_f32 v64, v64, v28
    v_mul_f32 v65, v65, v28
    v_mul_f32 v66, v66, v28
    v_mul_f32 v67, v67, v28
    v_max_f32_dpp v60, v60, v60 quad_perm:[2,3,0,1] row_mask:0xf bank_mask:0xf
    v_mul_f32 v64, 0xbfb8aa3b, v64
    v_mul_f32_e64 v65, 0.15915494, v65
    v_mul_f32 v66, 0xbfb8aa3b, v66
    v_mul_f32_e64 v67, 0.15915494, v67
    v_max_f32_dpp v60, v60, v60 row_ror:4 row_mask:0xf bank_mask:0xf
    v_mov_b32 v76, v64
    v_mov_b32 v77, v65
    v_mov_b32 v78, v66
    v_mov_b32 v79, v67
    v_max_f32_dpp v60, v60, v60 row_ror:8 row_mask:0xf bank_mask:0xf
    v_mul_f32 v80, 0x42000000, v64
    v_mul_f32 v81, 0x42000000, v65
    v_mul_f32 v82, 0x42000000, v66
    v_mul_f32 v83, 0x42000000, v67
    v_mul_f32 v84, 0x44000000, v64
    v_mul_f32 v85, 0x44000000, v65
    v_mul_f32 v86, 0x44000000, v66
    v_mul_f32 v87, 0x44000000, v67
    v_fract_f32 v77, v77
    v_fract_f32 v79, v79
    v_fract_f32 v81, v81
    v_fract_f32 v83, v83
    v_fract_f32 v85, v85
    v_fract_f32 v87, v87
    v_mov_b32 v72, v60
    s_nop 1
    v_permlane16_swap_b32 v72, v60
    s_nop 0
    v_max_f32 v60, v60, v72
    v_mov_b32 v72, v60
    s_nop 1
    v_permlane32_swap_b32 v72, v60
    s_nop 0
    v_max_f32 v60, v60, v72
    v_cos_f32 v88, v77
    v_sin_f32 v89, v77
    v_exp_f32 v76, v76
    v_cos_f32 v90, v79
    v_sin_f32 v91, v79
    v_exp_f32 v78, v78
    v_cos_f32 v128, v81
    v_sin_f32 v129, v81
    v_exp_f32 v80, v80
    v_cos_f32 v130, v83
    v_sin_f32 v131, v83
    v_exp_f32 v82, v82
    v_cos_f32 v148, v85
    v_sin_f32 v149, v85
    v_exp_f32 v84, v84
    v_cos_f32 v150, v87
    v_sin_f32 v151, v87
    v_exp_f32 v86, v86
    v_frexp_exp_i32_f32 v72, v60
    v_add_f32 v28, v28, v28
    v_ldexp_f32 v60, v28, v72
    v_sub_u32_e64 v72, 0, v72
    v_pk_mul_f32 v[88:89], v[88:89], v[76:77] op_sel_hi:[1,0]
    v_pk_mul_f32 v[90:91], v[90:91], v[78:79] op_sel_hi:[1,0]
    v_pk_mul_f32 v[128:129], v[128:129], v[80:81] op_sel_hi:[1,0]
    v_pk_mul_f32 v[130:131], v[130:131], v[82:83] op_sel_hi:[1,0]
    v_pk_mul_f32 v[148:149], v[148:149], v[84:85] op_sel_hi:[1,0]
    v_pk_mul_f32 v[150:151], v[150:151], v[86:87] op_sel_hi:[1,0]
    v_ldexp_f32 v68, v68, v72
    v_ldexp_f32 v69, v69, v72
    v_ldexp_f32 v70, v70, v72
    v_ldexp_f32 v71, v71, v72
    v_pk_mul_f32 v[92:93], v[88:89], v[88:89] op_sel_hi:[0,1]
    v_pk_mul_f32 v[94:95], v[90:91], v[90:91] op_sel_hi:[0,1]
    v_pk_mul_f32 v[132:133], v[128:129], v[128:129] op_sel_hi:[0,1]
    v_pk_mul_f32 v[134:135], v[130:131], v[130:131] op_sel_hi:[0,1]
    v_pk_mul_f32 v[156:157], v[148:149], v[148:149] op_sel_hi:[0,1]
    v_pk_mul_f32 v[158:159], v[150:151], v[150:151] op_sel_hi:[0,1]
    v_pk_fma_f32 v[92:93], v[88:89], v[88:89], v[92:93] op_sel:[1,1,0] op_sel_hi:[1,0,1] neg_lo:[0,1,0]
    v_pk_fma_f32 v[94:95], v[90:91], v[90:91], v[94:95] op_sel:[1,1,0] op_sel_hi:[1,0,1] neg_lo:[0,1,0]
    v_pk_fma_f32 v[132:133], v[128:129], v[128:129], v[132:133] op_sel:[1,1,0] op_sel_hi:[1,0,1] neg_lo:[0,1,0]
    v_pk_fma_f32 v[134:135], v[130:131], v[130:131], v[134:135] op_sel:[1,1,0] op_sel_hi:[1,0,1] neg_lo:[0,1,0]
    v_pk_fma_f32 v[156:157], v[148:149], v[148:149], v[156:157] op_sel:[1,1,0] op_sel_hi:[1,0,1] neg_lo:[0,1,0]
    v_pk_fma_f32 v[158:159], v[150:151], v[150:151], v[158:159] op_sel:[1,1,0] op_sel_hi:[1,0,1] neg_lo:[0,1,0]
    v_cvt_pk_f16_f32 v76, v88, v89
    v_cvt_pk_f16_f32 v77, v90, v91
    ds_write_b64 v13, v[76:77] offset:528
    v_cvt_pk_f16_f32 v78, v128, -v129
    v_cvt_pk_f16_f32 v79, v130, -v131
    ds_write_b64 v13, v[78:79] offset:6864
    v_cvt_pk_f16_f32 v80, v148, v149
    v_cvt_pk_f16_f32 v81, v150, v151
    ds_write_b64 v13, v[80:81] offset:10560
    v_cvt_pk_f16_f32 v82, v68, -v69
    v_cvt_pk_f16_f32 v83, v70, -v71
    ds_write_b64 v13, v[82:83] offset:8448
    v_pk_mul_f32 v[96:97], v[92:93], v[88:89] op_sel_hi:[0,1]
    v_pk_mul_f32 v[98:99], v[94:95], v[90:91] op_sel_hi:[0,1]
    v_pk_mul_f32 v[100:101], v[92:93], v[92:93] op_sel_hi:[0,1]
    v_pk_mul_f32 v[102:103], v[94:95], v[94:95] op_sel_hi:[0,1]
    v_pk_mul_f32 v[136:137], v[132:133], v[128:129] op_sel_hi:[0,1]
    v_pk_mul_f32 v[138:139], v[134:135], v[130:131] op_sel_hi:[0,1]
    v_pk_mul_f32 v[140:141], v[132:133], v[132:133] op_sel_hi:[0,1]
    v_pk_mul_f32 v[142:143], v[134:135], v[134:135] op_sel_hi:[0,1]
    v_pk_mul_f32 v[160:161], v[156:157], v[148:149] op_sel_hi:[0,1]
    v_pk_mul_f32 v[162:163], v[158:159], v[150:151] op_sel_hi:[0,1]
    v_pk_mul_f32 v[164:165], v[156:157], v[156:157] op_sel_hi:[0,1]
    v_pk_mul_f32 v[166:167], v[158:159], v[158:159] op_sel_hi:[0,1]
    v_pk_fma_f32 v[96:97], v[92:93], v[88:89], v[96:97] op_sel:[1,1,0] op_sel_hi:[1,0,1] neg_lo:[0,1,0]
    v_pk_fma_f32 v[98:99], v[94:95], v[90:91], v[98:99] op_sel:[1,1,0] op_sel_hi:[1,0,1] neg_lo:[0,1,0]
    v_pk_fma_f32 v[100:101], v[92:93], v[92:93], v[100:101] op_sel:[1,1,0] op_sel_hi:[1,0,1] neg_lo:[0,1,0]
    v_pk_fma_f32 v[102:103], v[94:95], v[94:95], v[102:103] op_sel:[1,1,0] op_sel_hi:[1,0,1] neg_lo:[0,1,0]
    v_pk_fma_f32 v[136:137], v[132:133], v[128:129], v[136:137] op_sel:[1,1,0] op_sel_hi:[1,0,1] neg_lo:[0,1,0]
    v_pk_fma_f32 v[138:139], v[134:135], v[130:131], v[138:139] op_sel:[1,1,0] op_sel_hi:[1,0,1] neg_lo:[0,1,0]
    v_pk_fma_f32 v[140:141], v[132:133], v[132:133], v[140:141] op_sel:[1,1,0] op_sel_hi:[1,0,1] neg_lo:[0,1,0]
    v_pk_fma_f32 v[142:143], v[134:135], v[134:135], v[142:143] op_sel:[1,1,0] op_sel_hi:[1,0,1] neg_lo:[0,1,0]
    v_pk_fma_f32 v[160:161], v[156:157], v[148:149], v[160:161] op_sel:[1,1,0] op_sel_hi:[1,0,1] neg_lo:[0,1,0]
    v_pk_fma_f32 v[162:163], v[158:159], v[150:151], v[162:163] op_sel:[1,1,0] op_sel_hi:[1,0,1] neg_lo:[0,1,0]
    v_pk_fma_f32 v[164:165], v[156:157], v[156:157], v[164:165] op_sel:[1,1,0] op_sel_hi:[1,0,1] neg_lo:[0,1,0]
    v_pk_fma_f32 v[166:167], v[158:159], v[158:159], v[166:167] op_sel:[1,1,0] op_sel_hi:[1,0,1] neg_lo:[0,1,0]
    v_cvt_pk_f16_f32 v84, v92, v93
    v_cvt_pk_f16_f32 v85, v94, v95
    ds_write_b64 v13, v[84:85] offset:1056
    v_cvt_pk_f16_f32 v86, v132, -v133
    v_cvt_pk_f16_f32 v87, v134, -v135
    ds_write_b64 v13, v[86:87] offset:7392
    v_cvt_pk_f16_f32 v76, v156, v157
    v_cvt_pk_f16_f32 v77, v158, v159
    ds_write_b64 v13, v[76:77] offset:11616
    s_lshl_b32 s48, s94, 20
    s_lshl_b32 s49, s2, 6
    s_add_u32 s48, s48, s49
    s_mov_b32 s50, 0x05040100
    s_mov_b32 s51, 0x07060302
    s_and_b32 s54, s2, 3
    s_lshl_b32 s54, s54, 6
    v_mov_b32 v63, 138224
    s_waitcnt vmcnt(0)
    s_cmp_lg_u32 s94, 0
    s_cbranch_scc1 L_mk_nl_3
    buffer_load_dwordx2 v[22:23], v1, s[8:11], s54 offen sc1
L_mk_nl_3:
    v_perm_b32 v200, v40, v32, s50
    v_perm_b32 v201, v40, v32, s51
    v_perm_b32 v202, v41, v33, s50
    v_perm_b32 v203, v41, v33, s51
    s_add_u32 s49, s48, 0
    s_nop 0
    buffer_store_dwordx4 v[200:203], v6, s[40:43], s49 offen sc1
    v_perm_b32 v204, v42, v34, s50
    v_perm_b32 v205, v42, v34, s51
    v_perm_b32 v206, v43, v35, s50
    v_perm_b32 v207, v43, v35, s51
    s_add_u32 s49, s48, 16384
    buffer_store_dwordx4 v[204:207], v6, s[40:43], s49 offen sc1
    v_perm_b32 v208, v44, v36, s50
    v_perm_b32 v209, v44, v36, s51
    v_perm_b32 v210, v45, v37, s50
    v_perm_b32 v211, v45, v37, s51
    s_add_u32 s49, s48, 524288
    buffer_store_dwordx4 v[208:211], v6, s[40:43], s49 offen sc1
    v_perm_b32 v212, v46, v38, s50
    v_perm_b32 v213, v46, v38, s51
    v_perm_b32 v214, v47, v39, s50
    v_perm_b32 v215, v47, v39, s51
    s_add_u32 s49, s48, 540672
    buffer_store_dwordx4 v[212:215], v6, s[40:43], s49 offen sc1
    v_pk_mul_f32 v[104:105], v[100:101], v[100:101] op_sel_hi:[0,1]
    v_pk_mul_f32 v[106:107], v[102:103], v[102:103] op_sel_hi:[0,1]
    v_pk_mul_f32 v[144:145], v[140:141], v[140:141] op_sel_hi:[0,1]
    v_pk_mul_f32 v[146:147], v[142:143], v[142:143] op_sel_hi:[0,1]
    v_pk_mul_f32 v[168:169], v[68:69], v[140:141] op_sel_hi:[0,1]
    v_pk_mul_f32 v[170:171], v[70:71], v[142:143] op_sel_hi:[0,1]
    v_pk_fma_f32 v[104:105], v[100:101], v[100:101], v[104:105] op_sel:[1,1,0] op_sel_hi:[1,0,1] neg_lo:[0,1,0]
    v_pk_fma_f32 v[106:107], v[102:103], v[102:103], v[106:107] op_sel:[1,1,0] op_sel_hi:[1,0,1] neg_lo:[0,1,0]
    v_pk_fma_f32 v[144:145], v[140:141], v[140:141], v[144:145] op_sel:[1,1,0] op_sel_hi:[1,0,1] neg_lo:[0,1,0]
    v_pk_fma_f32 v[146:147], v[142:143], v[142:143], v[146:147] op_sel:[1,1,0] op_sel_hi:[1,0,1] neg_lo:[0,1,0]
    v_pk_fma_f32 v[168:169], v[68:69], v[140:141], v[168:169] op_sel:[1,1,0] op_sel_hi:[1,0,1] neg_lo:[0,1,0]
    v_pk_fma_f32 v[170:171], v[70:71], v[142:143], v[170:171] op_sel:[1,1,0] op_sel_hi:[1,0,1] neg_lo:[0,1,0]
    v_cvt_pk_f16_f32 v78, v96, v97
    v_cvt_pk_f16_f32 v79, v98, v99
    ds_write_b64 v13, v[78:79] offset:1584
    v_cvt_pk_f16_f32 v80, v100, v101
    v_cvt_pk_f16_f32 v81, v102, v103
    ds_write_b64 v13, v[80:81] offset:2640
    v_cvt_pk_f16_f32 v82, v136, -v137
    v_cvt_pk_f16_f32 v83, v138, -v139
    ds_write_b64 v13, v[82:83] offset:7920
    v_cvt_pk_f16_f32 v84, v160, v161
    v_cvt_pk_f16_f32 v85, v162, v163
    ds_write_b64 v13, v[84:85] offset:12144
    v_pk_mul_f32 v[108:109], v[104:105], v[100:101] op_sel_hi:[0,1]
    v_pk_mul_f32 v[110:111], v[106:107], v[102:103] op_sel_hi:[0,1]
    v_pk_mul_f32 v[112:113], v[104:105], v[104:105] op_sel_hi:[0,1]
    v_pk_mul_f32 v[114:115], v[106:107], v[106:107] op_sel_hi:[0,1]
    v_pk_mul_f32 v[172:173], v[68:69], v[144:145] op_sel_hi:[0,1]
    v_pk_mul_f32 v[174:175], v[70:71], v[146:147] op_sel_hi:[0,1]
    v_pk_fma_f32 v[108:109], v[104:105], v[100:101], v[108:109] op_sel:[1,1,0] op_sel_hi:[1,0,1] neg_lo:[0,1,0]
    v_pk_fma_f32 v[110:111], v[106:107], v[102:103], v[110:111] op_sel:[1,1,0] op_sel_hi:[1,0,1] neg_lo:[0,1,0]
    v_pk_fma_f32 v[112:113], v[104:105], v[104:105], v[112:113] op_sel:[1,1,0] op_sel_hi:[1,0,1] neg_lo:[0,1,0]
    v_pk_fma_f32 v[114:115], v[106:107], v[106:107], v[114:115] op_sel:[1,1,0] op_sel_hi:[1,0,1] neg_lo:[0,1,0]
    v_pk_fma_f32 v[172:173], v[68:69], v[144:145], v[172:173] op_sel:[1,1,0] op_sel_hi:[1,0,1] neg_lo:[0,1,0]
    v_pk_fma_f32 v[174:175], v[70:71], v[146:147], v[174:175] op_sel:[1,1,0] op_sel_hi:[1,0,1] neg_lo:[0,1,0]
    v_cvt_pk_f16_f32 v86, v104, v105
    v_cvt_pk_f16_f32 v87, v106, v107
    ds_write_b64 v13, v[86:87] offset:3168
    v_cvt_pk_f16_f32 v76, v168, -v169
    v_cvt_pk_f16_f32 v77, v170, -v171
    ds_write_b64 v13, v[76:77] offset:8976
    v_pk_mul_f32 v[116:117], v[112:113], v[100:101] op_sel_hi:[0,1]
    v_pk_mul_f32 v[118:119], v[114:115], v[102:103] op_sel_hi:[0,1]
    v_pk_mul_f32 v[120:121], v[112:113], v[104:105] op_sel_hi:[0,1]
    v_pk_mul_f32 v[122:123], v[114:115], v[106:107] op_sel_hi:[0,1]
    v_pk_mul_f32 v[124:125], v[112:113], v[108:109] op_sel_hi:[0,1]
    v_pk_mul_f32 v[126:127], v[114:115], v[110:111] op_sel_hi:[0,1]
    v_pk_mul_f32 v[152:153], v[148:149], v[112:113] op_sel_hi:[0,1]
    v_pk_mul_f32 v[154:155], v[150:151], v[114:115] op_sel_hi:[0,1]
    v_pk_mul_f32 v[176:177], v[172:173], v[140:141] op_sel_hi:[0,1]
    v_pk_mul_f32 v[178:179], v[174:175], v[142:143] op_sel_hi:[0,1]
    v_pk_fma_f32 v[116:117], v[112:113], v[100:101], v[116:117] op_sel:[1,1,0] op_sel_hi:[1,0,1] neg_lo:[0,1,0]
    v_pk_fma_f32 v[118:119], v[114:115], v[102:103], v[118:119] op_sel:[1,1,0] op_sel_hi:[1,0,1] neg_lo:[0,1,0]
    v_pk_fma_f32 v[120:121], v[112:113], v[104:105], v[120:121] op_sel:[1,1,0] op_sel_hi:[1,0,1] neg_lo:[0,1,0]
    v_pk_fma_f32 v[122:123], v[114:115], v[106:107], v[122:123] op_sel:[1,1,0] op_sel_hi:[1,0,1] neg_lo:[0,1,0]
    v_pk_fma_f32 v[124:125], v[112:113], v[108:109], v[124:125] op_sel:[1,1,0] op_sel_hi:[1,0,1] neg_lo:[0,1,0]
    v_pk_fma_f32 v[126:127], v[114:115], v[110:111], v[126:127] op_sel:[1,1,0] op_sel_hi:[1,0,1] neg_lo:[0,1,0]
    v_pk_fma_f32 v[152:153], v[148:149], v[112:113], v[152:153] op_sel:[1,1,0] op_sel_hi:[1,0,1] neg_lo:[0,1,0]
    v_pk_fma_f32 v[154:155], v[150:151], v[114:115], v[154:155] op_sel:[1,1,0] op_sel_hi:[1,0,1] neg_lo:[0,1,0]
    v_pk_fma_f32 v[176:177], v[172:173], v[140:141], v[176:177] op_sel:[1,1,0] op_sel_hi:[1,0,1] neg_lo:[0,1,0]
    v_pk_fma_f32 v[178:179], v[174:175], v[142:143], v[178:179] op_sel:[1,1,0] op_sel_hi:[1,0,1] neg_lo:[0,1,0]
    v_cvt_pk_f16_f32 v78, v108, v109
    v_cvt_pk_f16_f32 v79, v110, v111
    ds_write_b64 v13, v[78:79] offset:3696
    v_cvt_pk_f16_f32 v80, v112, v113
    v_cvt_pk_f16_f32 v81, v114, v115
    ds_write_b64 v13, v[80:81] offset:4224
    v_cvt_pk_f16_f32 v82, v172, -v173
    v_cvt_pk_f16_f32 v83, v174, -v175
    ds_write_b64 v13, v[82:83] offset:9504
    v_cvt_pk_f16_f32 v84, v116, v117
    v_cvt_pk_f16_f32 v85, v118, v119
    ds_write_b64 v13, v[84:85] offset:4752
    v_cvt_pk_f16_f32 v86, v120, v121
    v_cvt_pk_f16_f32 v87, v122, v123
    ds_write_b64 v13, v[86:87] offset:5280
    v_cvt_pk_f16_f32 v76, v124, v125
    v_cvt_pk_f16_f32 v77, v126, v127
    ds_write_b64 v13, v[76:77] offset:5808
    v_cvt_pk_f16_f32 v78, v152, v153
    v_cvt_pk_f16_f32 v79, v154, v155
    ds_write_b64 v13, v[78:79] offset:11088
    v_cvt_pk_f16_f32 v80, v176, -v177
    v_cvt_pk_f16_f32 v81, v178, -v179
    ds_write_b64 v13, v[80:81] offset:10032
    v_mul_f32_e64 v61, v164, v68
    v_fma_f32 v61, -v165, v69, v61
    v_fma_f32 v61, v166, v70, v61
    v_fma_f32 v61, -v167, v71, v61
    s_nop 1
    v_add_f32_dpp v61, v61, v61 quad_perm:[1,0,3,2] row_mask:0xf bank_mask:0xf
    s_nop 1
    v_add_f32_dpp v61, v61, v61 quad_perm:[2,3,0,1] row_mask:0xf bank_mask:0xf
    s_nop 1
    v_add_f32_dpp v61, v61, v61 row_ror:4 row_mask:0xf bank_mask:0xf
    s_nop 1
    v_add_f32_dpp v61, v61, v61 row_ror:8 row_mask:0xf bank_mask:0xf
    v_mov_b32 v62, v61
    s_nop 1
    v_permlane16_swap_b32 v62, v61
    s_nop 1
    v_add_f32 v61, v61, v62
    v_mov_b32 v62, v61
    s_nop 1
    v_permlane32_swap_b32 v62, v61
    s_nop 1
    v_add_f32 v61, v61, v62
    v_mul_f32_e64 v61, v61, v60
    v_cvt_pk_bf16_f32 v61, v61, v61
    v_mov_b32_e64 v62, s55
    ds_write_b32 v62, v61 offset:1536
    v_lshlrev_b32 v64, 16, v32
    v_lshlrev_b32 v65, 16, v40
    v_and_b32 v66, s3, v32
    v_and_b32 v67, s3, v40
    v_lshlrev_b32 v68, 16, v33
    v_lshlrev_b32 v69, 16, v41
    v_and_b32 v70, s3, v33
    v_and_b32 v71, s3, v41
    v_lshlrev_b32 v72, 16, v34
    v_lshlrev_b32 v73, 16, v42
    v_and_b32 v74, s3, v34
    v_and_b32 v75, s3, v42
    v_lshlrev_b32 v76, 16, v35
    v_lshlrev_b32 v77, 16, v43
    v_and_b32 v78, s3, v35
    v_and_b32 v79, s3, v43
    v_lshlrev_b32 v80, 16, v36
    v_lshlrev_b32 v81, 16, v44
    v_and_b32 v82, s3, v36
    v_and_b32 v83, s3, v44
    v_lshlrev_b32 v84, 16, v37
    v_lshlrev_b32 v85, 16, v45
    v_and_b32 v86, s3, v37
    v_and_b32 v87, s3, v45
    v_lshlrev_b32 v88, 16, v38
    v_lshlrev_b32 v89, 16, v46
    v_and_b32 v90, s3, v38
    v_and_b32 v91, s3, v46
    v_lshlrev_b32 v92, 16, v39
    v_lshlrev_b32 v93, 16, v47
    v_and_b32 v94, s3, v39
    v_and_b32 v95, s3, v47
    v_pk_add_f32 v[152:153], v[64:65], v[68:69]
    v_pk_mul_f32 v[154:155], v[64:65], v[64:65]
    v_pk_add_f32 v[156:157], v[66:67], v[70:71]
    v_pk_mul_f32 v[158:159], v[66:67], v[66:67]
    v_pk_fma_f32 v[154:155], v[68:69], v[68:69], v[154:155]
    v_pk_fma_f32 v[158:159], v[70:71], v[70:71], v[158:159]
    v_pk_add_f32 v[152:153], v[152:153], v[72:73]
    v_pk_fma_f32 v[154:155], v[72:73], v[72:73], v[154:155]
    v_pk_add_f32 v[156:157], v[156:157], v[74:75]
    v_pk_fma_f32 v[158:159], v[74:75], v[74:75], v[158:159]
    v_pk_add_f32 v[152:153], v[152:153], v[76:77]
    v_pk_fma_f32 v[154:155], v[76:77], v[76:77], v[154:155]
    v_pk_add_f32 v[156:157], v[156:157], v[78:79]
    v_pk_fma_f32 v[158:159], v[78:79], v[78:79], v[158:159]
    v_pk_add_f32 v[152:153], v[152:153], v[80:81]
    v_pk_fma_f32 v[154:155], v[80:81], v[80:81], v[154:155]
    v_pk_add_f32 v[156:157], v[156:157], v[82:83]
    v_pk_fma_f32 v[158:159], v[82:83], v[82:83], v[158:159]
    v_pk_add_f32 v[152:153], v[152:153], v[84:85]
    v_pk_fma_f32 v[154:155], v[84:85], v[84:85], v[154:155]
    v_pk_add_f32 v[156:157], v[156:157], v[86:87]
    v_pk_fma_f32 v[158:159], v[86:87], v[86:87], v[158:159]
    v_pk_add_f32 v[152:153], v[152:153], v[88:89]
    v_pk_fma_f32 v[154:155], v[88:89], v[88:89], v[154:155]
    v_pk_add_f32 v[156:157], v[156:157], v[90:91]
    v_pk_fma_f32 v[158:159], v[90:91], v[90:91], v[158:159]
    v_pk_add_f32 v[152:153], v[152:153], v[92:93]
    v_pk_fma_f32 v[154:155], v[92:93], v[92:93], v[154:155]
    v_pk_add_f32 v[156:157], v[156:157], v[94:95]
    v_pk_fma_f32 v[158:159], v[94:95], v[94:95], v[158:159]
    v_pk_add_f32 v[152:153], v[152:153], v[156:157]
    v_pk_add_f32 v[154:155], v[154:155], v[158:159]
    v_and_b32 v176, 3, v30
    v_lshlrev_b32 v176, 4, v176
    v_add_u32 v176, 163584, v176
    s_lshl_b32 s48, s94, 6
    v_add_u32 v177, s48, v176
    v_add_f32_dpp v152, v152, v152 row_ror:4 row_mask:0xf bank_mask:0xf
    v_add_f32_dpp v153, v153, v153 row_ror:4 row_mask:0xf bank_mask:0xf
    v_add_f32_dpp v154, v154, v154 row_ror:4 row_mask:0xf bank_mask:0xf
    v_add_f32_dpp v155, v155, v155 row_ror:4 row_mask:0xf bank_mask:0xf
    v_add_f32_dpp v152, v152, v152 row_ror:8 row_mask:0xf bank_mask:0xf
    v_add_f32_dpp v153, v153, v153 row_ror:8 row_mask:0xf bank_mask:0xf
    v_add_f32_dpp v154, v154, v154 row_ror:8 row_mask:0xf bank_mask:0xf
    v_add_f32_dpp v155, v155, v155 row_ror:8 row_mask:0xf bank_mask:0xf
    v_mov_b32 v156, v152
    v_mov_b32 v157, v153
    v_mov_b32 v158, v154
    v_mov_b32 v159, v155
    v_permlane16_swap_b32 v156, v152
    v_permlane16_swap_b32 v157, v153
    v_permlane16_swap_b32 v158, v154
    v_permlane16_swap_b32 v159, v155
    v_add_f32 v152, v152, v156
    v_add_f32 v153, v153, v157
    v_add_f32 v154, v154, v158
    v_add_f32 v155, v155, v159
    v_mov_b32 v156, v152
    v_mov_b32 v157, v153
    v_mov_b32 v158, v154
    v_mov_b32 v159, v155
    v_permlane32_swap_b32 v156, v152
    v_permlane32_swap_b32 v157, v153
    v_permlane32_swap_b32 v158, v154
    v_permlane32_swap_b32 v159, v155
    v_add_f32 v152, v152, v156
    v_add_f32 v153, v153, v157
    v_add_f32 v154, v154, v158
    v_add_f32 v155, v155, v159
    ds_write_b128 v177, v[152:155]
    ds_read_b128 v[64:67], v10 offset:2112
    ds_read_b128 v[68:71], v10 offset:4224
    ds_read_b128 v[72:75], v11 offset:0
    ds_read_b128 v[76:79], v10 offset:8448
    ds_read_b128 v[80:83], v11 offset:6336
    ds_read_b128 v[84:87], v10 offset:10560
    ds_read_b128 v[88:91], v12 offset:2112
    ds_read_b128 v[92:95], v10 offset:2128
    ds_read_b128 v[96:99], v10 offset:4240
    ds_read_b128 v[100:103], v11 offset:16
    ds_read_b128 v[104:107], v10 offset:8464
    ds_read_b128 v[108:111], v11 offset:6352
    ds_read_b128 v[112:115], v10 offset:10576
    ds_read_b128 v[116:119], v12 offset:2128
    s_waitcnt lgkmcnt(7)
    s_nop 0
    v_pk_mul_f16 v120, v76, v80 op_sel_hi:[0,1]
    v_pk_mul_f16 v121, v77, v81 op_sel_hi:[0,1]
    v_pk_mul_f16 v122, v78, v82 op_sel_hi:[0,1]
    v_pk_mul_f16 v123, v79, v83 op_sel_hi:[0,1]
    v_pk_mul_f16 v124, v64, v72 op_sel_hi:[0,1]
    v_pk_mul_f16 v125, v65, v73 op_sel_hi:[0,1]
    v_pk_mul_f16 v126, v66, v74 op_sel_hi:[0,1]
    v_pk_mul_f16 v127, v67, v75 op_sel_hi:[0,1]
    v_pk_mul_f16 v128, v68, v72 op_sel_hi:[0,1]
    v_pk_mul_f16 v129, v69, v73 op_sel_hi:[0,1]
    v_pk_mul_f16 v130, v70, v74 op_sel_hi:[0,1]
    v_pk_mul_f16 v131, v71, v75 op_sel_hi:[0,1]
    v_pk_mul_f16 v132, v84, v88 op_sel_hi:[0,1]
    v_pk_mul_f16 v133, v85, v89 op_sel_hi:[0,1]
    v_pk_mul_f16 v134, v86, v90 op_sel_hi:[0,1]
    v_pk_mul_f16 v135, v87, v91 op_sel_hi:[0,1]
    v_pk_fma_f16 v120, v76, v80, v120 op_sel:[1,1,0] op_sel_hi:[1,0,1] neg_lo:[0,1,0]
    v_pk_fma_f16 v121, v77, v81, v121 op_sel:[1,1,0] op_sel_hi:[1,0,1] neg_lo:[0,1,0]
    v_pk_fma_f16 v122, v78, v82, v122 op_sel:[1,1,0] op_sel_hi:[1,0,1] neg_lo:[0,1,0]
    v_pk_fma_f16 v123, v79, v83, v123 op_sel:[1,1,0] op_sel_hi:[1,0,1] neg_lo:[0,1,0]
    v_pk_fma_f16 v124, v64, v72, v124 op_sel:[1,1,0] op_sel_hi:[1,0,1] neg_lo:[0,1,0]
    v_pk_fma_f16 v125, v65, v73, v125 op_sel:[1,1,0] op_sel_hi:[1,0,1] neg_lo:[0,1,0]
    v_pk_fma_f16 v126, v66, v74, v126 op_sel:[1,1,0] op_sel_hi:[1,0,1] neg_lo:[0,1,0]
    v_pk_fma_f16 v127, v67, v75, v127 op_sel:[1,1,0] op_sel_hi:[1,0,1] neg_lo:[0,1,0]
    v_pk_fma_f16 v128, v68, v72, v128 op_sel:[1,1,0] op_sel_hi:[1,0,1] neg_lo:[0,1,0]
    v_pk_fma_f16 v129, v69, v73, v129 op_sel:[1,1,0] op_sel_hi:[1,0,1] neg_lo:[0,1,0]
    v_pk_fma_f16 v130, v70, v74, v130 op_sel:[1,1,0] op_sel_hi:[1,0,1] neg_lo:[0,1,0]
    v_pk_fma_f16 v131, v71, v75, v131 op_sel:[1,1,0] op_sel_hi:[1,0,1] neg_lo:[0,1,0]
    v_pk_fma_f16 v132, v84, v88, v132 op_sel:[1,1,0] op_sel_hi:[1,0,1] neg_lo:[0,1,0]
    v_pk_fma_f16 v133, v85, v89, v133 op_sel:[1,1,0] op_sel_hi:[1,0,1] neg_lo:[0,1,0]
    v_pk_fma_f16 v134, v86, v90, v134 op_sel:[1,1,0] op_sel_hi:[1,0,1] neg_lo:[0,1,0]
    v_pk_fma_f16 v135, v87, v91, v135 op_sel:[1,1,0] op_sel_hi:[1,0,1] neg_lo:[0,1,0]
    v_mfma_f32_16x16x32_f16 v[48:51], v[124:127], v[120:123], 0
    ds_read_b128 v[64:67], v10 offset:2144
    ds_read_b128 v[68:71], v10 offset:4256
    v_mfma_f32_16x16x32_f16 v[52:55], v[128:131], v[120:123], 0
    ds_read_b128 v[72:75], v11 offset:32
    ds_read_b128 v[76:79], v10 offset:8480
    v_mfma_f32_16x16x32_f16 v[56:59], v[132:135], v[120:123], 0
    ds_read_b128 v[80:83], v11 offset:6368
    ds_read_b128 v[84:87], v10 offset:10592
    ds_read_b128 v[88:91], v12 offset:2144
    s_waitcnt vmcnt(0)
    s_cmp_lg_u32 s94, 0
    s_cbranch_scc1 L_mk_gn3_6
    s_mov_b32 s96, 0
L_mk_gn_4:
    v_readfirstlane_b32 s92, v22
    s_cmp_lg_u32 s92, 0
    s_cbranch_scc1 L_mk_gn2_5
    buffer_load_dwordx2 v[22:23], v1, s[8:11], s54 offen sc1
    s_waitcnt vmcnt(0)
    s_add_u32 s96, s96, 1
    s_cmp_lt_u32 s96, 400000
    s_cbranch_scc1 L_mk_gn_4
L_mk_gn2_5:
    ds_write_b64 v63, v[22:23]
L_mk_gn3_6:
    s_waitcnt lgkmcnt(0)
    s_barrier
    ds_read_b128 v[160:163], v176 offset:0
    ds_read_b128 v[164:167], v176 offset:64
    ds_read_b128 v[168:171], v176 offset:128
    ds_read_b128 v[172:175], v176 offset:192
    s_waitcnt lgkmcnt(0)
    s_nop 0
    v_pk_add_f32 v[152:153], v[160:161], v[164:165]
    v_pk_add_f32 v[156:157], v[168:169], v[172:173]
    v_pk_add_f32 v[154:155], v[162:163], v[166:167]
    v_pk_add_f32 v[158:159], v[170:171], v[174:175]
    v_pk_add_f32 v[152:153], v[152:153], v[156:157]
    v_pk_add_f32 v[154:155], v[154:155], v[158:159]
    v_mul_f32 v152, 0x3a800000, v152
    v_mul_f32 v153, 0x3a800000, v153
    v_mul_f32 v154, 0x3a800000, v154
    v_mul_f32 v155, 0x3a800000, v155
    v_fma_f32 v154, -v152, v152, v154
    v_fma_f32 v155, -v153, v153, v155
    v_max_f32 v154, 0, v154
    v_max_f32 v155, 0, v155
    v_cvt_pk_bf16_f32 v156, v154, v155
    v_lshlrev_b32 v154, 16, v156
    v_and_b32 v155, s3, v156
    v_add_f32 v154, 0x3727c5ac, v154
    v_add_f32 v155, 0x3727c5ac, v155
    v_cvt_pk_bf16_f32 v156, v154, v155
    v_lshlrev_b32 v154, 16, v156
    v_and_b32 v155, s3, v156
    v_sqrt_f32 v154, v154
    v_sqrt_f32 v155, v155
    v_cvt_pk_bf16_f32 v156, v152, v153
    v_cvt_pk_bf16_f32 v157, v154, v155
    ds_read_b64 v[32:33], v63
    s_cmp_lg_u32 s94, 0
    s_cbranch_scc1 L_mk_sg_7
    v_mov_b32 v158, v22
    v_mov_b32 v159, v23
    s_lshl_b32 s48, s2, 6
    s_mov_b64 exec, 0xf
    buffer_store_dwordx4 v[156:159], v8, s[60:63], s48 offen sc1
    s_mov_b64 exec, -1
L_mk_sg_7:
    s_add_u32 m0, s24, 0
    s_nop 0
    buffer_load_dwordx4 v224, s[4:7], s22 offen offset:0  lds
    buffer_load_dwordx4 v225, s[4:7], s22 offen offset:1024  lds
    buffer_load_dwordx4 v226, s[4:7], s22 offen offset:2048  lds
    buffer_load_dwordx4 v227, s[4:7], s22 offen offset:3072  lds
    s_add_u32 m0, s24, 4096
    s_nop 0
    buffer_load_dwordx4 v228, s[4:7], s22 offen offset:0  lds
    buffer_load_dwordx4 v229, s[4:7], s22 offen offset:1024  lds
    buffer_load_dwordx4 v230, s[4:7], s22 offen offset:2048  lds
    s_add_u32 s22, s22, 458752
    s_waitcnt lgkmcnt(7)
    s_nop 0
    v_pk_mul_f16 v136, v104, v108 op_sel_hi:[0,1]
    v_pk_mul_f16 v137, v105, v109 op_sel_hi:[0,1]
    v_pk_mul_f16 v138, v106, v110 op_sel_hi:[0,1]
    v_pk_mul_f16 v139, v107, v111 op_sel_hi:[0,1]
    v_pk_mul_f16 v140, v92, v100 op_sel_hi:[0,1]
    v_pk_mul_f16 v141, v93, v101 op_sel_hi:[0,1]
    v_pk_mul_f16 v142, v94, v102 op_sel_hi:[0,1]
    v_pk_mul_f16 v143, v95, v103 op_sel_hi:[0,1]
    v_pk_mul_f16 v144, v96, v100 op_sel_hi:[0,1]
    v_pk_mul_f16 v145, v97, v101 op_sel_hi:[0,1]
    v_pk_mul_f16 v146, v98, v102 op_sel_hi:[0,1]
    v_pk_mul_f16 v147, v99, v103 op_sel_hi:[0,1]
    v_pk_mul_f16 v148, v112, v116 op_sel_hi:[0,1]
    v_pk_mul_f16 v149, v113, v117 op_sel_hi:[0,1]
    v_pk_mul_f16 v150, v114, v118 op_sel_hi:[0,1]
    v_pk_mul_f16 v151, v115, v119 op_sel_hi:[0,1]
    v_pk_fma_f16 v136, v104, v108, v136 op_sel:[1,1,0] op_sel_hi:[1,0,1] neg_lo:[0,1,0]
    v_pk_fma_f16 v137, v105, v109, v137 op_sel:[1,1,0] op_sel_hi:[1,0,1] neg_lo:[0,1,0]
    v_pk_fma_f16 v138, v106, v110, v138 op_sel:[1,1,0] op_sel_hi:[1,0,1] neg_lo:[0,1,0]
    v_pk_fma_f16 v139, v107, v111, v139 op_sel:[1,1,0] op_sel_hi:[1,0,1] neg_lo:[0,1,0]
    v_pk_fma_f16 v140, v92, v100, v140 op_sel:[1,1,0] op_sel_hi:[1,0,1] neg_lo:[0,1,0]
    v_pk_fma_f16 v141, v93, v101, v141 op_sel:[1,1,0] op_sel_hi:[1,0,1] neg_lo:[0,1,0]
    v_pk_fma_f16 v142, v94, v102, v142 op_sel:[1,1,0] op_sel_hi:[1,0,1] neg_lo:[0,1,0]
    v_pk_fma_f16 v143, v95, v103, v143 op_sel:[1,1,0] op_sel_hi:[1,0,1] neg_lo:[0,1,0]
    v_pk_fma_f16 v144, v96, v100, v144 op_sel:[1,1,0] op_sel_hi:[1,0,1] neg_lo:[0,1,0]
    v_pk_fma_f16 v145, v97, v101, v145 op_sel:[1,1,0] op_sel_hi:[1,0,1] neg_lo:[0,1,0]
    v_pk_fma_f16 v146, v98, v102, v146 op_sel:[1,1,0] op_sel_hi:[1,0,1] neg_lo:[0,1,0]
    v_pk_fma_f16 v147, v99, v103, v147 op_sel:[1,1,0] op_sel_hi:[1,0,1] neg_lo:[0,1,0]
    v_pk_fma_f16 v148, v112, v116, v148 op_sel:[1,1,0] op_sel_hi:[1,0,1] neg_lo:[0,1,0]
    v_pk_fma_f16 v149, v113, v117, v149 op_sel:[1,1,0] op_sel_hi:[1,0,1] neg_lo:[0,1,0]
    v_pk_fma_f16 v150, v114, v118, v150 op_sel:[1,1,0] op_sel_hi:[1,0,1] neg_lo:[0,1,0]
    v_pk_fma_f16 v151, v115, v119, v151 op_sel:[1,1,0] op_sel_hi:[1,0,1] neg_lo:[0,1,0]
    v_mfma_f32_16x16x32_f16 v[48:51], v[140:143], v[136:139], v[48:51]
    ds_read_b128 v[92:95], v10 offset:2160
    ds_read_b128 v[96:99], v10 offset:4272
    v_mfma_f32_16x16x32_f16 v[52:55], v[144:147], v[136:139], v[52:55]
    ds_read_b128 v[100:103], v11 offset:48
    ds_read_b128 v[104:107], v10 offset:8496
    v_mfma_f32_16x16x32_f16 v[56:59], v[148:151], v[136:139], v[56:59]
    ds_read_b128 v[108:111], v11 offset:6384
    ds_read_b128 v[112:115], v10 offset:10608
    ds_read_b128 v[116:119], v12 offset:2160
    s_waitcnt lgkmcnt(7)
    s_nop 0
    v_pk_mul_f16 v120, v76, v80 op_sel_hi:[0,1]
    v_pk_mul_f16 v121, v77, v81 op_sel_hi:[0,1]
    v_pk_mul_f16 v122, v78, v82 op_sel_hi:[0,1]
    v_pk_mul_f16 v123, v79, v83 op_sel_hi:[0,1]
    v_pk_mul_f16 v124, v64, v72 op_sel_hi:[0,1]
    v_pk_mul_f16 v125, v65, v73 op_sel_hi:[0,1]
    v_pk_mul_f16 v126, v66, v74 op_sel_hi:[0,1]
    v_pk_mul_f16 v127, v67, v75 op_sel_hi:[0,1]
    v_pk_mul_f16 v128, v68, v72 op_sel_hi:[0,1]
    v_pk_mul_f16 v129, v69, v73 op_sel_hi:[0,1]
    v_pk_mul_f16 v130, v70, v74 op_sel_hi:[0,1]
    v_pk_mul_f16 v131, v71, v75 op_sel_hi:[0,1]
    v_pk_mul_f16 v132, v84, v88 op_sel_hi:[0,1]
    v_pk_mul_f16 v133, v85, v89 op_sel_hi:[0,1]
    v_pk_mul_f16 v134, v86, v90 op_sel_hi:[0,1]
    v_pk_mul_f16 v135, v87, v91 op_sel_hi:[0,1]
    v_pk_fma_f16 v120, v76, v80, v120 op_sel:[1,1,0] op_sel_hi:[1,0,1] neg_lo:[0,1,0]
    v_pk_fma_f16 v121, v77, v81, v121 op_sel:[1,1,0] op_sel_hi:[1,0,1] neg_lo:[0,1,0]
    v_pk_fma_f16 v122, v78, v82, v122 op_sel:[1,1,0] op_sel_hi:[1,0,1] neg_lo:[0,1,0]
    v_pk_fma_f16 v123, v79, v83, v123 op_sel:[1,1,0] op_sel_hi:[1,0,1] neg_lo:[0,1,0]
    v_pk_fma_f16 v124, v64, v72, v124 op_sel:[1,1,0] op_sel_hi:[1,0,1] neg_lo:[0,1,0]
    v_pk_fma_f16 v125, v65, v73, v125 op_sel:[1,1,0] op_sel_hi:[1,0,1] neg_lo:[0,1,0]
    v_pk_fma_f16 v126, v66, v74, v126 op_sel:[1,1,0] op_sel_hi:[1,0,1] neg_lo:[0,1,0]
    v_pk_fma_f16 v127, v67, v75, v127 op_sel:[1,1,0] op_sel_hi:[1,0,1] neg_lo:[0,1,0]
    v_pk_fma_f16 v128, v68, v72, v128 op_sel:[1,1,0] op_sel_hi:[1,0,1] neg_lo:[0,1,0]
    v_pk_fma_f16 v129, v69, v73, v129 op_sel:[1,1,0] op_sel_hi:[1,0,1] neg_lo:[0,1,0]
    v_pk_fma_f16 v130, v70, v74, v130 op_sel:[1,1,0] op_sel_hi:[1,0,1] neg_lo:[0,1,0]
    v_pk_fma_f16 v131, v71, v75, v131 op_sel:[1,1,0] op_sel_hi:[1,0,1] neg_lo:[0,1,0]
    v_pk_fma_f16 v132, v84, v88, v132 op_sel:[1,1,0] op_sel_hi:[1,0,1] neg_lo:[0,1,0]
    v_pk_fma_f16 v133, v85, v89, v133 op_sel:[1,1,0] op_sel_hi:[1,0,1] neg_lo:[0,1,0]
    v_pk_fma_f16 v134, v86, v90, v134 op_sel:[1,1,0] op_sel_hi:[1,0,1] neg_lo:[0,1,0]
    v_pk_fma_f16 v135, v87, v91, v135 op_sel:[1,1,0] op_sel_hi:[1,0,1] neg_lo:[0,1,0]
    v_mfma_f32_16x16x32_f16 v[48:51], v[124:127], v[120:123], v[48:51]
    ds_read_b128 v[64:67], v10 offset:2176
    ds_read_b128 v[68:71], v10 offset:4288
    v_mfma_f32_16x16x32_f16 v[52:55], v[128:131], v[120:123], v[52:55]
    ds_read_b128 v[72:75], v11 offset:64
    ds_read_b128 v[76:79], v10 offset:8512
    v_mfma_f32_16x16x32_f16 v[56:59], v[132:135], v[120:123], v[56:59]
    ds_read_b128 v[80:83], v11 offset:6400
    ds_read_b128 v[84:87], v10 offset:10624
    ds_read_b128 v[88:91], v12 offset:2176
    v_readfirstlane_b32 s92, v32
    v_readfirstlane_b32 s93, v33
    s_waitcnt lgkmcnt(7)
    s_nop 0
    v_pk_mul_f16 v136, v104, v108 op_sel_hi:[0,1]
    v_pk_mul_f16 v137, v105, v109 op_sel_hi:[0,1]
    v_pk_mul_f16 v138, v106, v110 op_sel_hi:[0,1]
    v_pk_mul_f16 v139, v107, v111 op_sel_hi:[0,1]
    v_pk_mul_f16 v140, v92, v100 op_sel_hi:[0,1]
    v_pk_mul_f16 v141, v93, v101 op_sel_hi:[0,1]
    v_pk_mul_f16 v142, v94, v102 op_sel_hi:[0,1]
    v_pk_mul_f16 v143, v95, v103 op_sel_hi:[0,1]
    v_pk_mul_f16 v144, v96, v100 op_sel_hi:[0,1]
    v_pk_mul_f16 v145, v97, v101 op_sel_hi:[0,1]
    v_pk_mul_f16 v146, v98, v102 op_sel_hi:[0,1]
    v_pk_mul_f16 v147, v99, v103 op_sel_hi:[0,1]
    v_pk_mul_f16 v148, v112, v116 op_sel_hi:[0,1]
    v_pk_mul_f16 v149, v113, v117 op_sel_hi:[0,1]
    v_pk_mul_f16 v150, v114, v118 op_sel_hi:[0,1]
    v_pk_mul_f16 v151, v115, v119 op_sel_hi:[0,1]
    v_pk_fma_f16 v136, v104, v108, v136 op_sel:[1,1,0] op_sel_hi:[1,0,1] neg_lo:[0,1,0]
    v_pk_fma_f16 v137, v105, v109, v137 op_sel:[1,1,0] op_sel_hi:[1,0,1] neg_lo:[0,1,0]
    v_pk_fma_f16 v138, v106, v110, v138 op_sel:[1,1,0] op_sel_hi:[1,0,1] neg_lo:[0,1,0]
    v_pk_fma_f16 v139, v107, v111, v139 op_sel:[1,1,0] op_sel_hi:[1,0,1] neg_lo:[0,1,0]
    v_pk_fma_f16 v140, v92, v100, v140 op_sel:[1,1,0] op_sel_hi:[1,0,1] neg_lo:[0,1,0]
    v_pk_fma_f16 v141, v93, v101, v141 op_sel:[1,1,0] op_sel_hi:[1,0,1] neg_lo:[0,1,0]
    v_pk_fma_f16 v142, v94, v102, v142 op_sel:[1,1,0] op_sel_hi:[1,0,1] neg_lo:[0,1,0]
    v_pk_fma_f16 v143, v95, v103, v143 op_sel:[1,1,0] op_sel_hi:[1,0,1] neg_lo:[0,1,0]
    v_pk_fma_f16 v144, v96, v100, v144 op_sel:[1,1,0] op_sel_hi:[1,0,1] neg_lo:[0,1,0]
    v_pk_fma_f16 v145, v97, v101, v145 op_sel:[1,1,0] op_sel_hi:[1,0,1] neg_lo:[0,1,0]
    v_pk_fma_f16 v146, v98, v102, v146 op_sel:[1,1,0] op_sel_hi:[1,0,1] neg_lo:[0,1,0]
    v_pk_fma_f16 v147, v99, v103, v147 op_sel:[1,1,0] op_sel_hi:[1,0,1] neg_lo:[0,1,0]
    v_pk_fma_f16 v148, v112, v116, v148 op_sel:[1,1,0] op_sel_hi:[1,0,1] neg_lo:[0,1,0]
    v_pk_fma_f16 v149, v113, v117, v149 op_sel:[1,1,0] op_sel_hi:[1,0,1] neg_lo:[0,1,0]
    v_pk_fma_f16 v150, v114, v118, v150 op_sel:[1,1,0] op_sel_hi:[1,0,1] neg_lo:[0,1,0]
    v_pk_fma_f16 v151, v115, v119, v151 op_sel:[1,1,0] op_sel_hi:[1,0,1] neg_lo:[0,1,0]
    v_mfma_f32_16x16x32_f16 v[48:51], v[140:143], v[136:139], v[48:51]
    ds_read_b128 v[92:95], v10 offset:2192
    ds_read_b128 v[96:99], v10 offset:4304
    v_mfma_f32_16x16x32_f16 v[52:55], v[144:147], v[136:139], v[52:55]
    ds_read_b128 v[100:103], v11 offset:80
    ds_read_b128 v[104:107], v10 offset:8528
    v_mfma_f32_16x16x32_f16 v[56:59], v[148:151], v[136:139], v[56:59]
    ds_read_b128 v[108:111], v11 offset:6416
    ds_read_b128 v[112:115], v10 offset:10640
    ds_read_b128 v[116:119], v12 offset:2192
    s_waitcnt lgkmcnt(7)
    s_nop 0
    v_pk_mul_f16 v120, v76, v80 op_sel_hi:[0,1]
    v_pk_mul_f16 v121, v77, v81 op_sel_hi:[0,1]
    v_pk_mul_f16 v122, v78, v82 op_sel_hi:[0,1]
    v_pk_mul_f16 v123, v79, v83 op_sel_hi:[0,1]
    v_pk_mul_f16 v124, v64, v72 op_sel_hi:[0,1]
    v_pk_mul_f16 v125, v65, v73 op_sel_hi:[0,1]
    v_pk_mul_f16 v126, v66, v74 op_sel_hi:[0,1]
    v_pk_mul_f16 v127, v67, v75 op_sel_hi:[0,1]
    v_pk_mul_f16 v128, v68, v72 op_sel_hi:[0,1]
    v_pk_mul_f16 v129, v69, v73 op_sel_hi:[0,1]
    v_pk_mul_f16 v130, v70, v74 op_sel_hi:[0,1]
    v_pk_mul_f16 v131, v71, v75 op_sel_hi:[0,1]
    v_pk_mul_f16 v132, v84, v88 op_sel_hi:[0,1]
    v_pk_mul_f16 v133, v85, v89 op_sel_hi:[0,1]
    v_pk_mul_f16 v134, v86, v90 op_sel_hi:[0,1]
    v_pk_mul_f16 v135, v87, v91 op_sel_hi:[0,1]
    v_pk_fma_f16 v120, v76, v80, v120 op_sel:[1,1,0] op_sel_hi:[1,0,1] neg_lo:[0,1,0]
    v_pk_fma_f16 v121, v77, v81, v121 op_sel:[1,1,0] op_sel_hi:[1,0,1] neg_lo:[0,1,0]
    v_pk_fma_f16 v122, v78, v82, v122 op_sel:[1,1,0] op_sel_hi:[1,0,1] neg_lo:[0,1,0]
    v_pk_fma_f16 v123, v79, v83, v123 op_sel:[1,1,0] op_sel_hi:[1,0,1] neg_lo:[0,1,0]
    v_pk_fma_f16 v124, v64, v72, v124 op_sel:[1,1,0] op_sel_hi:[1,0,1] neg_lo:[0,1,0]
    v_pk_fma_f16 v125, v65, v73, v125 op_sel:[1,1,0] op_sel_hi:[1,0,1] neg_lo:[0,1,0]
    v_pk_fma_f16 v126, v66, v74, v126 op_sel:[1,1,0] op_sel_hi:[1,0,1] neg_lo:[0,1,0]
    v_pk_fma_f16 v127, v67, v75, v127 op_sel:[1,1,0] op_sel_hi:[1,0,1] neg_lo:[0,1,0]
    v_pk_fma_f16 v128, v68, v72, v128 op_sel:[1,1,0] op_sel_hi:[1,0,1] neg_lo:[0,1,0]
    v_pk_fma_f16 v129, v69, v73, v129 op_sel:[1,1,0] op_sel_hi:[1,0,1] neg_lo:[0,1,0]
    v_pk_fma_f16 v130, v70, v74, v130 op_sel:[1,1,0] op_sel_hi:[1,0,1] neg_lo:[0,1,0]
    v_pk_fma_f16 v131, v71, v75, v131 op_sel:[1,1,0] op_sel_hi:[1,0,1] neg_lo:[0,1,0]
    v_pk_fma_f16 v132, v84, v88, v132 op_sel:[1,1,0] op_sel_hi:[1,0,1] neg_lo:[0,1,0]
    v_pk_fma_f16 v133, v85, v89, v133 op_sel:[1,1,0] op_sel_hi:[1,0,1] neg_lo:[0,1,0]
    v_pk_fma_f16 v134, v86, v90, v134 op_sel:[1,1,0] op_sel_hi:[1,0,1] neg_lo:[0,1,0]
    v_pk_fma_f16 v135, v87, v91, v135 op_sel:[1,1,0] op_sel_hi:[1,0,1] neg_lo:[0,1,0]
    v_mfma_f32_16x16x32_f16 v[48:51], v[124:127], v[120:123], v[48:51]
    ds_read_b128 v[64:67], v10 offset:2208
    ds_read_b128 v[68:71], v10 offset:4320
    v_mfma_f32_16x16x32_f16 v[52:55], v[128:131], v[120:123], v[52:55]
    ds_read_b128 v[72:75], v11 offset:96
    ds_read_b128 v[76:79], v10 offset:8544
    v_mfma_f32_16x16x32_f16 v[56:59], v[132:135], v[120:123], v[56:59]
    ds_read_b128 v[80:83], v11 offset:6432
    ds_read_b128 v[84:87], v10 offset:10656
    ds_read_b128 v[88:91], v12 offset:2208
    s_waitcnt lgkmcnt(7)
    s_nop 0
    v_pk_mul_f16 v136, v104, v108 op_sel_hi:[0,1]
    v_pk_mul_f16 v137, v105, v109 op_sel_hi:[0,1]
    v_pk_mul_f16 v138, v106, v110 op_sel_hi:[0,1]
    v_pk_mul_f16 v139, v107, v111 op_sel_hi:[0,1]
    v_pk_mul_f16 v140, v92, v100 op_sel_hi:[0,1]
    v_pk_mul_f16 v141, v93, v101 op_sel_hi:[0,1]
    v_pk_mul_f16 v142, v94, v102 op_sel_hi:[0,1]
    v_pk_mul_f16 v143, v95, v103 op_sel_hi:[0,1]
    v_pk_mul_f16 v144, v96, v100 op_sel_hi:[0,1]
    v_pk_mul_f16 v145, v97, v101 op_sel_hi:[0,1]
    v_pk_mul_f16 v146, v98, v102 op_sel_hi:[0,1]
    v_pk_mul_f16 v147, v99, v103 op_sel_hi:[0,1]
    v_pk_mul_f16 v148, v112, v116 op_sel_hi:[0,1]
    v_pk_mul_f16 v149, v113, v117 op_sel_hi:[0,1]
    v_pk_mul_f16 v150, v114, v118 op_sel_hi:[0,1]
    v_pk_mul_f16 v151, v115, v119 op_sel_hi:[0,1]
    v_pk_fma_f16 v136, v104, v108, v136 op_sel:[1,1,0] op_sel_hi:[1,0,1] neg_lo:[0,1,0]
    v_pk_fma_f16 v137, v105, v109, v137 op_sel:[1,1,0] op_sel_hi:[1,0,1] neg_lo:[0,1,0]
    v_pk_fma_f16 v138, v106, v110, v138 op_sel:[1,1,0] op_sel_hi:[1,0,1] neg_lo:[0,1,0]
    v_pk_fma_f16 v139, v107, v111, v139 op_sel:[1,1,0] op_sel_hi:[1,0,1] neg_lo:[0,1,0]
    v_pk_fma_f16 v140, v92, v100, v140 op_sel:[1,1,0] op_sel_hi:[1,0,1] neg_lo:[0,1,0]
    v_pk_fma_f16 v141, v93, v101, v141 op_sel:[1,1,0] op_sel_hi:[1,0,1] neg_lo:[0,1,0]
    v_pk_fma_f16 v142, v94, v102, v142 op_sel:[1,1,0] op_sel_hi:[1,0,1] neg_lo:[0,1,0]
    v_pk_fma_f16 v143, v95, v103, v143 op_sel:[1,1,0] op_sel_hi:[1,0,1] neg_lo:[0,1,0]
    v_pk_fma_f16 v144, v96, v100, v144 op_sel:[1,1,0] op_sel_hi:[1,0,1] neg_lo:[0,1,0]
    v_pk_fma_f16 v145, v97, v101, v145 op_sel:[1,1,0] op_sel_hi:[1,0,1] neg_lo:[0,1,0]
    v_pk_fma_f16 v146, v98, v102, v146 op_sel:[1,1,0] op_sel_hi:[1,0,1] neg_lo:[0,1,0]
    v_pk_fma_f16 v147, v99, v103, v147 op_sel:[1,1,0] op_sel_hi:[1,0,1] neg_lo:[0,1,0]
    v_pk_fma_f16 v148, v112, v116, v148 op_sel:[1,1,0] op_sel_hi:[1,0,1] neg_lo:[0,1,0]
    v_pk_fma_f16 v149, v113, v117, v149 op_sel:[1,1,0] op_sel_hi:[1,0,1] neg_lo:[0,1,0]
    v_pk_fma_f16 v150, v114, v118, v150 op_sel:[1,1,0] op_sel_hi:[1,0,1] neg_lo:[0,1,0]
    v_pk_fma_f16 v151, v115, v119, v151 op_sel:[1,1,0] op_sel_hi:[1,0,1] neg_lo:[0,1,0]
    v_mfma_f32_16x16x32_f16 v[48:51], v[140:143], v[136:139], v[48:51]
    ds_read_b128 v[92:95], v10 offset:2224
    ds_read_b128 v[96:99], v10 offset:4336
    v_mfma_f32_16x16x32_f16 v[52:55], v[144:147], v[136:139], v[52:55]
    ds_read_b128 v[100:103], v11 offset:112
    ds_read_b128 v[104:107], v10 offset:8560
    v_mfma_f32_16x16x32_f16 v[56:59], v[148:151], v[136:139], v[56:59]
    ds_read_b128 v[108:111], v11 offset:6448
    ds_read_b128 v[112:115], v10 offset:10672
    ds_read_b128 v[116:119], v12 offset:2224
    s_waitcnt lgkmcnt(7)
    s_nop 0
    v_pk_mul_f16 v120, v76, v80 op_sel_hi:[0,1]
    v_pk_mul_f16 v121, v77, v81 op_sel_hi:[0,1]
    v_pk_mul_f16 v122, v78, v82 op_sel_hi:[0,1]
    v_pk_mul_f16 v123, v79, v83 op_sel_hi:[0,1]
    v_pk_mul_f16 v124, v64, v72 op_sel_hi:[0,1]
    v_pk_mul_f16 v125, v65, v73 op_sel_hi:[0,1]
    v_pk_mul_f16 v126, v66, v74 op_sel_hi:[0,1]
    v_pk_mul_f16 v127, v67, v75 op_sel_hi:[0,1]
    v_pk_mul_f16 v128, v68, v72 op_sel_hi:[0,1]
    v_pk_mul_f16 v129, v69, v73 op_sel_hi:[0,1]
    v_pk_mul_f16 v130, v70, v74 op_sel_hi:[0,1]
    v_pk_mul_f16 v131, v71, v75 op_sel_hi:[0,1]
    v_pk_mul_f16 v132, v84, v88 op_sel_hi:[0,1]
    v_pk_mul_f16 v133, v85, v89 op_sel_hi:[0,1]
    v_pk_mul_f16 v134, v86, v90 op_sel_hi:[0,1]
    v_pk_mul_f16 v135, v87, v91 op_sel_hi:[0,1]
    v_pk_fma_f16 v120, v76, v80, v120 op_sel:[1,1,0] op_sel_hi:[1,0,1] neg_lo:[0,1,0]
    v_pk_fma_f16 v121, v77, v81, v121 op_sel:[1,1,0] op_sel_hi:[1,0,1] neg_lo:[0,1,0]
    v_pk_fma_f16 v122, v78, v82, v122 op_sel:[1,1,0] op_sel_hi:[1,0,1] neg_lo:[0,1,0]
    v_pk_fma_f16 v123, v79, v83, v123 op_sel:[1,1,0] op_sel_hi:[1,0,1] neg_lo:[0,1,0]
    v_pk_fma_f16 v124, v64, v72, v124 op_sel:[1,1,0] op_sel_hi:[1,0,1] neg_lo:[0,1,0]
    v_pk_fma_f16 v125, v65, v73, v125 op_sel:[1,1,0] op_sel_hi:[1,0,1] neg_lo:[0,1,0]
    v_pk_fma_f16 v126, v66, v74, v126 op_sel:[1,1,0] op_sel_hi:[1,0,1] neg_lo:[0,1,0]
    v_pk_fma_f16 v127, v67, v75, v127 op_sel:[1,1,0] op_sel_hi:[1,0,1] neg_lo:[0,1,0]
    v_pk_fma_f16 v128, v68, v72, v128 op_sel:[1,1,0] op_sel_hi:[1,0,1] neg_lo:[0,1,0]
    v_pk_fma_f16 v129, v69, v73, v129 op_sel:[1,1,0] op_sel_hi:[1,0,1] neg_lo:[0,1,0]
    v_pk_fma_f16 v130, v70, v74, v130 op_sel:[1,1,0] op_sel_hi:[1,0,1] neg_lo:[0,1,0]
    v_pk_fma_f16 v131, v71, v75, v131 op_sel:[1,1,0] op_sel_hi:[1,0,1] neg_lo:[0,1,0]
    v_pk_fma_f16 v132, v84, v88, v132 op_sel:[1,1,0] op_sel_hi:[1,0,1] neg_lo:[0,1,0]
    v_pk_fma_f16 v133, v85, v89, v133 op_sel:[1,1,0] op_sel_hi:[1,0,1] neg_lo:[0,1,0]
    v_pk_fma_f16 v134, v86, v90, v134 op_sel:[1,1,0] op_sel_hi:[1,0,1] neg_lo:[0,1,0]
    v_pk_fma_f16 v135, v87, v91, v135 op_sel:[1,1,0] op_sel_hi:[1,0,1] neg_lo:[0,1,0]
    v_mfma_f32_16x16x32_f16 v[48:51], v[124:127], v[120:123], v[48:51]
    v_mfma_f32_16x16x32_f16 v[52:55], v[128:131], v[120:123], v[52:55]
    v_mfma_f32_16x16x32_f16 v[56:59], v[132:135], v[120:123], v[56:59]
    s_waitcnt lgkmcnt(0)
    s_nop 0
    v_pk_mul_f16 v136, v104, v108 op_sel_hi:[0,1]
    v_pk_mul_f16 v137, v105, v109 op_sel_hi:[0,1]
    v_pk_mul_f16 v138, v106, v110 op_sel_hi:[0,1]
    v_pk_mul_f16 v139, v107, v111 op_sel_hi:[0,1]
    v_pk_mul_f16 v140, v92, v100 op_sel_hi:[0,1]
    v_pk_mul_f16 v141, v93, v101 op_sel_hi:[0,1]
    v_pk_mul_f16 v142, v94, v102 op_sel_hi:[0,1]
    v_pk_mul_f16 v143, v95, v103 op_sel_hi:[0,1]
    v_pk_mul_f16 v144, v96, v100 op_sel_hi:[0,1]
    v_pk_mul_f16 v145, v97, v101 op_sel_hi:[0,1]
    v_pk_mul_f16 v146, v98, v102 op_sel_hi:[0,1]
    v_pk_mul_f16 v147, v99, v103 op_sel_hi:[0,1]
    v_pk_mul_f16 v148, v112, v116 op_sel_hi:[0,1]
    v_pk_mul_f16 v149, v113, v117 op_sel_hi:[0,1]
    v_pk_mul_f16 v150, v114, v118 op_sel_hi:[0,1]
    v_pk_mul_f16 v151, v115, v119 op_sel_hi:[0,1]
    v_pk_fma_f16 v136, v104, v108, v136 op_sel:[1,1,0] op_sel_hi:[1,0,1] neg_lo:[0,1,0]
    v_pk_fma_f16 v137, v105, v109, v137 op_sel:[1,1,0] op_sel_hi:[1,0,1] neg_lo:[0,1,0]
    v_pk_fma_f16 v138, v106, v110, v138 op_sel:[1,1,0] op_sel_hi:[1,0,1] neg_lo:[0,1,0]
    v_pk_fma_f16 v139, v107, v111, v139 op_sel:[1,1,0] op_sel_hi:[1,0,1] neg_lo:[0,1,0]
    v_pk_fma_f16 v140, v92, v100, v140 op_sel:[1,1,0] op_sel_hi:[1,0,1] neg_lo:[0,1,0]
    v_pk_fma_f16 v141, v93, v101, v141 op_sel:[1,1,0] op_sel_hi:[1,0,1] neg_lo:[0,1,0]
    v_pk_fma_f16 v142, v94, v102, v142 op_sel:[1,1,0] op_sel_hi:[1,0,1] neg_lo:[0,1,0]
    v_pk_fma_f16 v143, v95, v103, v143 op_sel:[1,1,0] op_sel_hi:[1,0,1] neg_lo:[0,1,0]
    v_pk_fma_f16 v144, v96, v100, v144 op_sel:[1,1,0] op_sel_hi:[1,0,1] neg_lo:[0,1,0]
    v_pk_fma_f16 v145, v97, v101, v145 op_sel:[1,1,0] op_sel_hi:[1,0,1] neg_lo:[0,1,0]
    v_pk_fma_f16 v146, v98, v102, v146 op_sel:[1,1,0] op_sel_hi:[1,0,1] neg_lo:[0,1,0]
    v_pk_fma_f16 v147, v99, v103, v147 op_sel:[1,1,0] op_sel_hi:[1,0,1] neg_lo:[0,1,0]
    v_pk_fma_f16 v148, v112, v116, v148 op_sel:[1,1,0] op_sel_hi:[1,0,1] neg_lo:[0,1,0]
    v_pk_fma_f16 v149, v113, v117, v149 op_sel:[1,1,0] op_sel_hi:[1,0,1] neg_lo:[0,1,0]
    v_pk_fma_f16 v150, v114, v118, v150 op_sel:[1,1,0] op_sel_hi:[1,0,1] neg_lo:[0,1,0]
    v_pk_fma_f16 v151, v115, v119, v151 op_sel:[1,1,0] op_sel_hi:[1,0,1] neg_lo:[0,1,0]
    v_mfma_f32_16x16x32_f16 v[48:51], v[140:143], v[136:139], v[48:51]
    v_mfma_f32_16x16x32_f16 v[52:55], v[144:147], v[136:139], v[52:55]
    v_mfma_f32_16x16x32_f16 v[56:59], v[148:151], v[136:139], v[56:59]
    v_lshlrev_b32 v16, 4, v30
    v_add_u32 v16, s55, v16
    v_subrev_u32 v17, 4, v16
    v_add_u32 v2, s55, v2
    s_mov_b32 s48, 0x01000100
    s_mov_b32 s49, 0x03020302
    s_mov_b32 s50, 0x01000302
    s_mov_b32 s51, 0x03020504
    v_pk_mul_f32 v[48:49], v[48:49], v[60:61] op_sel_hi:[1,0]
    v_pk_mul_f32 v[50:51], v[50:51], v[60:61] op_sel_hi:[1,0]
    v_cvt_pk_bf16_f32 v64, v48, v49
    v_cvt_pk_bf16_f32 v65, v50, v51
    v_pk_mul_f32 v[52:53], v[52:53], v[60:61] op_sel_hi:[1,0]
    v_pk_mul_f32 v[54:55], v[54:55], v[60:61] op_sel_hi:[1,0]
    v_cvt_pk_bf16_f32 v66, v52, v53
    v_cvt_pk_bf16_f32 v67, v54, v55
    v_pk_mul_f32 v[56:57], v[56:57], v[60:61] op_sel_hi:[1,0]
    v_pk_mul_f32 v[58:59], v[58:59], v[60:61] op_sel_hi:[1,0]
    v_cvt_pk_bf16_f32 v68, v56, v57
    v_cvt_pk_bf16_f32 v69, v58, v59
    ds_write_b64 v15, v[64:65]
    ds_write_b64 v15, v[66:67] offset:32
    ds_write_b64 v18, v[68:69]
    ds_read_b128 v[72:75], v16
    ds_read_b32 v76, v16 offset:16
    ds_read_b32 v71, v17
    ds_read_b32 v78, v2 offset:1024
    ds_read_b32 v79, v2 offset:1028
    ds_read_b32 v80, v2 offset:1280
    ds_read_b32 v81, v2 offset:1284
    s_mov_b64 exec, 0x1ffffff
    ds_write_b128 v14, v[180:183] offset:0
    ds_write_b128 v14, v[180:183] offset:4512
    ds_write_b128 v14, v[180:183] offset:9024
    ds_write_b128 v14, v[180:183] offset:13536
    s_mov_b64 exec, -1
    s_nop 0
    s_mov_b32 s37, 4096
    s_mov_b32 s38, 8192
    s_mov_b32 s39, 12288
    buffer_load_dwordx4 v[160:163], v8, s[60:63], 0 offen sc1
    buffer_load_dwordx4 v[164:167], v8, s[60:63], s37 offen sc1
    buffer_load_dwordx4 v[168:171], v8, s[60:63], s38 offen sc1
    buffer_load_dwordx4 v[172:175], v8, s[60:63], s39 offen sc1
    s_waitcnt lgkmcnt(0)
    s_nop 0
    v_perm_b32 v84, v75, v74, v186
    v_perm_b32 v85, v74, v73, v187
    v_perm_b32 v86, v73, v72, v186
    v_perm_b32 v87, v72, v71, v188
    v_perm_b32 v88, v76, v75, v185
    v_perm_b32 v89, v74, v74, v184
    v_perm_b32 v90, v74, v73, v185
    v_perm_b32 v91, v72, v72, v184
    ds_write_b128 v20, v[84:87] offset:112
    ds_write_b128 v20, v[88:91] offset:4336
    v_perm_b32 v92, v79, v78, s51
    v_perm_b32 v93, v78, v78, s49
    v_perm_b32 v94, v78, v78, s48
    v_perm_b32 v95, v78, v78, s48
    ds_write_b128 v20, v[92:95] offset:1136
    v_perm_b32 v96, v79, v79, s48
    v_perm_b32 v97, v78, v78, s49
    v_perm_b32 v98, v78, v78, s50
    v_perm_b32 v99, v78, v78, s48
    ds_write_b128 v20, v[96:99] offset:5360
    s_lshl_b32 s55, s95, 14
    s_mov_b32 s96, 0
L_mk_p1_8:
    s_waitcnt vmcnt(0)
    v_cmp_ne_u64 vcc, s[92:93], v[162:163]
    v_cmp_ne_u64 s[48:49], s[92:93], v[166:167]
    s_or_b64 vcc, vcc, s[48:49]
    v_cmp_ne_u64 s[48:49], s[92:93], v[170:171]
    s_or_b64 vcc, vcc, s[48:49]
    v_cmp_ne_u64 s[48:49], s[92:93], v[174:175]
    s_or_b64 vcc, vcc, s[48:49]
    s_cbranch_vccz L_mk_p1d_9
    s_mov_b64 exec, vcc
    buffer_load_dwordx4 v[160:163], v8, s[60:63], 0 offen sc1
    buffer_load_dwordx4 v[164:167], v8, s[60:63], s37 offen sc1
    buffer_load_dwordx4 v[168:171], v8, s[60:63], s38 offen sc1
    buffer_load_dwordx4 v[172:175], v8, s[60:63], s39 offen sc1
    s_add_u32 s96, s96, 1
    s_cmp_lt_u32 s96, 400000
    s_cbranch_scc1 L_mk_p1_8
L_mk_p1d_9:
    s_mov_b64 exec, -1
    s_nop 0
    s_add_u32 s48, s55, 0
    buffer_load_dwordx4 v[48:51], v8, s[40:43], s48 offen sc1
    s_add_u32 s48, s55, 4096
    buffer_load_dwordx4 v[52:55], v8, s[40:43], s48 offen sc1
    s_add_u32 s48, s55, 8192
    buffer_load_dwordx4 v[56:59], v8, s[40:43], s48 offen sc1
    s_add_u32 s48, s55, 12288
    buffer_load_dwordx4 v[60:63], v8, s[40:43], s48 offen sc1
    s_mov_b32 s48, 0x01000100
    s_mov_b32 s49, 0x03020302
    v_perm_b32 v100, v80, v80, s49
    v_perm_b32 v101, v80, v80, s48
    v_perm_b32 v102, v80, v80, s48
    v_perm_b32 v103, v80, v80, s48
    ds_write_b128 v21, v[100:103] offset:2160
    v_perm_b32 v104, v81, v81, s48
    v_perm_b32 v105, v81, v80, s51
    v_perm_b32 v106, v80, v80, s49
    v_perm_b32 v107, v80, v80, s49
    ds_write_b128 v21, v[104:107] offset:2176
    v_perm_b32 v108, v80, v80, s49
    v_perm_b32 v109, v80, v80, s50
    v_perm_b32 v110, v80, v80, s48
    v_perm_b32 v111, v80, v80, s48
    ds_write_b128 v21, v[108:111] offset:6384
    v_perm_b32 v112, v81, v81, s48
    v_perm_b32 v113, v81, v81, s48
    v_perm_b32 v114, v80, v80, s49
    v_perm_b32 v115, v80, v80, s49
    ds_write_b128 v21, v[112:115] offset:6400
    ds_read_b128 a[128:131], v4 offset:0
    ds_read_b128 a[132:135], v4 offset:512
    ds_read_b128 a[136:139], v4 offset:1024
    ds_read_b128 a[140:143], v4 offset:1536
    ds_read_b128 a[144:147], v4 offset:64
    ds_read_b128 a[148:151], v4 offset:576
    ds_read_b128 a[152:155], v4 offset:1088
    ds_read_b128 a[156:159], v4 offset:1600
    v_lshlrev_b32 v162, 16, v161
    v_and_b32 v163, s3, v161
    v_and_b32 v161, s3, v160
    v_lshlrev_b32 v160, 16, v160
    v_rcp_f32 v162, v162
    v_rcp_f32 v163, v163
    v_lshlrev_b32 v166, 16, v165
    v_and_b32 v167, s3, v165
    v_and_b32 v165, s3, v164
    v_lshlrev_b32 v164, 16, v164
    v_rcp_f32 v166, v166
    v_rcp_f32 v167, v167
    v_lshlrev_b32 v170, 16, v169
    v_and_b32 v171, s3, v169
    v_and_b32 v169, s3, v168
    v_lshlrev_b32 v168, 16, v168
    v_rcp_f32 v170, v170
    v_rcp_f32 v171, v171
    v_lshlrev_b32 v174, 16, v173
    v_and_b32 v175, s3, v173
    v_and_b32 v173, s3, v172
    v_lshlrev_b32 v172, 16, v172
    v_rcp_f32 v174, v174
    v_rcp_f32 v175, v175
    s_barrier
    s_waitcnt vmcnt(3)
    v_lshlrev_b32 v128, 16, v48
    v_and_b32 v129, s3, v48
    v_lshlrev_b32 v130, 16, v49
    v_and_b32 v131, s3, v49
    v_lshlrev_b32 v132, 16, v50
    v_and_b32 v133, s3, v50
    v_lshlrev_b32 v134, 16, v51
    v_and_b32 v135, s3, v51
    v_pk_add_f32 v[96:97], v[128:129], v[160:161] neg_lo:[0,1] neg_hi:[0,1]
    v_pk_add_f32 v[98:99], v[130:131], v[160:161] neg_lo:[0,1] neg_hi:[0,1]
    v_pk_add_f32 v[100:101], v[132:133], v[160:161] neg_lo:[0,1] neg_hi:[0,1]
    v_pk_add_f32 v[102:103], v[134:135], v[160:161] neg_lo:[0,1] neg_hi:[0,1]
    v_cvt_pk_bf16_f32 v32, v96, v97
    v_cvt_pk_bf16_f32 v33, v98, v99
    v_cvt_pk_bf16_f32 v34, v100, v101
    v_cvt_pk_bf16_f32 v35, v102, v103
    v_lshlrev_b32 v96, 16, v32
    v_and_b32 v97, s3, v32
    v_lshlrev_b32 v98, 16, v33
    v_and_b32 v99, s3, v33
    v_lshlrev_b32 v100, 16, v34
    v_and_b32 v101, s3, v34
    v_lshlrev_b32 v102, 16, v35
    v_and_b32 v103, s3, v35
    v_pk_mul_f32 v[96:97], v[96:97], v[162:163]
    v_pk_mul_f32 v[98:99], v[98:99], v[162:163]
    v_pk_mul_f32 v[100:101], v[100:101], v[162:163]
    v_pk_mul_f32 v[102:103], v[102:103], v[162:163]
    v_cvt_pk_bf16_f32 v32, v96, v97
    v_cvt_pk_bf16_f32 v33, v98, v99
    v_cvt_pk_bf16_f32 v34, v100, v101
    v_cvt_pk_bf16_f32 v35, v102, v103
    ds_write2st64_b32 v190, v32, v34 offset0:0 offset1:141
    ds_write2st64_b32 v191, v33, v35 offset0:0 offset1:141
    ds_write2st64_b32 v192, v32, v34 offset0:0 offset1:141
    ds_write2st64_b32 v193, v33, v35 offset0:0 offset1:141
    ds_write2st64_b32 v194, v32, v34 offset0:0 offset1:141
    ds_write2st64_b32 v195, v33, v35 offset0:0 offset1:141
    ds_write2st64_b32 v196, v32, v34 offset0:0 offset1:141
    ds_write2st64_b32 v197, v33, v35 offset0:0 offset1:141
    s_waitcnt vmcnt(2)
    v_lshlrev_b32 v136, 16, v52
    v_and_b32 v137, s3, v52
    v_lshlrev_b32 v138, 16, v53
    v_and_b32 v139, s3, v53
    v_lshlrev_b32 v140, 16, v54
    v_and_b32 v141, s3, v54
    v_lshlrev_b32 v142, 16, v55
    v_and_b32_e64 v143, s3, v55
    v_pk_add_f32 v[104:105], v[136:137], v[164:165] neg_lo:[0,1] neg_hi:[0,1]
    v_pk_add_f32 v[106:107], v[138:139], v[164:165] neg_lo:[0,1] neg_hi:[0,1]
    v_pk_add_f32 v[108:109], v[140:141], v[164:165] neg_lo:[0,1] neg_hi:[0,1]
    v_pk_add_f32 v[110:111], v[142:143], v[164:165] neg_lo:[0,1] neg_hi:[0,1]
    v_cvt_pk_bf16_f32 v36, v104, v105
    v_cvt_pk_bf16_f32 v37, v106, v107
    v_cvt_pk_bf16_f32 v38, v108, v109
    v_cvt_pk_bf16_f32 v39, v110, v111
    v_lshlrev_b32 v104, 16, v36
    v_and_b32 v105, s3, v36
    v_lshlrev_b32 v106, 16, v37
    v_and_b32 v107, s3, v37
    v_lshlrev_b32 v108, 16, v38
    v_and_b32 v109, s3, v38
    v_lshlrev_b32 v110, 16, v39
    v_and_b32 v111, s3, v39
    v_pk_mul_f32 v[104:105], v[104:105], v[166:167]
    v_pk_mul_f32 v[106:107], v[106:107], v[166:167]
    v_pk_mul_f32 v[108:109], v[108:109], v[166:167]
    v_pk_mul_f32 v[110:111], v[110:111], v[166:167]
    v_cvt_pk_bf16_f32 v36, v104, v105
    v_cvt_pk_bf16_f32 v37, v106, v107
    v_cvt_pk_bf16_f32 v38, v108, v109
    v_cvt_pk_bf16_f32 v39, v110, v111
    ds_write2st64_b32 v190, v36, v38 offset0:4 offset1:145
    ds_write2st64_b32 v191, v37, v39 offset0:4 offset1:145
    ds_write2st64_b32 v192, v36, v38 offset0:4 offset1:145
    ds_write2st64_b32 v193, v37, v39 offset0:4 offset1:145
    ds_write2st64_b32 v194, v36, v38 offset0:4 offset1:145
    ds_write2st64_b32 v195, v37, v39 offset0:4 offset1:145
    ds_write2st64_b32 v196, v36, v38 offset0:4 offset1:145
    ds_write2st64_b32 v197, v37, v39 offset0:4 offset1:145
    s_waitcnt vmcnt(1)
    v_lshlrev_b32 v144, 16, v56
    v_and_b32 v145, s3, v56
    v_lshlrev_b32 v146, 16, v57
    v_and_b32 v147, s3, v57
    v_lshlrev_b32 v148, 16, v58
    v_and_b32 v149, s3, v58
    v_lshlrev_b32 v150, 16, v59
    v_and_b32_e64 v151, s3, v59
    v_pk_add_f32 v[112:113], v[144:145], v[168:169] neg_lo:[0,1] neg_hi:[0,1]
    v_pk_add_f32 v[114:115], v[146:147], v[168:169] neg_lo:[0,1] neg_hi:[0,1]
    v_pk_add_f32 v[116:117], v[148:149], v[168:169] neg_lo:[0,1] neg_hi:[0,1]
    v_pk_add_f32 v[118:119], v[150:151], v[168:169] neg_lo:[0,1] neg_hi:[0,1]
    v_cvt_pk_bf16_f32 v40, v112, v113
    v_cvt_pk_bf16_f32 v41, v114, v115
    v_cvt_pk_bf16_f32 v42, v116, v117
    v_cvt_pk_bf16_f32 v43, v118, v119
    v_lshlrev_b32 v112, 16, v40
    v_and_b32 v113, s3, v40
    v_lshlrev_b32 v114, 16, v41
    v_and_b32 v115, s3, v41
    v_lshlrev_b32 v116, 16, v42
    v_and_b32 v117, s3, v42
    v_lshlrev_b32 v118, 16, v43
    v_and_b32 v119, s3, v43
    v_pk_mul_f32 v[112:113], v[112:113], v[170:171]
    v_pk_mul_f32 v[114:115], v[114:115], v[170:171]
    v_pk_mul_f32 v[116:117], v[116:117], v[170:171]
    v_pk_mul_f32 v[118:119], v[118:119], v[170:171]
    v_cvt_pk_bf16_f32 v40, v112, v113
    v_cvt_pk_bf16_f32 v41, v114, v115
    v_cvt_pk_bf16_f32 v42, v116, v117
    v_cvt_pk_bf16_f32 v43, v118, v119
    ds_write2st64_b32 v190, v40, v42 offset0:8 offset1:149
    ds_write2st64_b32 v191, v41, v43 offset0:8 offset1:149
    ds_write2st64_b32 v192, v40, v42 offset0:8 offset1:149
    ds_write2st64_b32 v193, v41, v43 offset0:8 offset1:149
    ds_write2st64_b32 v194, v40, v42 offset0:8 offset1:149
    ds_write2st64_b32 v195, v41, v43 offset0:8 offset1:149
    ds_write2st64_b32 v196, v40, v42 offset0:8 offset1:149
    ds_write2st64_b32 v197, v41, v43 offset0:8 offset1:149
    s_waitcnt vmcnt(0)
    v_lshlrev_b32 v152, 16, v60
    v_and_b32 v153, s3, v60
    v_lshlrev_b32 v154, 16, v61
    v_and_b32 v155, s3, v61
    v_lshlrev_b32 v156, 16, v62
    v_and_b32 v157, s3, v62
    v_lshlrev_b32 v158, 16, v63
    v_and_b32_e64 v159, s3, v63
    v_pk_add_f32 v[120:121], v[152:153], v[172:173] neg_lo:[0,1] neg_hi:[0,1]
    v_pk_add_f32 v[122:123], v[154:155], v[172:173] neg_lo:[0,1] neg_hi:[0,1]
    v_pk_add_f32 v[124:125], v[156:157], v[172:173] neg_lo:[0,1] neg_hi:[0,1]
    v_pk_add_f32 v[126:127], v[158:159], v[172:173] neg_lo:[0,1] neg_hi:[0,1]
    v_cvt_pk_bf16_f32 v44, v120, v121
    v_cvt_pk_bf16_f32 v45, v122, v123
    v_cvt_pk_bf16_f32 v46, v124, v125
    v_cvt_pk_bf16_f32 v47, v126, v127
    v_lshlrev_b32 v120, 16, v44
    v_and_b32 v121, s3, v44
    v_lshlrev_b32 v122, 16, v45
    v_and_b32 v123, s3, v45
    v_lshlrev_b32 v124, 16, v46
    v_and_b32 v125, s3, v46
    v_lshlrev_b32 v126, 16, v47
    v_and_b32 v127, s3, v47
    v_pk_mul_f32 v[120:121], v[120:121], v[174:175]
    v_pk_mul_f32 v[122:123], v[122:123], v[174:175]
    v_pk_mul_f32 v[124:125], v[124:125], v[174:175]
    v_pk_mul_f32 v[126:127], v[126:127], v[174:175]
    v_cvt_pk_bf16_f32 v44, v120, v121
    v_cvt_pk_bf16_f32 v45, v122, v123
    v_cvt_pk_bf16_f32 v46, v124, v125
    v_cvt_pk_bf16_f32 v47, v126, v127
    ds_write2st64_b32 v190, v44, v46 offset0:12 offset1:153
    ds_write2st64_b32 v191, v45, v47 offset0:12 offset1:153
    ds_write2st64_b32 v192, v44, v46 offset0:12 offset1:153
    ds_write2st64_b32 v193, v45, v47 offset0:12 offset1:153
    ds_write2st64_b32 v194, v44, v46 offset0:12 offset1:153
    ds_write2st64_b32 v195, v45, v47 offset0:12 offset1:153
    ds_write2st64_b32 v196, v44, v46 offset0:12 offset1:153
    ds_write2st64_b32 v197, v45, v47 offset0:12 offset1:153
    s_waitcnt lgkmcnt(0)
    s_barrier
    ds_read_b128 a[160:163], v5 offset:448
    ds_read_b128 a[164:167], v5 offset:960
    ds_read_b128 a[168:171], v5 offset:1472
    ds_read_b128 a[172:175], v5 offset:1984
    ds_read_b128 a[176:179], v5 offset:384
    ds_read_b128 a[180:183], v5 offset:896
    ds_read_b128 a[184:187], v5 offset:1408
    ds_read_b128 a[188:191], v5 offset:1920
    s_lshl_b32 s12, s58, 16
    s_and_b32 s13, s58, 0xffff0000
    s_lshl_b32 s14, s59, 16
    s_and_b32 s15, s59, 0xffff0000
    v_mov_b32 v180, -1
    v_mov_b32 v181, -1
    v_mov_b32 v182, -1
    v_mov_b32 v183, -1
    s_waitcnt vmcnt(63) lgkmcnt(0)
    v_mfma_f32_16x16x32_bf16 v[64:67], a[128:131], a[160:163], 0
    ds_read_b128 a[192:195], v4 offset:128
    s_add_u32 s16, s55, 0
    v_mfma_f32_16x16x32_bf16 v[68:71], a[128:131], a[164:167], 0
    ds_read_b128 a[224:227], v5 offset:320
    buffer_store_dwordx4 v[180:183], v8, s[40:43], s16 offen sc1
    v_mfma_f32_16x16x32_bf16 v[72:75], a[128:131], a[168:171], 0
    ds_read_b128 a[228:231], v5 offset:832
    s_add_u32 s16, s55, 4096
    v_mfma_f32_16x16x32_bf16 v[76:79], a[128:131], a[172:175], 0
    ds_read_b128 a[232:235], v5 offset:1344
    buffer_store_dwordx4 v[180:183], v8, s[40:43], s16 offen sc1
    v_mfma_f32_16x16x32_bf16 v[68:71], a[132:135], a[160:163], v[68:71]
    s_add_u32 s16, s55, 8192
    buffer_store_dwordx4 v[180:183], v8, s[40:43], s16 offen sc1
    s_add_u32 s16, s55, 12288
    v_mfma_f32_16x16x32_bf16 v[72:75], a[132:135], a[164:167], v[72:75]
    ds_read_b128 a[236:239], v5 offset:1856
    buffer_store_dwordx4 v[180:183], v8, s[40:43], s16 offen sc1
    v_mfma_f32_16x16x32_bf16 v[76:79], a[132:135], a[168:171], v[76:79]
    ds_read_b128 a[196:199], v4 offset:640
    s_add_u32 m0, s24, 28800
    s_nop 0
    v_mfma_f32_16x16x32_bf16 v[72:75], a[136:139], a[160:163], v[72:75]
    ds_read_b128 a[200:203], v4 offset:1152
    buffer_load_dwordx4 v224, s[4:7], s22 offen offset:0  lds
    v_mfma_f32_16x16x32_bf16 v[76:79], a[136:139], a[164:167], v[76:79]
    ds_read_b128 a[204:207], v4 offset:1664
    buffer_load_dwordx4 v225, s[4:7], s22 offen offset:1024  lds
    v_mfma_f32_16x16x32_bf16 v[76:79], a[140:143], a[160:163], v[76:79]
    buffer_load_dwordx4 v226, s[4:7], s22 offen offset:2048  lds
    v_mfma_f32_16x16x32_bf16 v[64:67], a[144:147], a[176:179], v[64:67]
    ds_read_b128 a[208:211], v4 offset:192
    buffer_load_dwordx4 v227, s[4:7], s22 offen offset:3072  lds
    v_mfma_f32_16x16x32_bf16 v[68:71], a[144:147], a[180:183], v[68:71]
    ds_read_b128 a[240:243], v5 offset:256
    s_add_u32 m0, s24, 32896
    s_nop 0
    v_mfma_f32_16x16x32_bf16 v[72:75], a[144:147], a[184:187], v[72:75]
    ds_read_b128 a[244:247], v5 offset:768
    buffer_load_dwordx4 v228, s[4:7], s22 offen offset:0  lds
    v_mfma_f32_16x16x32_bf16 v[76:79], a[144:147], a[188:191], v[76:79]
    ds_read_b128 a[248:251], v5 offset:1280
    v_subrev_u32_e64 v17, s57, v7
    s_add_u32 s48, s24, 33920
    v_mfma_f32_16x16x32_bf16 v[68:71], a[148:151], a[176:179], v[68:71]
    v_add_u32 v17, s48, v17
    v_lshlrev_b32 v16, 2, v0
    v_lshrrev_b32 v18, 4, v0
    v_mfma_f32_16x16x32_bf16 v[72:75], a[148:151], a[180:183], v[72:75]
    ds_read_b128 a[252:255], v5 offset:1792
    v_lshlrev_b32 v18, 8, v18
    v_add_u32 v18, v18, v8
    v_mfma_f32_16x16x32_bf16 v[76:79], a[148:151], a[184:187], v[76:79]
    ds_read_b128 a[212:215], v4 offset:704
    v_add_u32 v19, 33920, v16
    v_add_u32 v20, 48384, v16
    v_mfma_f32_16x16x32_bf16 v[72:75], a[152:155], a[176:179], v[72:75]
    ds_read_b128 a[216:219], v4 offset:1216
    v_mfma_f32_16x16x32_bf16 v[76:79], a[152:155], a[180:183], v[76:79]
    ds_read_b128 a[220:223], v4 offset:1728
    v_mfma_f32_16x16x32_bf16 v[76:79], a[156:159], a[176:179], v[76:79]
    s_waitcnt vmcnt(63) lgkmcnt(6)
    v_mfma_f32_16x16x32_bf16 v[64:67], a[192:195], a[224:227], v[64:67]
    ds_read_b128 a[128:131], v4 offset:256
    v_lshlrev_b32 v96, 16, v32
    v_mfma_f32_16x16x32_bf16 v[68:71], a[192:195], a[228:231], v[68:71]
    ds_read_b128 a[160:163], v5 offset:192
    v_and_b32 v97, s3, v32
    v_mfma_f32_16x16x32_bf16 v[72:75], a[192:195], a[232:235], v[72:75]
    ds_read_b128 a[164:167], v5 offset:704
    v_mul_f32 v96, s12, v96
    v_mfma_f32_16x16x32_bf16 v[76:79], a[192:195], a[236:239], v[76:79]
    ds_read_b128 a[168:171], v5 offset:1216
    v_mul_f32 v97, s12, v97
    v_mfma_f32_16x16x32_bf16 v[68:71], a[196:199], a[224:227], v[68:71]
    v_cvt_pk_bf16_f32 v32, v96, v97
    v_lshlrev_b32 v96, 16, v32
    v_mfma_f32_16x16x32_bf16 v[72:75], a[196:199], a[228:231], v[72:75]
    ds_read_b128 a[172:175], v5 offset:1728
    v_and_b32 v97, s3, v32
    v_mfma_f32_16x16x32_bf16 v[76:79], a[196:199], a[232:235], v[76:79]
    ds_read_b128 a[132:135], v4 offset:768
    v_lshlrev_b32 v98, 16, v33
    v_mfma_f32_16x16x32_bf16 v[72:75], a[200:203], a[224:227], v[72:75]
    ds_read_b128 a[136:139], v4 offset:1280
    v_and_b32 v99, s3, v33
    v_mfma_f32_16x16x32_bf16 v[76:79], a[200:203], a[228:231], v[76:79]
    ds_read_b128 a[140:143], v4 offset:1792
    v_mul_f32 v98, s13, v98
    v_mfma_f32_16x16x32_bf16 v[76:79], a[204:207], a[224:227], v[76:79]
    v_mul_f32 v99, s13, v99
    v_cvt_pk_bf16_f32 v33, v98, v99
    v_mfma_f32_16x16x32_bf16 v[64:67], a[208:211], a[240:243], v[64:67]
    ds_read_b128 a[144:147], v4 offset:320
    s_waitcnt lgkmcnt(9)
    v_mfma_f32_16x16x32_bf16 v[68:71], a[208:211], a[244:247], v[68:71]
    ds_read_b128 a[176:179], v5 offset:128
    v_lshlrev_b32 v98, 16, v33
    v_mfma_f32_16x16x32_bf16 v[72:75], a[208:211], a[248:251], v[72:75]
    ds_read_b128 a[180:183], v5 offset:640
    v_and_b32 v99, s3, v33
    v_mfma_f32_16x16x32_bf16 v[76:79], a[208:211], a[252:255], v[76:79]
    ds_read_b128 a[184:187], v5 offset:1152
    v_lshlrev_b32 v100, 16, v34
    v_mfma_f32_16x16x32_bf16 v[68:71], a[212:215], a[240:243], v[68:71]
    v_and_b32 v101, s3, v34
    v_mul_f32 v100, s14, v100
    v_mfma_f32_16x16x32_bf16 v[72:75], a[212:215], a[244:247], v[72:75]
    ds_read_b128 a[188:191], v5 offset:1664
    v_mul_f32 v101, s14, v101
    v_mfma_f32_16x16x32_bf16 v[76:79], a[212:215], a[248:251], v[76:79]
    ds_read_b128 a[148:151], v4 offset:832
    v_cvt_pk_bf16_f32 v34, v100, v101
    v_mfma_f32_16x16x32_bf16 v[72:75], a[216:219], a[240:243], v[72:75]
    ds_read_b128 a[152:155], v4 offset:1344
    v_lshlrev_b32 v100, 16, v34
    v_mfma_f32_16x16x32_bf16 v[76:79], a[216:219], a[244:247], v[76:79]
    ds_read_b128 a[156:159], v4 offset:1856
    v_mfma_f32_16x16x32_bf16 v[76:79], a[220:223], a[240:243], v[76:79]
    s_waitcnt vmcnt(63) lgkmcnt(6)
    v_mfma_f32_16x16x32_bf16 v[64:67], a[128:131], a[160:163], v[64:67]
    ds_read_b128 a[192:195], v4 offset:384
    v_and_b32 v101, s3, v34
    v_mfma_f32_16x16x32_bf16 v[68:71], a[128:131], a[164:167], v[68:71]
    ds_read_b128 a[224:227], v5 offset:64
    v_lshlrev_b32 v102, 16, v35
    v_mfma_f32_16x16x32_bf16 v[72:75], a[128:131], a[168:171], v[72:75]
    ds_read_b128 a[228:231], v5 offset:576
    v_and_b32 v103, s3, v35
    v_mfma_f32_16x16x32_bf16 v[76:79], a[128:131], a[172:175], v[76:79]
    ds_read_b128 a[232:235], v5 offset:1088
    v_mul_f32 v102, s15, v102
    v_mfma_f32_16x16x32_bf16 v[68:71], a[132:135], a[160:163], v[68:71]
    v_mul_f32 v103, s15, v103
    v_cvt_pk_bf16_f32 v35, v102, v103
    v_mfma_f32_16x16x32_bf16 v[72:75], a[132:135], a[164:167], v[72:75]
    ds_read_b128 a[236:239], v5 offset:1600
    v_lshlrev_b32 v102, 16, v35
    v_mfma_f32_16x16x32_bf16 v[76:79], a[132:135], a[168:171], v[76:79]
    ds_read_b128 a[196:199], v4 offset:896
    v_and_b32 v103, s3, v35
    v_mfma_f32_16x16x32_bf16 v[72:75], a[136:139], a[160:163], v[72:75]
    ds_read_b128 a[200:203], v4 offset:1408
    v_lshlrev_b32 v104, 16, v36
    v_mfma_f32_16x16x32_bf16 v[76:79], a[136:139], a[164:167], v[76:79]
    ds_read_b128 a[204:207], v4 offset:1920
    v_and_b32 v105, s3, v36
    v_mfma_f32_16x16x32_bf16 v[76:79], a[140:143], a[160:163], v[76:79]
    v_mul_f32 v104, s12, v104
    v_mul_f32 v105, s12, v105
    v_mfma_f32_16x16x32_bf16 v[64:67], a[144:147], a[176:179], v[64:67]
    ds_read_b128 a[208:211], v4 offset:448
    s_waitcnt lgkmcnt(9)
    v_mfma_f32_16x16x32_bf16 v[68:71], a[144:147], a[180:183], v[68:71]
    ds_read_b128 a[240:243], v5 offset:0
    v_cvt_pk_bf16_f32 v36, v104, v105
    v_mfma_f32_16x16x32_bf16 v[72:75], a[144:147], a[184:187], v[72:75]
    ds_read_b128 a[244:247], v5 offset:512
    v_lshlrev_b32 v104, 16, v36
    v_mfma_f32_16x16x32_bf16 v[76:79], a[144:147], a[188:191], v[76:79]
    ds_read_b128 a[248:251], v5 offset:1024
    v_and_b32 v105, s3, v36
    v_mfma_f32_16x16x32_bf16 v[68:71], a[148:151], a[176:179], v[68:71]
    v_lshlrev_b32 v106, 16, v37
    v_and_b32 v107, s3, v37
    v_mfma_f32_16x16x32_bf16 v[72:75], a[148:151], a[180:183], v[72:75]
    ds_read_b128 a[252:255], v5 offset:1536
    v_mul_f32 v106, s13, v106
    v_mfma_f32_16x16x32_bf16 v[76:79], a[148:151], a[184:187], v[76:79]
    ds_read_b128 a[212:215], v4 offset:960
    v_mul_f32 v107, s13, v107
    v_mfma_f32_16x16x32_bf16 v[72:75], a[152:155], a[176:179], v[72:75]
    ds_read_b128 a[216:219], v4 offset:1472
    v_cvt_pk_bf16_f32 v37, v106, v107
    v_mfma_f32_16x16x32_bf16 v[76:79], a[152:155], a[180:183], v[76:79]
    ds_read_b128 a[220:223], v4 offset:1984
    v_mfma_f32_16x16x32_bf16 v[76:79], a[156:159], a[176:179], v[76:79]
    s_waitcnt vmcnt(63) lgkmcnt(6)
    v_mfma_f32_16x16x32_bf16 v[64:67], a[192:195], a[224:227], v[64:67]
    ds_read_b128 a[128:131], v4 offset:0
    v_lshlrev_b32 v106, 16, v37
    v_mfma_f32_16x16x32_bf16 v[68:71], a[192:195], a[228:231], v[68:71]
    ds_read_b128 a[176:179], v5 offset:2496
    v_and_b32 v107, s3, v37
    v_mfma_f32_16x16x32_bf16 v[72:75], a[192:195], a[232:235], v[72:75]
    ds_read_b128 a[180:183], v5 offset:3008
    v_lshlrev_b32 v108, 16, v38
    v_mfma_f32_16x16x32_bf16 v[76:79], a[192:195], a[236:239], v[76:79]
    ds_read_b128 a[184:187], v5 offset:3520
    v_and_b32 v109, s3, v38
    v_mfma_f32_16x16x32_bf16 v[68:71], a[196:199], a[224:227], v[68:71]
    v_mul_f32 v108, s14, v108
    v_mul_f32 v109, s14, v109
    v_mfma_f32_16x16x32_bf16 v[72:75], a[196:199], a[228:231], v[72:75]
    ds_read_b128 a[188:191], v5 offset:4032
    v_cvt_pk_bf16_f32 v38, v108, v109
    v_mfma_f32_16x16x32_bf16 v[76:79], a[196:199], a[232:235], v[76:79]
    ds_read_b128 a[132:135], v4 offset:512
    v_lshlrev_b32 v108, 16, v38
    v_mfma_f32_16x16x32_bf16 v[72:75], a[200:203], a[224:227], v[72:75]
    ds_read_b128 a[172:175], v5 offset:1984
    v_and_b32 v109, s3, v38
    v_mfma_f32_16x16x32_bf16 v[76:79], a[200:203], a[228:231], v[76:79]
    ds_read_b128 a[136:139], v4 offset:1024
    v_lshlrev_b32 v110, 16, v39
    v_mfma_f32_16x16x32_bf16 v[76:79], a[204:207], a[224:227], v[76:79]
    v_and_b32 v111, s3, v39
    v_mul_f32 v110, s15, v110
    v_mfma_f32_16x16x32_bf16 v[64:67], a[208:211], a[240:243], v[64:67]
    ds_read_b128 a[168:171], v5 offset:1472
    s_waitcnt lgkmcnt(9)
    v_mfma_f32_16x16x32_bf16 v[68:71], a[208:211], a[244:247], v[68:71]
    ds_read_b128 a[140:143], v4 offset:1536
    v_mul_f32 v111, s15, v111
    v_mfma_f32_16x16x32_bf16 v[72:75], a[208:211], a[248:251], v[72:75]
    ds_read_b128 a[164:167], v5 offset:960
    v_cvt_pk_bf16_f32 v39, v110, v111
    v_mfma_f32_16x16x32_bf16 v[76:79], a[208:211], a[252:255], v[76:79]
    ds_read_b128 a[144:147], v4 offset:2048
    v_lshlrev_b32 v110, 16, v39
    v_mfma_f32_16x16x32_bf16 v[68:71], a[212:215], a[240:243], v[68:71]
    v_and_b32 v111, s3, v39
    v_mfma_f32_16x16x32_bf16 v[72:75], a[212:215], a[244:247], v[72:75]
    ds_read_b128 a[160:163], v5 offset:448
    v_mfma_f32_16x16x32_bf16 v[76:79], a[212:215], a[248:251], v[76:79]
    ds_read_b128 a[148:151], v4 offset:2560
    v_mfma_f32_16x16x32_bf16 v[72:75], a[216:219], a[240:243], v[72:75]
    ds_read_b128 a[152:155], v4 offset:3072
    v_mfma_f32_16x16x32_bf16 v[76:79], a[216:219], a[244:247], v[76:79]
    ds_read_b128 a[156:159], v4 offset:3584
    v_mfma_f32_16x16x32_bf16 v[76:79], a[220:223], a[240:243], v[76:79]
    s_waitcnt vmcnt(63) lgkmcnt(6)
    v_mfma_f32_16x16x32_bf16 v[80:83], a[128:131], a[176:179], 0
    ds_read_b128 a[192:195], v4 offset:64
    v_mfma_f32_16x16x32_bf16 v[84:87], a[128:131], a[180:183], 0
    ds_read_b128 a[240:243], v5 offset:2432
    v_cvt_pk_bf16_f32 v168, v64, v65
    v_cvt_pk_bf16_f32 v169, v66, v67
    v_mfma_f32_16x16x32_bf16 v[88:91], a[128:131], a[184:187], 0
    ds_write2_b32 v17, v168, v169 offset0:0 offset1:4
    v_cvt_pk_bf16_f32 v170, v68, v69
    v_mfma_f32_16x16x32_bf16 v[92:95], a[128:131], a[188:191], 0
    v_cvt_pk_bf16_f32 v171, v70, v71
    ds_write2_b32 v17, v170, v171 offset0:128 offset1:132
    v_mfma_f32_16x16x32_bf16 v[80:83], a[132:135], a[172:175], v[80:83]
    ds_read_b128 a[244:247], v5 offset:2944
    v_add_u32 v17, 1024, v17
    v_cvt_pk_bf16_f32 v172, v72, v73
    v_mfma_f32_16x16x32_bf16 v[84:87], a[132:135], a[176:179], v[84:87]
    v_cvt_pk_bf16_f32 v173, v74, v75
    ds_write2_b32 v17, v172, v173 offset0:0 offset1:4
    v_mfma_f32_16x16x32_bf16 v[88:91], a[132:135], a[180:183], v[88:91]
    ds_read_b128 a[248:251], v5 offset:3456
    v_cvt_pk_bf16_f32 v174, v76, v77
    v_cvt_pk_bf16_f32 v175, v78, v79
    v_mfma_f32_16x16x32_bf16 v[92:95], a[132:135], a[184:187], v[92:95]
    ds_write2_b32 v17, v174, v175 offset0:128 offset1:132
    v_mfma_f32_16x16x32_bf16 v[80:83], a[136:139], a[168:171], v[80:83]
    v_mfma_f32_16x16x32_bf16 v[84:87], a[136:139], a[172:175], v[84:87]
    s_waitcnt lgkmcnt(0)
    s_barrier
    v_mfma_f32_16x16x32_bf16 v[88:91], a[136:139], a[176:179], v[88:91]
    ds_read2st64_b32 v[48:49], v19 offset0:0 offset1:28
    v_mfma_f32_16x16x32_bf16 v[92:95], a[136:139], a[180:183], v[92:95]
    ds_read2st64_b32 v[50:51], v20 offset0:0 offset1:28
    v_mfma_f32_16x16x32_bf16 v[80:83], a[140:143], a[164:167], v[80:83]
    ds_read2st64_b32 v[52:53], v19 offset0:4 offset1:32
    v_mfma_f32_16x16x32_bf16 v[84:87], a[140:143], a[168:171], v[84:87]
    ds_read2st64_b32 v[54:55], v20 offset0:4 offset1:32
    v_mfma_f32_16x16x32_bf16 v[88:91], a[140:143], a[172:175], v[88:91]
    ds_read_b128 a[252:255], v5 offset:3968
    v_mfma_f32_16x16x32_bf16 v[92:95], a[140:143], a[176:179], v[92:95]
    ds_read_b128 a[196:199], v4 offset:576
    v_mfma_f32_16x16x32_bf16 v[80:83], a[144:147], a[160:163], v[80:83]
    ds_read_b128 a[236:239], v5 offset:1920
    v_mfma_f32_16x16x32_bf16 v[84:87], a[144:147], a[164:167], v[84:87]
    ds_read_b128 a[200:203], v4 offset:1088
    v_mfma_f32_16x16x32_bf16 v[88:91], a[144:147], a[168:171], v[88:91]
    ds_read_b128 a[232:235], v5 offset:1408
    v_mfma_f32_16x16x32_bf16 v[92:95], a[144:147], a[172:175], v[92:95]
    ds_read_b128 a[204:207], v4 offset:1600
    v_mfma_f32_16x16x32_bf16 v[84:87], a[148:151], a[160:163], v[84:87]
    ds_read_b128 a[228:231], v5 offset:896
    v_mfma_f32_16x16x32_bf16 v[88:91], a[148:151], a[164:167], v[88:91]
    ds_read_b128 a[208:211], v4 offset:2112
    v_mfma_f32_16x16x32_bf16 v[92:95], a[148:151], a[168:171], v[92:95]
    ds_read_b128 a[224:227], v5 offset:384
    v_mfma_f32_16x16x32_bf16 v[88:91], a[152:155], a[160:163], v[88:91]
    ds_read_b128 a[212:215], v4 offset:2624
    v_mfma_f32_16x16x32_bf16 v[92:95], a[152:155], a[164:167], v[92:95]
    ds_read_b128 a[216:219], v4 offset:3136
    v_mfma_f32_16x16x32_bf16 v[92:95], a[156:159], a[160:163], v[92:95]
    ds_read_b128 a[220:223], v4 offset:3648
    s_waitcnt vmcnt(63) lgkmcnt(6)
    v_lshlrev_b32 v160, 16, v48
    v_and_b32 v161, s3, v48
    v_lshlrev_b32 v162, 16, v49
    v_and_b32 v163, s3, v49
    v_lshlrev_b32 v164, 16, v50
    v_and_b32 v165, s3, v50
    v_lshlrev_b32 v166, 16, v51
    v_and_b32_e64 v167, s3, v51
    v_pk_add_f32 v[96:97], v[96:97], v[160:161]
    v_pk_add_f32 v[98:99], v[98:99], v[162:163]
    v_pk_add_f32 v[100:101], v[100:101], v[164:165]
    v_pk_add_f32 v[102:103], v[102:103], v[166:167]
    v_cvt_pk_bf16_f32 v160, v96, v97
    v_cvt_pk_bf16_f32 v161, v98, v99
    v_cvt_pk_bf16_f32 v162, v100, v101
    v_cvt_pk_bf16_f32 v163, v102, v103
    v_lshlrev_b32 v96, 16, v160
    v_and_b32 v97, s3, v160
    v_lshlrev_b32 v98, 16, v161
    v_and_b32 v99, s3, v161
    v_lshlrev_b32 v100, 16, v162
    v_and_b32 v101, s3, v162
    v_lshlrev_b32 v102, 16, v163
    v_and_b32 v103, s3, v163
    v_pk_add_f32 v[96:97], v[96:97], v[128:129]
    v_pk_add_f32 v[98:99], v[98:99], v[130:131]
    v_pk_add_f32 v[100:101], v[100:101], v[132:133]
    v_pk_add_f32 v[102:103], v[102:103], v[134:135]
    v_cvt_pk_bf16_f32 v48, v96, v98
    v_cvt_pk_bf16_f32 v49, v100, v102
    v_cvt_pk_bf16_f32 v50, v97, v99
    v_cvt_pk_bf16_f32 v51, v101, v103
    s_add_u32 s48, s55, 0
    buffer_store_dwordx4 v[48:51], v18, s[44:47], s48 offen sc1
    v_lshlrev_b32 v160, 16, v52
    v_and_b32 v161, s3, v52
    v_lshlrev_b32 v162, 16, v53
    v_and_b32 v163, s3, v53
    v_lshlrev_b32 v164, 16, v54
    v_and_b32 v165, s3, v54
    v_lshlrev_b32 v166, 16, v55
    v_and_b32_e64 v167, s3, v55
    v_pk_add_f32 v[104:105], v[104:105], v[160:161]
    v_pk_add_f32 v[106:107], v[106:107], v[162:163]
    v_pk_add_f32 v[108:109], v[108:109], v[164:165]
    v_pk_add_f32 v[110:111], v[110:111], v[166:167]
    v_cvt_pk_bf16_f32 v160, v104, v105
    v_cvt_pk_bf16_f32 v161, v106, v107
    v_cvt_pk_bf16_f32 v162, v108, v109
    v_cvt_pk_bf16_f32 v163, v110, v111
    v_lshlrev_b32 v104, 16, v160
    v_and_b32 v105, s3, v160
    v_lshlrev_b32 v106, 16, v161
    v_and_b32 v107, s3, v161
    v_lshlrev_b32 v108, 16, v162
    v_and_b32 v109, s3, v162
    v_lshlrev_b32 v110, 16, v163
    v_and_b32 v111, s3, v163
    v_pk_add_f32 v[104:105], v[104:105], v[136:137]
    v_pk_add_f32 v[106:107], v[106:107], v[138:139]
    v_pk_add_f32 v[108:109], v[108:109], v[140:141]
    v_pk_add_f32 v[110:111], v[110:111], v[142:143]
    v_cvt_pk_bf16_f32 v52, v104, v106
    v_cvt_pk_bf16_f32 v53, v108, v110
    v_cvt_pk_bf16_f32 v54, v105, v107
    v_cvt_pk_bf16_f32 v55, v109, v111
    s_add_u32 s48, s55, 8192
    buffer_store_dwordx4 v[52:55], v18, s[44:47], s48 offen sc1
    v_mfma_f32_16x16x32_bf16 v[80:83], a[192:195], a[240:243], v[80:83]
    ds_read_b128 a[128:131], v4 offset:128
    v_lshlrev_b32 v112, 16, v40
    v_mfma_f32_16x16x32_bf16 v[84:87], a[192:195], a[244:247], v[84:87]
    v_and_b32 v113, s3, v40
    v_mul_f32 v112, s12, v112
    v_mfma_f32_16x16x32_bf16 v[88:91], a[192:195], a[248:251], v[88:91]
    ds_read_b128 a[176:179], v5 offset:2368
    v_mul_f32 v113, s12, v113
    v_mfma_f32_16x16x32_bf16 v[92:95], a[192:195], a[252:255], v[92:95]
    ds_read_b128 a[180:183], v5 offset:2880
    v_cvt_pk_bf16_f32 v40, v112, v113
    v_mfma_f32_16x16x32_bf16 v[80:83], a[196:199], a[236:239], v[80:83]
    v_lshlrev_b32 v112, 16, v40
    v_and_b32 v113, s3, v40
    v_mfma_f32_16x16x32_bf16 v[84:87], a[196:199], a[240:243], v[84:87]
    ds_read_b128 a[184:187], v5 offset:3392
    v_lshlrev_b32 v114, 16, v41
    v_mfma_f32_16x16x32_bf16 v[88:91], a[196:199], a[244:247], v[88:91]
    ds_read_b128 a[188:191], v5 offset:3904
    v_and_b32 v115, s3, v41
    v_mfma_f32_16x16x32_bf16 v[92:95], a[196:199], a[248:251], v[92:95]
    v_mul_f32 v114, s13, v114
    v_mul_f32 v115, s13, v115
    v_mfma_f32_16x16x32_bf16 v[80:83], a[200:203], a[232:235], v[80:83]
    ds_read_b128 a[132:135], v4 offset:640
    v_cvt_pk_bf16_f32 v41, v114, v115
    v_mfma_f32_16x16x32_bf16 v[84:87], a[200:203], a[236:239], v[84:87]
    v_lshlrev_b32 v114, 16, v41
    v_and_b32 v115, s3, v41
    v_mfma_f32_16x16x32_bf16 v[88:91], a[200:203], a[240:243], v[88:91]
    ds_read_b128 a[172:175], v5 offset:1856
    v_lshlrev_b32 v116, 16, v42
    v_mfma_f32_16x16x32_bf16 v[92:95], a[200:203], a[244:247], v[92:95]
    ds_read_b128 a[136:139], v4 offset:1152
    s_waitcnt lgkmcnt(8)
    v_mfma_f32_16x16x32_bf16 v[80:83], a[204:207], a[228:231], v[80:83]
    v_and_b32 v117, s3, v42
    v_mul_f32 v116, s14, v116
    v_mfma_f32_16x16x32_bf16 v[84:87], a[204:207], a[232:235], v[84:87]
    ds_read_b128 a[168:171], v5 offset:1344
    v_mul_f32 v117, s14, v117
    v_mfma_f32_16x16x32_bf16 v[88:91], a[204:207], a[236:239], v[88:91]
    ds_read_b128 a[140:143], v4 offset:1664
    v_cvt_pk_bf16_f32 v42, v116, v117
    v_mfma_f32_16x16x32_bf16 v[92:95], a[204:207], a[240:243], v[92:95]
    v_lshlrev_b32 v116, 16, v42
    v_and_b32 v117, s3, v42
    v_mfma_f32_16x16x32_bf16 v[80:83], a[208:211], a[224:227], v[80:83]
    ds_read_b128 a[164:167], v5 offset:832
    v_lshlrev_b32 v118, 16, v43
    v_mfma_f32_16x16x32_bf16 v[84:87], a[208:211], a[228:231], v[84:87]
    v_and_b32 v119, s3, v43
    v_mul_f32 v118, s15, v118
    v_mfma_f32_16x16x32_bf16 v[88:91], a[208:211], a[232:235], v[88:91]
    ds_read_b128 a[144:147], v4 offset:2176
    v_mul_f32 v119, s15, v119
    v_mfma_f32_16x16x32_bf16 v[92:95], a[208:211], a[236:239], v[92:95]
    ds_read_b128 a[160:163], v5 offset:320
    v_cvt_pk_bf16_f32 v43, v118, v119
    v_mfma_f32_16x16x32_bf16 v[84:87], a[212:215], a[224:227], v[84:87]
    v_lshlrev_b32 v118, 16, v43
    v_and_b32 v119, s3, v43
    v_mfma_f32_16x16x32_bf16 v[88:91], a[212:215], a[228:231], v[88:91]
    ds_read_b128 a[148:151], v4 offset:2688
    v_mfma_f32_16x16x32_bf16 v[92:95], a[212:215], a[232:235], v[92:95]
    ds_read_b128 a[152:155], v4 offset:3200
    v_mfma_f32_16x16x32_bf16 v[88:91], a[216:219], a[224:227], v[88:91]
    v_mfma_f32_16x16x32_bf16 v[92:95], a[216:219], a[228:231], v[92:95]
    ds_read_b128 a[156:159], v4 offset:3712
    v_mfma_f32_16x16x32_bf16 v[92:95], a[220:223], a[224:227], v[92:95]
    s_waitcnt vmcnt(0) lgkmcnt(6)
    s_barrier
    s_cmp_lg_u32 s94, 0
    s_cbranch_scc1 L_mk_fl_10
    s_lshl_b32 s48, s2, 6
    s_add_u32 s48, s48, 16384
    v_mov_b32 v24, s92
    v_mov_b32 v25, s93
    v_mov_b32 v26, 0
    s_mov_b64 exec, 1
    buffer_store_dwordx2 v[24:25], v26, s[60:63], s48 offen sc1
    s_mov_b64 exec, -1
L_mk_fl_10:
    v_mfma_f32_16x16x32_bf16 v[80:83], a[128:131], a[176:179], v[80:83]
    ds_read_b128 a[192:195], v4 offset:192
    v_lshlrev_b32 v120, 16, v44
    v_and_b32 v121, s3, v44
    v_mfma_f32_16x16x32_bf16 v[84:87], a[128:131], a[180:183], v[84:87]
    v_mul_f32 v120, s12, v120
    v_mul_f32_e64 v121, s12, v121
    v_cvt_pk_bf16_f32 v44, v120, v121
    v_mfma_f32_16x16x32_bf16 v[88:91], a[128:131], a[184:187], v[88:91]
    ds_read_b128 a[240:243], v5 offset:2304
    v_lshlrev_b32 v120, 16, v44
    v_and_b32 v121, s3, v44
    v_mfma_f32_16x16x32_bf16 v[92:95], a[128:131], a[188:191], v[92:95]
    ds_read_b128 a[244:247], v5 offset:2816
    v_lshlrev_b32 v122, 16, v45
    v_and_b32 v123, s3, v45
    v_mfma_f32_16x16x32_bf16 v[80:83], a[132:135], a[172:175], v[80:83]
    v_mul_f32 v122, s13, v122
    v_mul_f32 v123, s13, v123
    v_cvt_pk_bf16_f32 v45, v122, v123
    v_mfma_f32_16x16x32_bf16 v[84:87], a[132:135], a[176:179], v[84:87]
    ds_read_b128 a[248:251], v5 offset:3328
    v_lshlrev_b32 v122, 16, v45
    v_and_b32 v123, s3, v45
    v_mfma_f32_16x16x32_bf16 v[88:91], a[132:135], a[180:183], v[88:91]
    ds_read_b128 a[252:255], v5 offset:3840
    v_lshlrev_b32 v124, 16, v46
    v_and_b32 v125, s3, v46
    v_mfma_f32_16x16x32_bf16 v[92:95], a[132:135], a[184:187], v[92:95]
    v_mul_f32 v124, s14, v124
    v_mul_f32 v125, s14, v125
    v_cvt_pk_bf16_f32 v46, v124, v125
    v_mfma_f32_16x16x32_bf16 v[80:83], a[136:139], a[168:171], v[80:83]
    ds_read_b128 a[196:199], v4 offset:704
    v_lshlrev_b32 v124, 16, v46
    v_and_b32 v125, s3, v46
    v_mfma_f32_16x16x32_bf16 v[84:87], a[136:139], a[172:175], v[84:87]
    v_lshlrev_b32 v126, 16, v47
    v_and_b32 v127, s3, v47
    v_mul_f32 v126, s15, v126
    v_mfma_f32_16x16x32_bf16 v[88:91], a[136:139], a[176:179], v[88:91]
    ds_read_b128 a[236:239], v5 offset:1792
    v_mul_f32 v127, s15, v127
    v_cvt_pk_bf16_f32 v47, v126, v127
    v_mfma_f32_16x16x32_bf16 v[92:95], a[136:139], a[180:183], v[92:95]
    ds_read_b128 a[200:203], v4 offset:1216
    s_waitcnt lgkmcnt(8)
    v_lshlrev_b32 v126, 16, v47
    v_mfma_f32_16x16x32_bf16 v[80:83], a[140:143], a[164:167], v[80:83]
    v_and_b32_e64 v127, s3, v47
    buffer_load_dwordx4 v229, s[4:7], s22 offen offset:1024  lds
    v_mfma_f32_16x16x32_bf16 v[84:87], a[140:143], a[168:171], v[84:87]
    ds_read_b128 a[232:235], v5 offset:1280
    buffer_load_dwordx4 v230, s[4:7], s22 offen offset:2048  lds
    v_mfma_f32_16x16x32_bf16 v[88:91], a[140:143], a[172:175], v[88:91]
    ds_read_b128 a[204:207], v4 offset:1728
    s_mov_b32 s22, 0
    s_cmp_eq_u32 s22, s19
    s_cselect_b32 s22, s18, s22
    v_mfma_f32_16x16x32_bf16 v[92:95], a[140:143], a[176:179], v[92:95]
    v_mfma_f32_16x16x32_bf16 v[80:83], a[144:147], a[160:163], v[80:83]
    ds_read_b128 a[228:231], v5 offset:768
    v_mfma_f32_16x16x32_bf16 v[84:87], a[144:147], a[164:167], v[84:87]
    v_mfma_f32_16x16x32_bf16 v[88:91], a[144:147], a[168:171], v[88:91]
    ds_read_b128 a[208:211], v4 offset:2240
    v_mfma_f32_16x16x32_bf16 v[92:95], a[144:147], a[172:175], v[92:95]
    ds_read_b128 a[224:227], v5 offset:256
    v_mfma_f32_16x16x32_bf16 v[84:87], a[148:151], a[160:163], v[84:87]
    v_mfma_f32_16x16x32_bf16 v[88:91], a[148:151], a[164:167], v[88:91]
    ds_read_b128 a[212:215], v4 offset:2752
    v_mfma_f32_16x16x32_bf16 v[92:95], a[148:151], a[168:171], v[92:95]
    ds_read_b128 a[216:219], v4 offset:3264
    v_mfma_f32_16x16x32_bf16 v[88:91], a[152:155], a[160:163], v[88:91]
    v_mfma_f32_16x16x32_bf16 v[92:95], a[152:155], a[164:167], v[92:95]
    ds_read_b128 a[220:223], v4 offset:3776
    v_mfma_f32_16x16x32_bf16 v[92:95], a[156:159], a[160:163], v[92:95]
    s_waitcnt vmcnt(63) lgkmcnt(6)
    v_mfma_f32_16x16x32_bf16 v[80:83], a[192:195], a[240:243], v[80:83]
    ds_read_b128 a[128:131], v4 offset:256
    s_add_u32 s8, s90, 4194304
    s_addc_u32 s9, s91, 0
    v_mfma_f32_16x16x32_bf16 v[84:87], a[192:195], a[244:247], v[84:87]
    s_mov_b32 s10, 14680064
    s_mov_b32 s11, 0x20000
    s_add_u32 s36, s90, 18874368
    s_addc_u32 s37, s91, 0
    v_mfma_f32_16x16x32_bf16 v[88:91], a[192:195], a[248:251], v[88:91]
    ds_read_b128 a[176:179], v5 offset:2240
    s_mov_b32 s38, 32768
    s_mov_b32 s39, 0x20000
    v_mfma_f32_16x16x32_bf16 v[92:95], a[192:195], a[252:255], v[92:95]
    ds_read_b128 a[180:183], v5 offset:2752
    s_add_u32 s40, s90, 19005440
    s_addc_u32 s41, s91, 0
    v_mfma_f32_16x16x32_bf16 v[80:83], a[196:199], a[236:239], v[80:83]
    s_mov_b32 s42, 262144
    s_mov_b32 s43, 0x20000
    s_mov_b32 s12, s84
    s_mov_b32 s13, s85
    v_mfma_f32_16x16x32_bf16 v[84:87], a[196:199], a[240:243], v[84:87]
    ds_read_b128 a[184:187], v5 offset:3264
    s_mov_b32 s14, 7340032
    s_mov_b32 s15, 0x20000
    v_mfma_f32_16x16x32_bf16 v[88:91], a[196:199], a[244:247], v[88:91]
    ds_read_b128 a[188:191], v5 offset:3776
    s_mul_i32 s16, s2, 28672
    s_lshl_b32 s32, s34, 13
    v_mfma_f32_16x16x32_bf16 v[92:95], a[196:199], a[248:251], v[92:95]
    s_lshl_b32 s20, s33, 19
    s_add_u32 s21, s20, 65536
    s_mov_b32 s17, s20
    s_add_u32 s26, s20, 524288
    v_mfma_f32_16x16x32_bf16 v[80:83], a[200:203], a[232:235], v[80:83]
    ds_read_b128 a[132:135], v4 offset:768
    s_mov_b32 s23, 0
    s_mov_b32 s25, 4
    v_mfma_f32_16x16x32_bf16 v[84:87], a[200:203], a[236:239], v[84:87]
    v_add_u32 v16, 129792, v16
    v_mfma_f32_16x16x32_bf16 v[88:91], a[200:203], a[240:243], v[88:91]
    ds_read_b128 a[172:175], v5 offset:1728
    v_mfma_f32_16x16x32_bf16 v[92:95], a[200:203], a[244:247], v[92:95]
    ds_read_b128 a[136:139], v4 offset:1280
    s_waitcnt lgkmcnt(8)
    v_mfma_f32_16x16x32_bf16 v[80:83], a[204:207], a[228:231], v[80:83]
    v_mfma_f32_16x16x32_bf16 v[84:87], a[204:207], a[232:235], v[84:87]
    ds_read_b128 a[168:171], v5 offset:1216
    v_mfma_f32_16x16x32_bf16 v[88:91], a[204:207], a[236:239], v[88:91]
    ds_read_b128 a[140:143], v4 offset:1792
    v_mfma_f32_16x16x32_bf16 v[92:95], a[204:207], a[240:243], v[92:95]
    v_mfma_f32_16x16x32_bf16 v[80:83], a[208:211], a[224:227], v[80:83]
    ds_read_b128 a[164:167], v5 offset:704
    v_mfma_f32_16x16x32_bf16 v[84:87], a[208:211], a[228:231], v[84:87]
    v_mfma_f32_16x16x32_bf16 v[88:91], a[208:211], a[232:235], v[88:91]
    ds_read_b128 a[144:147], v4 offset:2304
    v_mfma_f32_16x16x32_bf16 v[92:95], a[208:211], a[236:239], v[92:95]
    ds_read_b128 a[160:163], v5 offset:192
    v_mfma_f32_16x16x32_bf16 v[84:87], a[212:215], a[224:227], v[84:87]
    v_mfma_f32_16x16x32_bf16 v[88:91], a[212:215], a[228:231], v[88:91]
    ds_read_b128 a[148:151], v4 offset:2816
    v_mfma_f32_16x16x32_bf16 v[92:95], a[212:215], a[232:235], v[92:95]
    ds_read_b128 a[152:155], v4 offset:3328
    v_mfma_f32_16x16x32_bf16 v[88:91], a[216:219], a[224:227], v[88:91]
    v_mfma_f32_16x16x32_bf16 v[92:95], a[216:219], a[228:231], v[92:95]
    ds_read_b128 a[156:159], v4 offset:3840
    v_mfma_f32_16x16x32_bf16 v[92:95], a[220:223], a[224:227], v[92:95]
    s_waitcnt vmcnt(63) lgkmcnt(6)
    v_mfma_f32_16x16x32_bf16 v[80:83], a[128:131], a[176:179], v[80:83]
    ds_read_b128 a[192:195], v4 offset:320
    v_mfma_f32_16x16x32_bf16 v[84:87], a[128:131], a[180:183], v[84:87]
    v_mfma_f32_16x16x32_bf16 v[88:91], a[128:131], a[184:187], v[88:91]
    ds_read_b128 a[240:243], v5 offset:2176
    v_mfma_f32_16x16x32_bf16 v[92:95], a[128:131], a[188:191], v[92:95]
    ds_read_b128 a[244:247], v5 offset:2688
    v_mfma_f32_16x16x32_bf16 v[80:83], a[132:135], a[172:175], v[80:83]
    v_mfma_f32_16x16x32_bf16 v[84:87], a[132:135], a[176:179], v[84:87]
    ds_read_b128 a[248:251], v5 offset:3200
    v_mfma_f32_16x16x32_bf16 v[88:91], a[132:135], a[180:183], v[88:91]
    ds_read_b128 a[252:255], v5 offset:3712
    v_mfma_f32_16x16x32_bf16 v[92:95], a[132:135], a[184:187], v[92:95]
    v_mfma_f32_16x16x32_bf16 v[80:83], a[136:139], a[168:171], v[80:83]
    ds_read_b128 a[196:199], v4 offset:832
    v_mfma_f32_16x16x32_bf16 v[84:87], a[136:139], a[172:175], v[84:87]
    v_mfma_f32_16x16x32_bf16 v[88:91], a[136:139], a[176:179], v[88:91]
    ds_read_b128 a[236:239], v5 offset:1664
    v_mfma_f32_16x16x32_bf16 v[92:95], a[136:139], a[180:183], v[92:95]
    ds_read_b128 a[200:203], v4 offset:1344
    s_waitcnt lgkmcnt(8)
    v_mfma_f32_16x16x32_bf16 v[80:83], a[140:143], a[164:167], v[80:83]
    v_mfma_f32_16x16x32_bf16 v[84:87], a[140:143], a[168:171], v[84:87]
    ds_read_b128 a[232:235], v5 offset:1152
    v_mfma_f32_16x16x32_bf16 v[88:91], a[140:143], a[172:175], v[88:91]
    ds_read_b128 a[204:207], v4 offset:1856
    v_mfma_f32_16x16x32_bf16 v[92:95], a[140:143], a[176:179], v[92:95]
    v_mfma_f32_16x16x32_bf16 v[80:83], a[144:147], a[160:163], v[80:83]
    ds_read_b128 a[228:231], v5 offset:640
    v_mfma_f32_16x16x32_bf16 v[84:87], a[144:147], a[164:167], v[84:87]
    v_mfma_f32_16x16x32_bf16 v[88:91], a[144:147], a[168:171], v[88:91]
    ds_read_b128 a[208:211], v4 offset:2368
    v_mfma_f32_16x16x32_bf16 v[92:95], a[144:147], a[172:175], v[92:95]
    ds_read_b128 a[224:227], v5 offset:128
    v_mfma_f32_16x16x32_bf16 v[84:87], a[148:151], a[160:163], v[84:87]
    v_mfma_f32_16x16x32_bf16 v[88:91], a[148:151], a[164:167], v[88:91]
    ds_read_b128 a[212:215], v4 offset:2880
    v_mfma_f32_16x16x32_bf16 v[92:95], a[148:151], a[168:171], v[92:95]
    ds_read_b128 a[216:219], v4 offset:3392
    v_mfma_f32_16x16x32_bf16 v[88:91], a[152:155], a[160:163], v[88:91]
    v_mfma_f32_16x16x32_bf16 v[92:95], a[152:155], a[164:167], v[92:95]
    ds_read_b128 a[220:223], v4 offset:3904
    v_mfma_f32_16x16x32_bf16 v[92:95], a[156:159], a[160:163], v[92:95]
    s_waitcnt vmcnt(63) lgkmcnt(6)
    v_mfma_f32_16x16x32_bf16 v[80:83], a[192:195], a[240:243], v[80:83]
    ds_read_b128 a[128:131], v4 offset:384
    v_mfma_f32_16x16x32_bf16 v[84:87], a[192:195], a[244:247], v[84:87]
    v_mfma_f32_16x16x32_bf16 v[88:91], a[192:195], a[248:251], v[88:91]
    ds_read_b128 a[176:179], v5 offset:2112
    v_mfma_f32_16x16x32_bf16 v[92:95], a[192:195], a[252:255], v[92:95]
    ds_read_b128 a[180:183], v5 offset:2624
    v_mfma_f32_16x16x32_bf16 v[80:83], a[196:199], a[236:239], v[80:83]
    v_mfma_f32_16x16x32_bf16 v[84:87], a[196:199], a[240:243], v[84:87]
    ds_read_b128 a[184:187], v5 offset:3136
    v_mfma_f32_16x16x32_bf16 v[88:91], a[196:199], a[244:247], v[88:91]
    ds_read_b128 a[188:191], v5 offset:3648
    v_mfma_f32_16x16x32_bf16 v[92:95], a[196:199], a[248:251], v[92:95]
    v_mfma_f32_16x16x32_bf16 v[80:83], a[200:203], a[232:235], v[80:83]
    ds_read_b128 a[132:135], v4 offset:896
    v_mfma_f32_16x16x32_bf16 v[84:87], a[200:203], a[236:239], v[84:87]
    v_mfma_f32_16x16x32_bf16 v[88:91], a[200:203], a[240:243], v[88:91]
    ds_read_b128 a[172:175], v5 offset:1600
    v_mfma_f32_16x16x32_bf16 v[92:95], a[200:203], a[244:247], v[92:95]
    ds_read_b128 a[136:139], v4 offset:1408
    s_waitcnt lgkmcnt(8)
    v_mfma_f32_16x16x32_bf16 v[80:83], a[204:207], a[228:231], v[80:83]
    v_mfma_f32_16x16x32_bf16 v[84:87], a[204:207], a[232:235], v[84:87]
    ds_read_b128 a[168:171], v5 offset:1088
    v_mfma_f32_16x16x32_bf16 v[88:91], a[204:207], a[236:239], v[88:91]
    ds_read_b128 a[140:143], v4 offset:1920
    v_mfma_f32_16x16x32_bf16 v[92:95], a[204:207], a[240:243], v[92:95]
    v_mfma_f32_16x16x32_bf16 v[80:83], a[208:211], a[224:227], v[80:83]
    ds_read_b128 a[164:167], v5 offset:576
    v_mfma_f32_16x16x32_bf16 v[84:87], a[208:211], a[228:231], v[84:87]
    v_mfma_f32_16x16x32_bf16 v[88:91], a[208:211], a[232:235], v[88:91]
    ds_read_b128 a[144:147], v4 offset:2432
    v_mfma_f32_16x16x32_bf16 v[92:95], a[208:211], a[236:239], v[92:95]
    ds_read_b128 a[160:163], v5 offset:64
    v_mfma_f32_16x16x32_bf16 v[84:87], a[212:215], a[224:227], v[84:87]
    v_mfma_f32_16x16x32_bf16 v[88:91], a[212:215], a[228:231], v[88:91]
    ds_read_b128 a[148:151], v4 offset:2944
    v_mfma_f32_16x16x32_bf16 v[92:95], a[212:215], a[232:235], v[92:95]
    ds_read_b128 a[152:155], v4 offset:3456
    v_mfma_f32_16x16x32_bf16 v[88:91], a[216:219], a[224:227], v[88:91]
    v_mfma_f32_16x16x32_bf16 v[92:95], a[216:219], a[228:231], v[92:95]
    ds_read_b128 a[156:159], v4 offset:3968
    v_mfma_f32_16x16x32_bf16 v[92:95], a[220:223], a[224:227], v[92:95]
    s_waitcnt vmcnt(63) lgkmcnt(6)
    v_mfma_f32_16x16x32_bf16 v[80:83], a[128:131], a[176:179], v[80:83]
    ds_read_b128 a[192:195], v4 offset:448
    s_mov_b32 s49, 16384
    v_mfma_f32_16x16x32_bf16 v[84:87], a[128:131], a[180:183], v[84:87]
    ds_read_b128 a[240:243], v5 offset:2048
    v_mfma_f32_16x16x32_bf16 v[88:91], a[128:131], a[184:187], v[88:91]
    ds_read_b128 a[196:199], v4 offset:960
    v_mfma_f32_16x16x32_bf16 v[92:95], a[128:131], a[188:191], v[92:95]
    ds_read_b128 a[236:239], v5 offset:1536
    v_mfma_f32_16x16x32_bf16 v[80:83], a[132:135], a[172:175], v[80:83]
    buffer_load_dwordx2 v[22:23], v29, s[60:63], s49 offen sc1
    v_mfma_f32_16x16x32_bf16 v[84:87], a[132:135], a[176:179], v[84:87]
    ds_read_b128 a[200:203], v4 offset:1472
    v_mfma_f32_16x16x32_bf16 v[88:91], a[132:135], a[180:183], v[88:91]
    ds_read_b128 a[232:235], v5 offset:1024
    v_mfma_f32_16x16x32_bf16 v[92:95], a[132:135], a[184:187], v[92:95]
    ds_read_b128 a[204:207], v4 offset:1984
    v_mfma_f32_16x16x32_bf16 v[80:83], a[136:139], a[168:171], v[80:83]
    v_mfma_f32_16x16x32_bf16 v[84:87], a[136:139], a[172:175], v[84:87]
    ds_read_b128 a[228:231], v5 offset:512
    v_mfma_f32_16x16x32_bf16 v[88:91], a[136:139], a[176:179], v[88:91]
    ds_read_b128 a[208:211], v4 offset:2496
    v_mfma_f32_16x16x32_bf16 v[92:95], a[136:139], a[180:183], v[92:95]
    ds_read_b128 a[224:227], v5 offset:0
    s_waitcnt lgkmcnt(10)
    v_mfma_f32_16x16x32_bf16 v[80:83], a[140:143], a[164:167], v[80:83]
    v_mfma_f32_16x16x32_bf16 v[84:87], a[140:143], a[168:171], v[84:87]
    ds_read_b128 a[244:247], v5 offset:2560
    v_mfma_f32_16x16x32_bf16 v[88:91], a[140:143], a[172:175], v[88:91]
    ds_read_b128 a[212:215], v4 offset:3008
    v_mfma_f32_16x16x32_bf16 v[92:95], a[140:143], a[176:179], v[92:95]
    ds_read_b128 a[248:251], v5 offset:3072
    v_mfma_f32_16x16x32_bf16 v[80:83], a[144:147], a[160:163], v[80:83]
    v_mfma_f32_16x16x32_bf16 v[84:87], a[144:147], a[164:167], v[84:87]
    ds_read_b128 a[216:219], v4 offset:3520
    v_mfma_f32_16x16x32_bf16 v[88:91], a[144:147], a[168:171], v[88:91]
    ds_read_b128 a[252:255], v5 offset:3584
    v_mfma_f32_16x16x32_bf16 v[92:95], a[144:147], a[172:175], v[92:95]
    ds_read_b128 a[220:223], v4 offset:4032
    v_mfma_f32_16x16x32_bf16 v[84:87], a[148:151], a[160:163], v[84:87]
    v_mfma_f32_16x16x32_bf16 v[88:91], a[148:151], a[164:167], v[88:91]
    v_mfma_f32_16x16x32_bf16 v[92:95], a[148:151], a[168:171], v[92:95]
    v_mfma_f32_16x16x32_bf16 v[88:91], a[152:155], a[160:163], v[88:91]
    v_mfma_f32_16x16x32_bf16 v[92:95], a[152:155], a[164:167], v[92:95]
    v_mfma_f32_16x16x32_bf16 v[92:95], a[156:159], a[160:163], v[92:95]
    s_waitcnt vmcnt(0) lgkmcnt(0)
    v_cmp_ne_u64_e64 vcc, s[92:93], v[22:23]
    s_cbranch_vccz L_mk_feok_11
    s_mov_b32 s96, 0
L_mk_poll_12:
    buffer_load_dwordx2 v[22:23], v29, s[60:63], s49 offen sc1
    s_waitcnt vmcnt(0)
    v_cmp_ne_u64_e64 vcc, s[92:93], v[22:23]
    s_cbranch_vccz L_mk_pdone_13
    s_mov_b64 exec, vcc
    s_add_u32 s96, s96, 1
    s_cmp_lt_u32 s96, 400000
    s_cbranch_scc1 L_mk_poll_12
L_mk_pdone_13:
    s_mov_b64 exec, -1
L_mk_feok_11:
    s_barrier
    v_mfma_f32_16x16x32_bf16 v[80:83], a[192:195], a[240:243], v[80:83]
    buffer_load_dwordx2 a[0:1], v231, s[44:47], s20 offen offset:0 sc1
    v_mfma_f32_16x16x32_bf16 v[80:83], a[196:199], a[236:239], v[80:83]
    buffer_load_dwordx2 a[2:3], v231, s[44:47], s21 offen offset:0 sc1
    v_mfma_f32_16x16x32_bf16 v[80:83], a[200:203], a[232:235], v[80:83]
    buffer_load_dwordx2 a[4:5], v231, s[44:47], s20 offen offset:128 sc1
    v_mfma_f32_16x16x32_bf16 v[80:83], a[204:207], a[228:231], v[80:83]
    buffer_load_dwordx2 a[6:7], v231, s[44:47], s21 offen offset:128 sc1
    v_mfma_f32_16x16x32_bf16 v[80:83], a[208:211], a[224:227], v[80:83]
    s_add_u32 s20, s20, 131072
    s_add_u32 s21, s20, 65536
    v_mfma_f32_16x16x32_bf16 v[84:87], a[192:195], a[244:247], v[84:87]
    buffer_load_dwordx2 a[8:9], v231, s[44:47], s20 offen offset:0 sc1
    v_mfma_f32_16x16x32_bf16 v[84:87], a[196:199], a[240:243], v[84:87]
    buffer_load_dwordx2 a[10:11], v231, s[44:47], s21 offen offset:0 sc1
    v_mfma_f32_16x16x32_bf16 v[84:87], a[200:203], a[236:239], v[84:87]
    buffer_load_dwordx2 a[12:13], v231, s[44:47], s20 offen offset:128 sc1
    v_mfma_f32_16x16x32_bf16 v[84:87], a[204:207], a[232:235], v[84:87]
    buffer_load_dwordx2 a[14:15], v231, s[44:47], s21 offen offset:128 sc1
    v_mfma_f32_16x16x32_bf16 v[84:87], a[208:211], a[228:231], v[84:87]
    s_add_u32 s20, s20, 131072
    s_add_u32 s21, s20, 65536
    v_mfma_f32_16x16x32_bf16 v[84:87], a[212:215], a[224:227], v[84:87]
    v_mfma_f32_16x16x32_bf16 v[88:91], a[192:195], a[248:251], v[88:91]
    v_mfma_f32_16x16x32_bf16 v[88:91], a[196:199], a[244:247], v[88:91]
    v_cvt_pk_bf16_f32 v168, v80, v81
    v_mfma_f32_16x16x32_bf16 v[88:91], a[200:203], a[240:243], v[88:91]
    v_cvt_pk_bf16_f32 v169, v82, v83
    v_mfma_f32_16x16x32_bf16 v[88:91], a[204:207], a[236:239], v[88:91]
    ds_write2_b32 v7, v168, v169 offset0:0 offset1:4
    v_mfma_f32_16x16x32_bf16 v[88:91], a[208:211], a[232:235], v[88:91]
    v_mfma_f32_16x16x32_bf16 v[88:91], a[212:215], a[228:231], v[88:91]
    v_mfma_f32_16x16x32_bf16 v[88:91], a[216:219], a[224:227], v[88:91]
    v_mfma_f32_16x16x32_bf16 v[92:95], a[192:195], a[252:255], v[92:95]
    v_cvt_pk_bf16_f32 v170, v84, v85
    v_mfma_f32_16x16x32_bf16 v[92:95], a[196:199], a[248:251], v[92:95]
    v_cvt_pk_bf16_f32 v171, v86, v87
    v_mfma_f32_16x16x32_bf16 v[92:95], a[200:203], a[244:247], v[92:95]
    ds_write2_b32 v7, v170, v171 offset0:128 offset1:132
    v_mfma_f32_16x16x32_bf16 v[92:95], a[204:207], a[240:243], v[92:95]
    v_add_u32 v7, 1024, v7
    v_mfma_f32_16x16x32_bf16 v[92:95], a[208:211], a[236:239], v[92:95]
    v_mfma_f32_16x16x32_bf16 v[92:95], a[212:215], a[232:235], v[92:95]
    v_mfma_f32_16x16x32_bf16 v[92:95], a[216:219], a[228:231], v[92:95]
    v_mfma_f32_16x16x32_bf16 v[92:95], a[220:223], a[224:227], v[92:95]
    v_cvt_pk_bf16_f32 v172, v88, v89
    v_cvt_pk_bf16_f32 v173, v90, v91
    ds_write2_b32 v7, v172, v173 offset0:0 offset1:4
    s_nop 4
    v_cvt_pk_bf16_f32 v174, v92, v93
    v_cvt_pk_bf16_f32 v175, v94, v95
    ds_write2_b32 v7, v174, v175 offset0:128 offset1:132
    s_waitcnt vmcnt(9) lgkmcnt(0)
    s_barrier
    ds_read2st64_b32 v[56:57], v16 offset0:0 offset1:33
    ds_read2st64_b32 v[58:59], v16 offset0:66 offset1:99
    ds_read2st64_b32 v[60:61], v16 offset0:4 offset1:37
    ds_read2st64_b32 v[62:63], v16 offset0:70 offset1:103
    s_add_u32 m0, s24, 57600
    s_nop 0
    s_nop 0
    buffer_load_dwordx4 v224, s[4:7], s22 offen offset:0  lds
    ds_read_b64_tr_b16 a[64:65], v233 offset:0
    ds_read_b64_tr_b16 a[66:67], v233 offset:3584
    ds_read_b64_tr_b16 a[68:69], v233 offset:32
    ds_read_b64_tr_b16 a[70:71], v233 offset:3616
    ds_read_b64_tr_b16 a[72:73], v233 offset:64
    ds_read_b64_tr_b16 a[74:75], v233 offset:3648
    ds_read_b64_tr_b16 a[76:77], v233 offset:96
    ds_read_b64_tr_b16 a[78:79], v233 offset:3680
    ds_read_b64_tr_b16 a[80:81], v233 offset:128
    ds_read_b64_tr_b16 a[82:83], v233 offset:3712
    ds_read_b64_tr_b16 a[84:85], v233 offset:160
    ds_read_b64_tr_b16 a[86:87], v233 offset:3744
    buffer_load_dwordx4 v225, s[4:7], s22 offen offset:1024  lds
    s_waitcnt lgkmcnt(12)
    v_lshlrev_b32 v160, 16, v56
    v_and_b32 v161, s3, v56
    v_lshlrev_b32 v162, 16, v57
    v_and_b32 v163, s3, v57
    v_lshlrev_b32 v164, 16, v58
    v_and_b32 v165, s3, v58
    v_lshlrev_b32 v166, 16, v59
    v_and_b32_e64 v167, s3, v59
    v_pk_add_f32 v[112:113], v[112:113], v[160:161]
    v_pk_add_f32 v[114:115], v[114:115], v[162:163]
    v_pk_add_f32 v[116:117], v[116:117], v[164:165]
    v_pk_add_f32 v[118:119], v[118:119], v[166:167]
    buffer_load_dwordx4 v226, s[4:7], s22 offen offset:2048  lds
    v_cvt_pk_bf16_f32 v160, v112, v113
    v_cvt_pk_bf16_f32 v161, v114, v115
    v_cvt_pk_bf16_f32 v162, v116, v117
    v_cvt_pk_bf16_f32 v163, v118, v119
    v_lshlrev_b32 v112, 16, v160
    v_and_b32 v113, s3, v160
    v_lshlrev_b32 v114, 16, v161
    v_and_b32 v115, s3, v161
    v_lshlrev_b32 v116, 16, v162
    v_and_b32 v117, s3, v162
    v_lshlrev_b32 v118, 16, v163
    v_and_b32 v119, s3, v163
    buffer_load_dwordx4 v227, s[4:7], s22 offen offset:3072  lds
    v_pk_add_f32 v[112:113], v[112:113], v[144:145]
    v_pk_add_f32 v[114:115], v[114:115], v[146:147]
    v_pk_add_f32 v[116:117], v[116:117], v[148:149]
    v_pk_add_f32 v[118:119], v[118:119], v[150:151]
    v_cvt_pk_bf16_f32 v56, v112, v114
    v_cvt_pk_bf16_f32 v57, v116, v118
    v_cvt_pk_bf16_f32 v58, v113, v115
    v_cvt_pk_bf16_f32 v59, v117, v119
    s_add_u32 s48, s55, 256
    buffer_store_dwordx4 v[56:59], v18, s[44:47], s48 offen sc1
    v_lshlrev_b32 v160, 16, v60
    v_and_b32 v161, s3, v60
    s_add_u32 m0, s24, 61696
    s_nop 0
    buffer_load_dwordx4 v228, s[4:7], s22 offen offset:0  lds
    v_lshlrev_b32 v162, 16, v61
    v_and_b32 v163, s3, v61
    v_lshlrev_b32 v164, 16, v62
    v_and_b32 v165, s3, v62
    v_lshlrev_b32 v166, 16, v63
    v_and_b32_e64 v167, s3, v63
    v_pk_add_f32 v[120:121], v[120:121], v[160:161]
    v_pk_add_f32 v[122:123], v[122:123], v[162:163]
    v_pk_add_f32 v[124:125], v[124:125], v[164:165]
    v_pk_add_f32 v[126:127], v[126:127], v[166:167]
    v_cvt_pk_bf16_f32 v160, v120, v121
    v_cvt_pk_bf16_f32 v161, v122, v123
    buffer_load_dwordx4 v229, s[4:7], s22 offen offset:1024  lds
    v_cvt_pk_bf16_f32 v162, v124, v125
    v_cvt_pk_bf16_f32 v163, v126, v127
    v_lshlrev_b32 v120, 16, v160
    v_and_b32 v121, s3, v160
    v_lshlrev_b32 v122, 16, v161
    v_and_b32 v123, s3, v161
    v_lshlrev_b32 v124, 16, v162
    v_and_b32 v125, s3, v162
    v_lshlrev_b32 v126, 16, v163
    v_and_b32 v127, s3, v163
    v_pk_add_f32 v[120:121], v[120:121], v[152:153]
    v_pk_add_f32 v[122:123], v[122:123], v[154:155]
    buffer_load_dwordx4 v230, s[4:7], s22 offen offset:2048  lds
    s_add_u32 s22, s22, 458752
    v_pk_add_f32 v[124:125], v[124:125], v[156:157]
    v_pk_add_f32 v[126:127], v[126:127], v[158:159]
    v_cvt_pk_bf16_f32 v60, v120, v122
    v_cvt_pk_bf16_f32 v61, v124, v126
    v_cvt_pk_bf16_f32 v62, v121, v123
    v_cvt_pk_bf16_f32 v63, v125, v127
    s_add_u32 s48, s55, 8448
    buffer_store_dwordx4 v[60:63], v18, s[44:47], s48 offen sc1
    ds_read_b64_tr_b16 a[88:89], v233 offset:192
    ds_read_b64_tr_b16 a[90:91], v233 offset:3776
    ds_read_b64_tr_b16 a[92:93], v233 offset:14464
    ds_read_b64_tr_b16 a[94:95], v233 offset:18048
    ds_read_b64_tr_b16 a[96:97], v233 offset:14496
    ds_read_b64_tr_b16 a[98:99], v233 offset:18080
    ds_read_b64_tr_b16 a[100:101], v233 offset:14528
    ds_read_b64_tr_b16 a[102:103], v233 offset:18112
    ds_read_b64_tr_b16 a[104:105], v233 offset:14560
    ds_read_b64_tr_b16 a[106:107], v233 offset:18144
    ds_read_b64_tr_b16 a[108:109], v233 offset:14592
    ds_read_b64_tr_b16 a[110:111], v233 offset:18176
    ds_read_b64_tr_b16 a[112:113], v233 offset:14624
    ds_read_b64_tr_b16 a[114:115], v233 offset:18208
    ds_read_b64_tr_b16 a[116:117], v233 offset:14656
    ds_read_b64_tr_b16 a[118:119], v233 offset:18240
    v_mov_b32 v1, v224
    v_mov_b32 v2, v225
    v_mov_b32 v3, v226
    v_mov_b32 v4, v227
    v_mov_b32 v5, v228
    v_mov_b32 v6, v229
    v_mov_b32 v7, v230
    v_mov_b32 v8, v231
    v_mov_b32 v9, v232
    v_mov_b32 v10, v233
    v_mov_b32 v28, v234
    v_mov_b32 v16, v235
    v_add_u32 v11, 57600, v10
    v_mov_b32 v12, 0x3f803f80
    v_mov_b32 v13, 0x3f803f80
    v_mov_b32 v14, 0x3f803f80
    v_mov_b32 v15, 0x3f803f80
    s_waitcnt vmcnt(13) lgkmcnt(0)
    v_mfma_f32_16x16x32_bf16 v[32:35], a[64:67], a[0:3], 0
    ds_read_b64_tr_b16 a[120:121], v10 offset:7168
    v_mfma_f32_16x16x32_bf16 v[40:43], a[64:67], a[4:7], 0
    ds_read_b64_tr_b16 a[122:123], v10 offset:10752
    v_mfma_f32_16x16x32_bf16 v[72:75], a[68:71], a[4:7], 0
    ds_read_b64_tr_b16 a[124:125], v10 offset:7200
    buffer_load_dwordx2 a[16:17], v8, s[44:47], s20 offen offset:0 sc1
    v_mfma_f32_16x16x32_bf16 v[64:67], a[68:71], a[0:3], 0
    ds_read_b64_tr_b16 a[126:127], v10 offset:10784
    v_mfma_f32_16x16x32_bf16 v[96:99], a[72:75], a[0:3], 0
    ds_read_b64_tr_b16 a[128:129], v10 offset:7232
    v_mfma_f32_16x16x32_bf16 v[104:107], a[72:75], a[4:7], 0
    ds_read_b64_tr_b16 a[130:131], v10 offset:10816
    buffer_load_dwordx2 a[18:19], v8, s[44:47], s21 offen offset:0 sc1
    v_mfma_f32_16x16x32_bf16 v[136:139], a[76:79], a[4:7], 0
    ds_read_b64_tr_b16 a[132:133], v10 offset:7264
    v_mfma_f32_16x16x32_bf16 v[128:131], a[76:79], a[0:3], 0
    ds_read_b64_tr_b16 a[134:135], v10 offset:10848
    v_mfma_f32_16x16x32_bf16 v[160:163], a[80:83], a[0:3], 0
    ds_read_b64_tr_b16 a[136:137], v10 offset:7296
    buffer_load_dwordx2 a[20:21], v8, s[44:47], s20 offen offset:128 sc1
    v_mfma_f32_16x16x32_bf16 v[168:171], a[80:83], a[4:7], 0
    ds_read_b64_tr_b16 a[138:139], v10 offset:10880
    v_mfma_f32_16x16x32_bf16 v[200:203], a[84:87], a[4:7], 0
    ds_read_b64_tr_b16 a[140:141], v10 offset:7328
    v_mfma_f32_16x16x32_bf16 v[192:195], a[84:87], a[0:3], 0
    ds_read_b64_tr_b16 a[142:143], v10 offset:10912
    buffer_load_dwordx2 a[22:23], v8, s[44:47], s21 offen offset:128 sc1
    v_mfma_f32_16x16x32_bf16 v[224:227], a[88:91], a[0:3], 0
    ds_read_b64_tr_b16 a[144:145], v10 offset:7360
    s_add_u32 s20, s20, 131072
    s_add_u32 s21, s20, 65536
    v_mfma_f32_16x16x32_bf16 v[232:235], a[88:91], a[4:7], 0
    ds_read_b64_tr_b16 a[146:147], v10 offset:10944
    s_add_u32 m0, s24, 86400
    v_mfma_f32_16x16x32_bf16 v[44:47], a[92:95], a[4:7], 0
    ds_read_b64_tr_b16 a[148:149], v10 offset:21632
    buffer_load_dwordx4 v1, s[4:7], s22 offen offset:0  lds
    v_mfma_f32_16x16x32_bf16 v[36:39], a[92:95], a[0:3], 0
    ds_read_b64_tr_b16 a[150:151], v10 offset:25216
    v_mfma_f32_16x16x32_bf16 v[68:71], a[96:99], a[0:3], 0
    ds_read_b64_tr_b16 a[152:153], v10 offset:21664
    v_mfma_f32_16x16x32_bf16 v[76:79], a[96:99], a[4:7], 0
    ds_read_b64_tr_b16 a[154:155], v10 offset:25248
    buffer_load_dwordx4 v2, s[4:7], s22 offen offset:1024  lds
    v_mfma_f32_16x16x32_bf16 v[108:111], a[100:103], a[4:7], 0
    ds_read_b64_tr_b16 a[156:157], v10 offset:21696
    v_mfma_f32_16x16x32_bf16 v[100:103], a[100:103], a[0:3], 0
    ds_read_b64_tr_b16 a[158:159], v10 offset:25280
    v_mfma_f32_16x16x32_bf16 v[132:135], a[104:107], a[0:3], 0
    ds_read_b64_tr_b16 a[160:161], v10 offset:21728
    buffer_load_dwordx4 v3, s[4:7], s22 offen offset:2048  lds
    v_mfma_f32_16x16x32_bf16 v[140:143], a[104:107], a[4:7], 0
    ds_read_b64_tr_b16 a[162:163], v10 offset:25312
    v_mfma_f32_16x16x32_bf16 v[172:175], a[108:111], a[4:7], 0
    ds_read_b64_tr_b16 a[164:165], v10 offset:21760
    v_mfma_f32_16x16x32_bf16 v[164:167], a[108:111], a[0:3], 0
    ds_read_b64_tr_b16 a[166:167], v10 offset:25344
    v_mfma_f32_16x16x32_bf16 v[196:199], a[112:115], a[0:3], 0
    ds_read_b64_tr_b16 a[168:169], v10 offset:21792
    v_mfma_f32_16x16x32_bf16 v[204:207], a[112:115], a[4:7], 0
    ds_read_b64_tr_b16 a[170:171], v10 offset:25376
    v_mfma_f32_16x16x32_bf16 v[236:239], a[116:119], a[4:7], 0
    ds_read_b64_tr_b16 a[172:173], v10 offset:21824
    v_mfma_f32_16x16x32_bf16 v[228:231], a[116:119], a[0:3], 0
    ds_read_b64_tr_b16 a[174:175], v10 offset:25408
    s_cmp_lg_u32 s94, 0
    s_cbranch_scc1 L_mk_ncs_15
    v_mfma_f32_16x16x32_bf16 v[48:51], v[12:15], a[64:67], 0
    v_mfma_f32_16x16x32_bf16 v[80:83], v[12:15], a[68:71], 0
    v_mfma_f32_16x16x32_bf16 v[112:115], v[12:15], a[72:75], 0
    v_mfma_f32_16x16x32_bf16 v[144:147], v[12:15], a[76:79], 0
    v_mfma_f32_16x16x32_bf16 v[176:179], v[12:15], a[80:83], 0
    v_mfma_f32_16x16x32_bf16 v[208:211], v[12:15], a[84:87], 0
    v_mfma_f32_16x16x32_bf16 v[240:243], v[12:15], a[88:91], 0
    v_mfma_f32_16x16x32_bf16 v[52:55], v[12:15], a[92:95], 0
    v_mfma_f32_16x16x32_bf16 v[84:87], v[12:15], a[96:99], 0
    v_mfma_f32_16x16x32_bf16 v[116:119], v[12:15], a[100:103], 0
    v_mfma_f32_16x16x32_bf16 v[148:151], v[12:15], a[104:107], 0
    v_mfma_f32_16x16x32_bf16 v[180:183], v[12:15], a[108:111], 0
    v_mfma_f32_16x16x32_bf16 v[212:215], v[12:15], a[112:115], 0
    v_mfma_f32_16x16x32_bf16 v[244:247], v[12:15], a[116:119], 0
L_mk_ncs_15:
    s_waitcnt vmcnt(7) lgkmcnt(12)
    s_barrier
    s_cmp_lg_u32 s94, 0
    s_cbranch_scc1 L_mk_fl_16
    s_lshl_b32 s48, s2, 6
    s_add_u32 s48, s48, 16400
    v_mov_b32 v22, s92
    v_mov_b32 v23, s93
    v_mov_b32 v24, 0
    s_mov_b64 exec, 1
    buffer_store_dwordx2 v[22:23], v24, s[60:63], s48 offen sc1
    s_mov_b64 exec, -1
L_mk_fl_16:
    v_mfma_f32_16x16x32_bf16 v[32:35], a[120:123], a[8:11], v[32:35]
    ds_read_b64_tr_b16 a[64:65], v10 offset:28800
    v_mfma_f32_16x16x32_bf16 v[40:43], a[120:123], a[12:15], v[40:43]
    ds_read_b64_tr_b16 a[66:67], v10 offset:32384
    v_mfma_f32_16x16x32_bf16 v[72:75], a[124:127], a[12:15], v[72:75]
    ds_read_b64_tr_b16 a[68:69], v10 offset:28832
    buffer_load_dwordx2 a[24:25], v8, s[44:47], s20 offen offset:0 sc1
    v_mfma_f32_16x16x32_bf16 v[64:67], a[124:127], a[8:11], v[64:67]
    ds_read_b64_tr_b16 a[70:71], v10 offset:32416
    v_mfma_f32_16x16x32_bf16 v[96:99], a[128:131], a[8:11], v[96:99]
    ds_read_b64_tr_b16 a[72:73], v10 offset:28864
    v_mfma_f32_16x16x32_bf16 v[104:107], a[128:131], a[12:15], v[104:107]
    ds_read_b64_tr_b16 a[74:75], v10 offset:32448
    buffer_load_dwordx2 a[26:27], v8, s[44:47], s21 offen offset:0 sc1
    v_mfma_f32_16x16x32_bf16 v[136:139], a[132:135], a[12:15], v[136:139]
    ds_read_b64_tr_b16 a[76:77], v10 offset:28896
    v_mfma_f32_16x16x32_bf16 v[128:131], a[132:135], a[8:11], v[128:131]
    ds_read_b64_tr_b16 a[78:79], v10 offset:32480
    s_waitcnt lgkmcnt(8)
    v_mfma_f32_16x16x32_bf16 v[160:163], a[136:139], a[8:11], v[160:163]
    ds_read_b64_tr_b16 a[80:81], v10 offset:28928
    buffer_load_dwordx2 a[28:29], v8, s[44:47], s20 offen offset:128 sc1
    v_mfma_f32_16x16x32_bf16 v[168:171], a[136:139], a[12:15], v[168:171]
    ds_read_b64_tr_b16 a[82:83], v10 offset:32512
    v_mfma_f32_16x16x32_bf16 v[200:203], a[140:143], a[12:15], v[200:203]
    ds_read_b64_tr_b16 a[84:85], v10 offset:28960
    v_mfma_f32_16x16x32_bf16 v[192:195], a[140:143], a[8:11], v[192:195]
    ds_read_b64_tr_b16 a[86:87], v10 offset:32544
    buffer_load_dwordx2 a[30:31], v8, s[44:47], s21 offen offset:128 sc1
    v_mfma_f32_16x16x32_bf16 v[224:227], a[144:147], a[8:11], v[224:227]
    ds_read_b64_tr_b16 a[88:89], v10 offset:28992
    s_cmp_eq_u32 s17, 0
    s_cselect_b32 s20, s26, 0
    s_add_u32 s21, s20, 65536
    v_mfma_f32_16x16x32_bf16 v[232:235], a[144:147], a[12:15], v[232:235]
    ds_read_b64_tr_b16 a[90:91], v10 offset:32576
    v_mfma_f32_16x16x32_bf16 v[44:47], a[148:151], a[12:15], v[44:47]
    ds_read_b64_tr_b16 a[92:93], v10 offset:43264
    buffer_load_dwordx4 v4, s[4:7], s22 offen offset:3072  lds
    v_mfma_f32_16x16x32_bf16 v[36:39], a[148:151], a[8:11], v[36:39]
    ds_read_b64_tr_b16 a[94:95], v10 offset:46848
    v_mfma_f32_16x16x32_bf16 v[68:71], a[152:155], a[8:11], v[68:71]
    ds_read_b64_tr_b16 a[96:97], v10 offset:43296
    s_add_u32 m0, s24, 90496
    v_mfma_f32_16x16x32_bf16 v[76:79], a[152:155], a[12:15], v[76:79]
    ds_read_b64_tr_b16 a[98:99], v10 offset:46880
    buffer_load_dwordx4 v5, s[4:7], s22 offen offset:0  lds
    v_mfma_f32_16x16x32_bf16 v[108:111], a[156:159], a[12:15], v[108:111]
    ds_read_b64_tr_b16 a[100:101], v10 offset:43328
    v_mfma_f32_16x16x32_bf16 v[100:103], a[156:159], a[8:11], v[100:103]
    ds_read_b64_tr_b16 a[102:103], v10 offset:46912
    v_mfma_f32_16x16x32_bf16 v[132:135], a[160:163], a[8:11], v[132:135]
    ds_read_b64_tr_b16 a[104:105], v10 offset:43360
    buffer_load_dwordx4 v6, s[4:7], s22 offen offset:1024  lds
    v_mfma_f32_16x16x32_bf16 v[140:143], a[160:163], a[12:15], v[140:143]
    ds_read_b64_tr_b16 a[106:107], v10 offset:46944
    v_mfma_f32_16x16x32_bf16 v[172:175], a[164:167], a[12:15], v[172:175]
    ds_read_b64_tr_b16 a[108:109], v10 offset:43392
    v_mfma_f32_16x16x32_bf16 v[164:167], a[164:167], a[8:11], v[164:167]
    ds_read_b64_tr_b16 a[110:111], v10 offset:46976
    v_mfma_f32_16x16x32_bf16 v[196:199], a[168:171], a[8:11], v[196:199]
    ds_read_b64_tr_b16 a[112:113], v10 offset:43424
    v_mfma_f32_16x16x32_bf16 v[204:207], a[168:171], a[12:15], v[204:207]
    ds_read_b64_tr_b16 a[114:115], v10 offset:47008
    v_mfma_f32_16x16x32_bf16 v[236:239], a[172:175], a[12:15], v[236:239]
    ds_read_b64_tr_b16 a[116:117], v10 offset:43456
    v_mfma_f32_16x16x32_bf16 v[228:231], a[172:175], a[8:11], v[228:231]
    ds_read_b64_tr_b16 a[118:119], v10 offset:47040
    s_cmp_lg_u32 s94, 1
    s_cbranch_scc1 L_mk_ncs_17
    v_mfma_f32_16x16x32_bf16 v[48:51], v[12:15], a[120:123], 0
    v_mfma_f32_16x16x32_bf16 v[80:83], v[12:15], a[124:127], 0
    v_mfma_f32_16x16x32_bf16 v[112:115], v[12:15], a[128:131], 0
    v_mfma_f32_16x16x32_bf16 v[144:147], v[12:15], a[132:135], 0
    v_mfma_f32_16x16x32_bf16 v[176:179], v[12:15], a[136:139], 0
    v_mfma_f32_16x16x32_bf16 v[208:211], v[12:15], a[140:143], 0
    v_mfma_f32_16x16x32_bf16 v[240:243], v[12:15], a[144:147], 0
    v_mfma_f32_16x16x32_bf16 v[52:55], v[12:15], a[148:151], 0
    v_mfma_f32_16x16x32_bf16 v[84:87], v[12:15], a[152:155], 0
    v_mfma_f32_16x16x32_bf16 v[116:119], v[12:15], a[156:159], 0
    v_mfma_f32_16x16x32_bf16 v[148:151], v[12:15], a[160:163], 0
    v_mfma_f32_16x16x32_bf16 v[180:183], v[12:15], a[164:167], 0
    v_mfma_f32_16x16x32_bf16 v[212:215], v[12:15], a[168:171], 0
    v_mfma_f32_16x16x32_bf16 v[244:247], v[12:15], a[172:175], 0
L_mk_ncs_17:
    s_waitcnt vmcnt(10) lgkmcnt(12)
    v_mfma_f32_16x16x32_bf16 v[32:35], a[64:67], a[16:19], v[32:35]
    ds_read_b64_tr_b16 a[120:121], v10 offset:35968
    v_mfma_f32_16x16x32_bf16 v[40:43], a[64:67], a[20:23], v[40:43]
    ds_read_b64_tr_b16 a[122:123], v10 offset:39552
    v_mfma_f32_16x16x32_bf16 v[72:75], a[68:71], a[20:23], v[72:75]
    ds_read_b64_tr_b16 a[124:125], v10 offset:36000
    buffer_load_dwordx2 a[32:33], v8, s[44:47], s20 offen offset:0 sc1
    v_mfma_f32_16x16x32_bf16 v[64:67], a[68:71], a[16:19], v[64:67]
    ds_read_b64_tr_b16 a[126:127], v10 offset:39584
    v_mfma_f32_16x16x32_bf16 v[96:99], a[72:75], a[16:19], v[96:99]
    ds_read_b64_tr_b16 a[128:129], v10 offset:36032
    v_mfma_f32_16x16x32_bf16 v[104:107], a[72:75], a[20:23], v[104:107]
    ds_read_b64_tr_b16 a[130:131], v10 offset:39616
    buffer_load_dwordx2 a[34:35], v8, s[44:47], s21 offen offset:0 sc1
    v_mfma_f32_16x16x32_bf16 v[136:139], a[76:79], a[20:23], v[136:139]
    ds_read_b64_tr_b16 a[132:133], v10 offset:36064
    v_mfma_f32_16x16x32_bf16 v[128:131], a[76:79], a[16:19], v[128:131]
    ds_read_b64_tr_b16 a[134:135], v10 offset:39648
    s_waitcnt lgkmcnt(8)
    v_mfma_f32_16x16x32_bf16 v[160:163], a[80:83], a[16:19], v[160:163]
    ds_read_b64_tr_b16 a[136:137], v10 offset:36096
    buffer_load_dwordx2 a[36:37], v8, s[44:47], s20 offen offset:128 sc1
    v_mfma_f32_16x16x32_bf16 v[168:171], a[80:83], a[20:23], v[168:171]
    ds_read_b64_tr_b16 a[138:139], v10 offset:39680
    v_mfma_f32_16x16x32_bf16 v[200:203], a[84:87], a[20:23], v[200:203]
    ds_read_b64_tr_b16 a[140:141], v10 offset:36128
    v_mfma_f32_16x16x32_bf16 v[192:195], a[84:87], a[16:19], v[192:195]
    ds_read_b64_tr_b16 a[142:143], v10 offset:39712
    buffer_load_dwordx2 a[38:39], v8, s[44:47], s21 offen offset:128 sc1
    v_mfma_f32_16x16x32_bf16 v[224:227], a[88:91], a[16:19], v[224:227]
    ds_read_b64_tr_b16 a[144:145], v10 offset:36160
    s_add_u32 s20, s20, 131072
    s_add_u32 s21, s20, 65536
    v_mfma_f32_16x16x32_bf16 v[232:235], a[88:91], a[20:23], v[232:235]
    ds_read_b64_tr_b16 a[146:147], v10 offset:39744
    v_mfma_f32_16x16x32_bf16 v[44:47], a[92:95], a[20:23], v[44:47]
    ds_read_b64_tr_b16 a[148:149], v10 offset:50432
    buffer_load_dwordx4 v7, s[4:7], s22 offen offset:2048  lds
    v_mfma_f32_16x16x32_bf16 v[36:39], a[92:95], a[16:19], v[36:39]
    ds_read_b64_tr_b16 a[150:151], v10 offset:54016
    s_add_u32 s22, s22, 458752
    s_cmp_eq_u32 s22, s19
    s_cselect_b32 s22, s18, s22
    v_mfma_f32_16x16x32_bf16 v[68:71], a[96:99], a[16:19], v[68:71]
    ds_read_b64_tr_b16 a[152:153], v10 offset:50464
    v_mfma_f32_16x16x32_bf16 v[76:79], a[96:99], a[20:23], v[76:79]
    ds_read_b64_tr_b16 a[154:155], v10 offset:54048
    v_mfma_f32_16x16x32_bf16 v[108:111], a[100:103], a[20:23], v[108:111]
    ds_read_b64_tr_b16 a[156:157], v10 offset:50496
    v_mfma_f32_16x16x32_bf16 v[100:103], a[100:103], a[16:19], v[100:103]
    ds_read_b64_tr_b16 a[158:159], v10 offset:54080
    v_mfma_f32_16x16x32_bf16 v[132:135], a[104:107], a[16:19], v[132:135]
    ds_read_b64_tr_b16 a[160:161], v10 offset:50528
    v_mfma_f32_16x16x32_bf16 v[140:143], a[104:107], a[20:23], v[140:143]
    ds_read_b64_tr_b16 a[162:163], v10 offset:54112
    v_mfma_f32_16x16x32_bf16 v[172:175], a[108:111], a[20:23], v[172:175]
    ds_read_b64_tr_b16 a[164:165], v10 offset:50560
    v_mfma_f32_16x16x32_bf16 v[164:167], a[108:111], a[16:19], v[164:167]
    ds_read_b64_tr_b16 a[166:167], v10 offset:54144
    v_mfma_f32_16x16x32_bf16 v[196:199], a[112:115], a[16:19], v[196:199]
    ds_read_b64_tr_b16 a[168:169], v10 offset:50592
    v_mfma_f32_16x16x32_bf16 v[204:207], a[112:115], a[20:23], v[204:207]
    ds_read_b64_tr_b16 a[170:171], v10 offset:54176
    v_mfma_f32_16x16x32_bf16 v[236:239], a[116:119], a[20:23], v[236:239]
    ds_read_b64_tr_b16 a[172:173], v10 offset:50624
    v_mfma_f32_16x16x32_bf16 v[228:231], a[116:119], a[16:19], v[228:231]
    ds_read_b64_tr_b16 a[174:175], v10 offset:54208
    s_cmp_lg_u32 s94, 2
    s_cbranch_scc1 L_mk_ncs_18
    v_mfma_f32_16x16x32_bf16 v[48:51], v[12:15], a[64:67], 0
    v_mfma_f32_16x16x32_bf16 v[80:83], v[12:15], a[68:71], 0
    v_mfma_f32_16x16x32_bf16 v[112:115], v[12:15], a[72:75], 0
    v_mfma_f32_16x16x32_bf16 v[144:147], v[12:15], a[76:79], 0
    v_mfma_f32_16x16x32_bf16 v[176:179], v[12:15], a[80:83], 0
    v_mfma_f32_16x16x32_bf16 v[208:211], v[12:15], a[84:87], 0
    v_mfma_f32_16x16x32_bf16 v[240:243], v[12:15], a[88:91], 0
    v_mfma_f32_16x16x32_bf16 v[52:55], v[12:15], a[92:95], 0
    v_mfma_f32_16x16x32_bf16 v[84:87], v[12:15], a[96:99], 0
    v_mfma_f32_16x16x32_bf16 v[116:119], v[12:15], a[100:103], 0
    v_mfma_f32_16x16x32_bf16 v[148:151], v[12:15], a[104:107], 0
    v_mfma_f32_16x16x32_bf16 v[180:183], v[12:15], a[108:111], 0
    v_mfma_f32_16x16x32_bf16 v[212:215], v[12:15], a[112:115], 0
    v_mfma_f32_16x16x32_bf16 v[244:247], v[12:15], a[116:119], 0
L_mk_ncs_18:
    s_waitcnt vmcnt(8) lgkmcnt(12)
    v_mfma_f32_16x16x32_bf16 v[32:35], a[120:123], a[24:27], v[32:35]
    ds_read_b64_tr_b16 a[64:65], v11 offset:0
    v_mfma_f32_16x16x32_bf16 v[40:43], a[120:123], a[28:31], v[40:43]
    ds_read_b64_tr_b16 a[66:67], v11 offset:3584
    v_mfma_f32_16x16x32_bf16 v[72:75], a[124:127], a[28:31], v[72:75]
    ds_read_b64_tr_b16 a[68:69], v11 offset:32
    buffer_load_dwordx2 a[40:41], v8, s[44:47], s20 offen offset:0 sc1
    v_mfma_f32_16x16x32_bf16 v[64:67], a[124:127], a[24:27], v[64:67]
    ds_read_b64_tr_b16 a[70:71], v11 offset:3616
    v_mfma_f32_16x16x32_bf16 v[96:99], a[128:131], a[24:27], v[96:99]
    ds_read_b64_tr_b16 a[72:73], v11 offset:64
    v_mfma_f32_16x16x32_bf16 v[104:107], a[128:131], a[28:31], v[104:107]
    ds_read_b64_tr_b16 a[74:75], v11 offset:3648
    buffer_load_dwordx2 a[42:43], v8, s[44:47], s21 offen offset:0 sc1
    v_mfma_f32_16x16x32_bf16 v[136:139], a[132:135], a[28:31], v[136:139]
    ds_read_b64_tr_b16 a[76:77], v11 offset:96
    v_mfma_f32_16x16x32_bf16 v[128:131], a[132:135], a[24:27], v[128:131]
    ds_read_b64_tr_b16 a[78:79], v11 offset:3680
    s_waitcnt lgkmcnt(8)
    v_mfma_f32_16x16x32_bf16 v[160:163], a[136:139], a[24:27], v[160:163]
    ds_read_b64_tr_b16 a[80:81], v11 offset:128
    buffer_load_dwordx2 a[44:45], v8, s[44:47], s20 offen offset:128 sc1
    v_mfma_f32_16x16x32_bf16 v[168:171], a[136:139], a[28:31], v[168:171]
    ds_read_b64_tr_b16 a[82:83], v11 offset:3712
    v_mfma_f32_16x16x32_bf16 v[200:203], a[140:143], a[28:31], v[200:203]
    ds_read_b64_tr_b16 a[84:85], v11 offset:160
    v_mfma_f32_16x16x32_bf16 v[192:195], a[140:143], a[24:27], v[192:195]
    ds_read_b64_tr_b16 a[86:87], v11 offset:3744
    buffer_load_dwordx2 a[46:47], v8, s[44:47], s21 offen offset:128 sc1
    v_mfma_f32_16x16x32_bf16 v[224:227], a[144:147], a[24:27], v[224:227]
    ds_read_b64_tr_b16 a[88:89], v11 offset:192
    s_add_u32 s20, s20, 131072
    s_add_u32 s21, s20, 65536
    v_mfma_f32_16x16x32_bf16 v[232:235], a[144:147], a[28:31], v[232:235]
    ds_read_b64_tr_b16 a[90:91], v11 offset:3776
    v_mfma_f32_16x16x32_bf16 v[44:47], a[148:151], a[28:31], v[44:47]
    ds_read_b64_tr_b16 a[92:93], v11 offset:14464
    v_mfma_f32_16x16x32_bf16 v[36:39], a[148:151], a[24:27], v[36:39]
    ds_read_b64_tr_b16 a[94:95], v11 offset:18048
    v_mfma_f32_16x16x32_bf16 v[68:71], a[152:155], a[24:27], v[68:71]
    ds_read_b64_tr_b16 a[96:97], v11 offset:14496
    v_mfma_f32_16x16x32_bf16 v[76:79], a[152:155], a[28:31], v[76:79]
    ds_read_b64_tr_b16 a[98:99], v11 offset:18080
    v_mfma_f32_16x16x32_bf16 v[108:111], a[156:159], a[28:31], v[108:111]
    ds_read_b64_tr_b16 a[100:101], v11 offset:14528
    v_mfma_f32_16x16x32_bf16 v[100:103], a[156:159], a[24:27], v[100:103]
    ds_read_b64_tr_b16 a[102:103], v11 offset:18112
    v_mfma_f32_16x16x32_bf16 v[132:135], a[160:163], a[24:27], v[132:135]
    ds_read_b64_tr_b16 a[104:105], v11 offset:14560
    v_mfma_f32_16x16x32_bf16 v[140:143], a[160:163], a[28:31], v[140:143]
    ds_read_b64_tr_b16 a[106:107], v11 offset:18144
    v_mfma_f32_16x16x32_bf16 v[172:175], a[164:167], a[28:31], v[172:175]
    ds_read_b64_tr_b16 a[108:109], v11 offset:14592
    v_mfma_f32_16x16x32_bf16 v[164:167], a[164:167], a[24:27], v[164:167]
    ds_read_b64_tr_b16 a[110:111], v11 offset:18176
    v_mfma_f32_16x16x32_bf16 v[196:199], a[168:171], a[24:27], v[196:199]
    ds_read_b64_tr_b16 a[112:113], v11 offset:14624
    v_mfma_f32_16x16x32_bf16 v[204:207], a[168:171], a[28:31], v[204:207]
    ds_read_b64_tr_b16 a[114:115], v11 offset:18208
    v_mfma_f32_16x16x32_bf16 v[236:239], a[172:175], a[28:31], v[236:239]
    ds_read_b64_tr_b16 a[116:117], v11 offset:14656
    v_mfma_f32_16x16x32_bf16 v[228:231], a[172:175], a[24:27], v[228:231]
    ds_read_b64_tr_b16 a[118:119], v11 offset:18240
    s_cmp_lg_u32 s94, 3
    s_cbranch_scc1 L_mk_ncs_19
    v_mfma_f32_16x16x32_bf16 v[48:51], v[12:15], a[120:123], 0
    v_mfma_f32_16x16x32_bf16 v[80:83], v[12:15], a[124:127], 0
    v_mfma_f32_16x16x32_bf16 v[112:115], v[12:15], a[128:131], 0
    v_mfma_f32_16x16x32_bf16 v[144:147], v[12:15], a[132:135], 0
    v_mfma_f32_16x16x32_bf16 v[176:179], v[12:15], a[136:139], 0
    v_mfma_f32_16x16x32_bf16 v[208:211], v[12:15], a[140:143], 0
    v_mfma_f32_16x16x32_bf16 v[240:243], v[12:15], a[144:147], 0
    v_mfma_f32_16x16x32_bf16 v[52:55], v[12:15], a[148:151], 0
    v_mfma_f32_16x16x32_bf16 v[84:87], v[12:15], a[152:155], 0
    v_mfma_f32_16x16x32_bf16 v[116:119], v[12:15], a[156:159], 0
    v_mfma_f32_16x16x32_bf16 v[148:151], v[12:15], a[160:163], 0
    v_mfma_f32_16x16x32_bf16 v[180:183], v[12:15], a[164:167], 0
    v_mfma_f32_16x16x32_bf16 v[212:215], v[12:15], a[168:171], 0
    v_mfma_f32_16x16x32_bf16 v[244:247], v[12:15], a[172:175], 0
L_mk_ncs_19:
    s_waitcnt vmcnt(5) lgkmcnt(12)
    v_mfma_f32_16x16x32_bf16 v[32:35], a[64:67], a[32:35], v[32:35]
    ds_read_b64_tr_b16 a[120:121], v11 offset:7168
    s_mul_i32 s50, s94, 896
    v_mfma_f32_16x16x32_bf16 v[40:43], a[64:67], a[36:39], v[40:43]
    ds_read_b64_tr_b16 a[122:123], v11 offset:10752
    s_add_u32 s50, s50, 115200
    v_mfma_f32_16x16x32_bf16 v[72:75], a[68:71], a[36:39], v[72:75]
    ds_read_b64_tr_b16 a[124:125], v11 offset:7200
    buffer_load_dwordx2 a[48:49], v8, s[44:47], s20 offen offset:0 sc1
    v_and_b32 v17, 15, v30
    v_mfma_f32_16x16x32_bf16 v[64:67], a[68:71], a[32:35], v[64:67]
    ds_read_b64_tr_b16 a[126:127], v11 offset:10784
    v_lshl_add_u32 v17, v17, 2, s50
    v_mfma_f32_16x16x32_bf16 v[96:99], a[72:75], a[32:35], v[96:99]
    ds_read_b64_tr_b16 a[128:129], v11 offset:7232
    v_mfma_f32_16x16x32_bf16 v[104:107], a[72:75], a[36:39], v[104:107]
    ds_read_b64_tr_b16 a[130:131], v11 offset:10816
    buffer_load_dwordx2 a[50:51], v8, s[44:47], s21 offen offset:0 sc1
    v_mfma_f32_16x16x32_bf16 v[136:139], a[76:79], a[36:39], v[136:139]
    ds_read_b64_tr_b16 a[132:133], v11 offset:7264
    v_mfma_f32_16x16x32_bf16 v[128:131], a[76:79], a[32:35], v[128:131]
    ds_read_b64_tr_b16 a[134:135], v11 offset:10848
    s_waitcnt lgkmcnt(8)
    v_mfma_f32_16x16x32_bf16 v[160:163], a[80:83], a[32:35], v[160:163]
    ds_read_b64_tr_b16 a[136:137], v11 offset:7296
    buffer_load_dwordx2 a[52:53], v8, s[44:47], s20 offen offset:128 sc1
    ds_write2_b32 v17, v48, v52 offset0:0 offset1:112
    v_mfma_f32_16x16x32_bf16 v[168:171], a[80:83], a[36:39], v[168:171]
    ds_read_b64_tr_b16 a[138:139], v11 offset:10880
    ds_write2_b32 v17, v80, v84 offset0:16 offset1:128
    v_mfma_f32_16x16x32_bf16 v[200:203], a[84:87], a[36:39], v[200:203]
    ds_read_b64_tr_b16 a[140:141], v11 offset:7328
    ds_write2_b32 v17, v112, v116 offset0:32 offset1:144
    v_mfma_f32_16x16x32_bf16 v[192:195], a[84:87], a[32:35], v[192:195]
    ds_read_b64_tr_b16 a[142:143], v11 offset:10912
    buffer_load_dwordx2 a[54:55], v8, s[44:47], s21 offen offset:128 sc1
    ds_write2_b32 v17, v144, v148 offset0:48 offset1:160
    v_mfma_f32_16x16x32_bf16 v[224:227], a[88:91], a[32:35], v[224:227]
    ds_read_b64_tr_b16 a[144:145], v11 offset:7360
    s_add_u32 s20, s20, 131072
    s_add_u32 s21, s20, 65536
    ds_write2_b32 v17, v176, v180 offset0:64 offset1:176
    v_mfma_f32_16x16x32_bf16 v[232:235], a[88:91], a[36:39], v[232:235]
    ds_read_b64_tr_b16 a[146:147], v11 offset:10944
    s_mov_b32 s49, 16400
    ds_write2_b32 v17, v208, v212 offset0:80 offset1:192
    v_mfma_f32_16x16x32_bf16 v[44:47], a[92:95], a[36:39], v[44:47]
    ds_read_b64_tr_b16 a[148:149], v11 offset:21632
    buffer_load_dwordx2 v[26:27], v29, s[60:63], s49 offen sc1
    ds_write2_b32 v17, v240, v244 offset0:96 offset1:208
    v_mfma_f32_16x16x32_bf16 v[36:39], a[92:95], a[32:35], v[36:39]
    ds_read_b64_tr_b16 a[150:151], v11 offset:25216
    v_mfma_f32_16x16x32_bf16 v[68:71], a[96:99], a[32:35], v[68:71]
    ds_read_b64_tr_b16 a[152:153], v11 offset:21664
    v_mfma_f32_16x16x32_bf16 v[76:79], a[96:99], a[36:39], v[76:79]
    ds_read_b64_tr_b16 a[154:155], v11 offset:25248
    v_mfma_f32_16x16x32_bf16 v[108:111], a[100:103], a[36:39], v[108:111]
    ds_read_b64_tr_b16 a[156:157], v11 offset:21696
    v_mfma_f32_16x16x32_bf16 v[100:103], a[100:103], a[32:35], v[100:103]
    ds_read_b64_tr_b16 a[158:159], v11 offset:25280
    v_mfma_f32_16x16x32_bf16 v[132:135], a[104:107], a[32:35], v[132:135]
    ds_read_b64_tr_b16 a[160:161], v11 offset:21728
    v_mfma_f32_16x16x32_bf16 v[140:143], a[104:107], a[36:39], v[140:143]
    ds_read_b64_tr_b16 a[162:163], v11 offset:25312
    v_mfma_f32_16x16x32_bf16 v[172:175], a[108:111], a[36:39], v[172:175]
    ds_read_b64_tr_b16 a[164:165], v11 offset:21760
    v_mfma_f32_16x16x32_bf16 v[164:167], a[108:111], a[32:35], v[164:167]
    ds_read_b64_tr_b16 a[166:167], v11 offset:25344
    v_mfma_f32_16x16x32_bf16 v[196:199], a[112:115], a[32:35], v[196:199]
    ds_read_b64_tr_b16 a[168:169], v11 offset:21792
    v_mfma_f32_16x16x32_bf16 v[204:207], a[112:115], a[36:39], v[204:207]
    ds_read_b64_tr_b16 a[170:171], v11 offset:25376
    v_mfma_f32_16x16x32_bf16 v[236:239], a[116:119], a[36:39], v[236:239]
    ds_read_b64_tr_b16 a[172:173], v11 offset:21824
    v_mfma_f32_16x16x32_bf16 v[228:231], a[116:119], a[32:35], v[228:231]
    ds_read_b64_tr_b16 a[174:175], v11 offset:25408
    s_waitcnt vmcnt(0) lgkmcnt(12)
    v_cmp_ne_u64_e64 vcc, s[92:93], v[26:27]
    s_cbranch_vccz L_mk_flok_20
    s_mov_b32 s96, 0
L_mk_poll_21:
    buffer_load_dwordx2 v[26:27], v29, s[60:63], s49 offen sc1
    s_waitcnt vmcnt(0)
    v_cmp_ne_u64_e64 vcc, s[92:93], v[26:27]
    s_cbranch_vccz L_mk_pdone_22
    s_mov_b64 exec, vcc
    s_add_u32 s96, s96, 1
    s_cmp_lt_u32 s96, 400000
    s_cbranch_scc1 L_mk_poll_21
L_mk_pdone_22:
    s_mov_b64 exec, -1
L_mk_flok_20:
    s_barrier
    v_mfma_f32_16x16x32_bf16 v[32:35], a[120:123], a[40:43], v[32:35]
    ds_read_b64_tr_b16 a[64:65], v11 offset:28800
    v_mfma_f32_16x16x32_bf16 v[40:43], a[120:123], a[44:47], v[40:43]
    ds_read_b64_tr_b16 a[66:67], v11 offset:32384
    v_mfma_f32_16x16x32_bf16 v[72:75], a[124:127], a[44:47], v[72:75]
    ds_read_b64_tr_b16 a[68:69], v11 offset:28832
    buffer_load_dwordx2 a[56:57], v8, s[44:47], s20 offen offset:0 sc1
    v_mfma_f32_16x16x32_bf16 v[64:67], a[124:127], a[40:43], v[64:67]
    ds_read_b64_tr_b16 a[70:71], v11 offset:32416
    v_mfma_f32_16x16x32_bf16 v[96:99], a[128:131], a[40:43], v[96:99]
    ds_read_b64_tr_b16 a[72:73], v11 offset:28864
    v_mfma_f32_16x16x32_bf16 v[104:107], a[128:131], a[44:47], v[104:107]
    ds_read_b64_tr_b16 a[74:75], v11 offset:32448
    buffer_load_dwordx2 a[58:59], v8, s[44:47], s21 offen offset:0 sc1
    v_mfma_f32_16x16x32_bf16 v[136:139], a[132:135], a[44:47], v[136:139]
    ds_read_b64_tr_b16 a[76:77], v11 offset:28896
    v_mfma_f32_16x16x32_bf16 v[128:131], a[132:135], a[40:43], v[128:131]
    ds_read_b64_tr_b16 a[78:79], v11 offset:32480
    s_waitcnt lgkmcnt(8)
    v_mfma_f32_16x16x32_bf16 v[160:163], a[136:139], a[40:43], v[160:163]
    ds_read_b64_tr_b16 a[80:81], v11 offset:28928
    buffer_load_dwordx2 a[60:61], v8, s[44:47], s20 offen offset:128 sc1
    v_mfma_f32_16x16x32_bf16 v[168:171], a[136:139], a[44:47], v[168:171]
    ds_read_b64_tr_b16 a[82:83], v11 offset:32512
    v_mfma_f32_16x16x32_bf16 v[200:203], a[140:143], a[44:47], v[200:203]
    ds_read_b64_tr_b16 a[84:85], v11 offset:28960
    v_mfma_f32_16x16x32_bf16 v[192:195], a[140:143], a[40:43], v[192:195]
    ds_read_b64_tr_b16 a[86:87], v11 offset:32544
    buffer_load_dwordx2 a[62:63], v8, s[44:47], s21 offen offset:128 sc1
    v_mfma_f32_16x16x32_bf16 v[224:227], a[144:147], a[40:43], v[224:227]
    ds_read_b64_tr_b16 a[88:89], v11 offset:28992
    s_mov_b32 s20, s17
    s_add_u32 s21, s20, 65536
    v_mfma_f32_16x16x32_bf16 v[232:235], a[144:147], a[44:47], v[232:235]
    ds_read_b64_tr_b16 a[90:91], v11 offset:32576
    v_mfma_f32_16x16x32_bf16 v[44:47], a[148:151], a[44:47], v[44:47]
    ds_read_b64_tr_b16 a[92:93], v11 offset:43264
    buffer_load_dwordx2 a[0:1], v8, s[44:47], s20 offen offset:256 sc1
    v_mfma_f32_16x16x32_bf16 v[36:39], a[148:151], a[40:43], v[36:39]
    ds_read_b64_tr_b16 a[94:95], v11 offset:46848
    v_mfma_f32_16x16x32_bf16 v[68:71], a[152:155], a[40:43], v[68:71]
    ds_read_b64_tr_b16 a[96:97], v11 offset:43296
    v_mfma_f32_16x16x32_bf16 v[76:79], a[152:155], a[44:47], v[76:79]
    ds_read_b64_tr_b16 a[98:99], v11 offset:46880
    buffer_load_dwordx2 a[2:3], v8, s[44:47], s21 offen offset:256 sc1
    v_mfma_f32_16x16x32_bf16 v[108:111], a[156:159], a[44:47], v[108:111]
    ds_read_b64_tr_b16 a[100:101], v11 offset:43328
    v_mfma_f32_16x16x32_bf16 v[100:103], a[156:159], a[40:43], v[100:103]
    ds_read_b64_tr_b16 a[102:103], v11 offset:46912
    v_mfma_f32_16x16x32_bf16 v[132:135], a[160:163], a[40:43], v[132:135]
    ds_read_b64_tr_b16 a[104:105], v11 offset:43360
    buffer_load_dwordx2 a[4:5], v8, s[44:47], s20 offen offset:384 sc1
    v_mfma_f32_16x16x32_bf16 v[140:143], a[160:163], a[44:47], v[140:143]
    ds_read_b64_tr_b16 a[106:107], v11 offset:46944
    v_mfma_f32_16x16x32_bf16 v[172:175], a[164:167], a[44:47], v[172:175]
    ds_read_b64_tr_b16 a[108:109], v11 offset:43392
    v_mfma_f32_16x16x32_bf16 v[164:167], a[164:167], a[40:43], v[164:167]
    ds_read_b64_tr_b16 a[110:111], v11 offset:46976
    buffer_load_dwordx2 a[6:7], v8, s[44:47], s21 offen offset:384 sc1
    v_mfma_f32_16x16x32_bf16 v[196:199], a[168:171], a[40:43], v[196:199]
    ds_read_b64_tr_b16 a[112:113], v11 offset:43424
    s_add_u32 s20, s20, 131072
    s_add_u32 s21, s20, 65536
    v_mfma_f32_16x16x32_bf16 v[204:207], a[168:171], a[44:47], v[204:207]
    ds_read_b64_tr_b16 a[114:115], v11 offset:47008
    v_mfma_f32_16x16x32_bf16 v[236:239], a[172:175], a[44:47], v[236:239]
    ds_read_b64_tr_b16 a[116:117], v11 offset:43456
    v_mfma_f32_16x16x32_bf16 v[228:231], a[172:175], a[40:43], v[228:231]
    ds_read_b64_tr_b16 a[118:119], v11 offset:47040
    s_waitcnt vmcnt(9) lgkmcnt(12)
    v_mfma_f32_16x16x32_bf16 v[32:35], a[64:67], a[48:51], v[32:35]
    ds_read_b64_tr_b16 a[120:121], v11 offset:35968
    v_and_b32 v17, 3, v30
    v_mfma_f32_16x16x32_bf16 v[40:43], a[64:67], a[52:55], v[40:43]
    ds_read_b64_tr_b16 a[122:123], v11 offset:39552
    s_lshl_b32 s50, s94, 2
    v_mfma_f32_16x16x32_bf16 v[72:75], a[68:71], a[52:55], v[72:75]
    ds_read_b64_tr_b16 a[124:125], v11 offset:36000
    buffer_load_dwordx2 a[8:9], v8, s[44:47], s20 offen offset:256 sc1
    v_add_u32 v17, s50, v17
    v_mfma_f32_16x16x32_bf16 v[64:67], a[68:71], a[48:51], v[64:67]
    ds_read_b64_tr_b16 a[126:127], v11 offset:39584
    v_min_u32 v17, 13, v17
    v_mfma_f32_16x16x32_bf16 v[96:99], a[72:75], a[48:51], v[96:99]
    ds_read_b64_tr_b16 a[128:129], v11 offset:36032
    v_lshlrev_b32 v17, 6, v17
    v_mfma_f32_16x16x32_bf16 v[104:107], a[72:75], a[52:55], v[104:107]
    ds_read_b64_tr_b16 a[130:131], v11 offset:39616
    buffer_load_dwordx2 a[10:11], v8, s[44:47], s21 offen offset:256 sc1
    v_and_b32 v18, 60, v30
    v_mfma_f32_16x16x32_bf16 v[136:139], a[76:79], a[52:55], v[136:139]
    ds_read_b64_tr_b16 a[132:133], v11 offset:36064
    v_add_u32 v17, v17, v18
    v_mfma_f32_16x16x32_bf16 v[128:131], a[76:79], a[48:51], v[128:131]
    ds_read_b64_tr_b16 a[134:135], v11 offset:39648
    s_waitcnt lgkmcnt(8)
    v_add_u32 v17, 115200, v17
    v_mfma_f32_16x16x32_bf16 v[160:163], a[80:83], a[48:51], v[160:163]
    ds_read_b64_tr_b16 a[136:137], v11 offset:36096
    buffer_load_dwordx2 a[12:13], v8, s[44:47], s20 offen offset:384 sc1
    ds_read_b32 v20, v17 offset:0
    v_mfma_f32_16x16x32_bf16 v[168:171], a[80:83], a[52:55], v[168:171]
    ds_read_b64_tr_b16 a[138:139], v11 offset:39680
    ds_read_b32 v21, v17 offset:896
    v_mfma_f32_16x16x32_bf16 v[200:203], a[84:87], a[52:55], v[200:203]
    ds_read_b64_tr_b16 a[140:141], v11 offset:36128
    ds_read_b32 v22, v17 offset:1792
    v_mfma_f32_16x16x32_bf16 v[192:195], a[84:87], a[48:51], v[192:195]
    ds_read_b64_tr_b16 a[142:143], v11 offset:39712
    buffer_load_dwordx2 a[14:15], v8, s[44:47], s21 offen offset:384 sc1
    ds_read_b32 v23, v17 offset:2688
    v_mfma_f32_16x16x32_bf16 v[224:227], a[88:91], a[48:51], v[224:227]
    ds_read_b64_tr_b16 a[144:145], v11 offset:36160
    s_add_u32 s20, s20, 131072
    s_add_u32 s21, s20, 65536
    v_mfma_f32_16x16x32_bf16 v[232:235], a[88:91], a[52:55], v[232:235]
    ds_read_b64_tr_b16 a[146:147], v11 offset:39744
    v_mfma_f32_16x16x32_bf16 v[44:47], a[92:95], a[52:55], v[44:47]
    ds_read_b64_tr_b16 a[148:149], v11 offset:50432
    buffer_load_dwordx2 a[16:17], v8, s[44:47], s20 offen offset:256 sc1
    v_mfma_f32_16x16x32_bf16 v[36:39], a[92:95], a[48:51], v[36:39]
    ds_read_b64_tr_b16 a[150:151], v11 offset:54016
    v_mfma_f32_16x16x32_bf16 v[68:71], a[96:99], a[48:51], v[68:71]
    ds_read_b64_tr_b16 a[152:153], v11 offset:50464
    v_mfma_f32_16x16x32_bf16 v[76:79], a[96:99], a[52:55], v[76:79]
    ds_read_b64_tr_b16 a[154:155], v11 offset:54048
    buffer_load_dwordx2 a[18:19], v8, s[44:47], s21 offen offset:256 sc1
    v_mfma_f32_16x16x32_bf16 v[108:111], a[100:103], a[52:55], v[108:111]
    ds_read_b64_tr_b16 a[156:157], v11 offset:50496
    v_mfma_f32_16x16x32_bf16 v[100:103], a[100:103], a[48:51], v[100:103]
    ds_read_b64_tr_b16 a[158:159], v11 offset:54080
    v_mfma_f32_16x16x32_bf16 v[132:135], a[104:107], a[48:51], v[132:135]
    ds_read_b64_tr_b16 a[160:161], v11 offset:50528
    buffer_load_dwordx2 a[20:21], v8, s[44:47], s20 offen offset:384 sc1
    v_mfma_f32_16x16x32_bf16 v[140:143], a[104:107], a[52:55], v[140:143]
    ds_read_b64_tr_b16 a[162:163], v11 offset:54112
    v_mfma_f32_16x16x32_bf16 v[172:175], a[108:111], a[52:55], v[172:175]
    ds_read_b64_tr_b16 a[164:165], v11 offset:50560
    v_mfma_f32_16x16x32_bf16 v[164:167], a[108:111], a[48:51], v[164:167]
    ds_read_b64_tr_b16 a[166:167], v11 offset:54144
    buffer_load_dwordx2 a[22:23], v8, s[44:47], s21 offen offset:384 sc1
    v_mfma_f32_16x16x32_bf16 v[196:199], a[112:115], a[48:51], v[196:199]
    ds_read_b64_tr_b16 a[168:169], v11 offset:50592
    s_add_u32 s20, s20, 131072
    s_add_u32 s21, s20, 65536
    v_mfma_f32_16x16x32_bf16 v[204:207], a[112:115], a[52:55], v[204:207]
    ds_read_b64_tr_b16 a[170:171], v11 offset:54176
    v_mfma_f32_16x16x32_bf16 v[236:239], a[116:119], a[52:55], v[236:239]
    ds_read_b64_tr_b16 a[172:173], v11 offset:50624
    v_mfma_f32_16x16x32_bf16 v[228:231], a[116:119], a[48:51], v[228:231]
    ds_read_b64_tr_b16 a[174:175], v11 offset:54208
    s_waitcnt vmcnt(12) lgkmcnt(12)
    v_mfma_f32_16x16x32_bf16 v[32:35], a[120:123], a[56:59], v[32:35]
    ds_read_b64_tr_b16 a[64:65], v10 offset:0
    v_add_f32 v20, v20, v21
    v_add_f32 v22, v22, v23
    v_mfma_f32_16x16x32_bf16 v[40:43], a[120:123], a[60:63], v[40:43]
    ds_read_b64_tr_b16 a[66:67], v10 offset:3584
    v_lshlrev_b32 v18, 2, v0
    v_add_f32 v20, v20, v22
    v_mfma_f32_16x16x32_bf16 v[72:75], a[124:127], a[60:63], v[72:75]
    ds_read_b64_tr_b16 a[68:69], v10 offset:32
    buffer_load_dwordx2 a[24:25], v8, s[44:47], s20 offen offset:256 sc1
    v_mfma_f32_16x16x32_bf16 v[64:67], a[124:127], a[56:59], v[64:67]
    ds_read_b64_tr_b16 a[70:71], v10 offset:3616
    v_cvt_pk_bf16_f32 v21, v20, v20
    v_lshlrev_b32 v21, 16, v21
    v_mfma_f32_16x16x32_bf16 v[96:99], a[128:131], a[56:59], v[96:99]
    ds_read_b64_tr_b16 a[72:73], v10 offset:64
    v_sub_f32_e64 v20, v20, v21
    v_cvt_pk_bf16_f32 v20, v21, v20
    v_mfma_f32_16x16x32_bf16 v[104:107], a[128:131], a[60:63], v[104:107]
    ds_read_b64_tr_b16 a[74:75], v10 offset:3648
    buffer_load_dwordx2 a[26:27], v8, s[44:47], s21 offen offset:256 sc1
    v_mfma_f32_16x16x32_bf16 v[136:139], a[132:135], a[60:63], v[136:139]
    ds_read_b64_tr_b16 a[76:77], v10 offset:96
    s_lshl_b32 s50, s33, 10
    s_add_u32 s50, s50, s32
    v_mfma_f32_16x16x32_bf16 v[128:131], a[132:135], a[56:59], v[128:131]
    ds_read_b64_tr_b16 a[78:79], v10 offset:3680
    s_waitcnt lgkmcnt(8)
    v_mfma_f32_16x16x32_bf16 v[160:163], a[136:139], a[56:59], v[160:163]
    ds_read_b64_tr_b16 a[80:81], v10 offset:128
    buffer_load_dwordx2 a[28:29], v8, s[44:47], s20 offen offset:384 sc1
    v_mfma_f32_16x16x32_bf16 v[168:171], a[136:139], a[60:63], v[168:171]
    ds_read_b64_tr_b16 a[82:83], v10 offset:3712
    buffer_store_dword v20, v18, s[40:43], s50 offen sc1
    v_mfma_f32_16x16x32_bf16 v[200:203], a[140:143], a[60:63], v[200:203]
    ds_read_b64_tr_b16 a[84:85], v10 offset:160
    v_and_b32 v29, 3, v30
    v_lshlrev_b32 v29, 4, v29
    v_mfma_f32_16x16x32_bf16 v[192:195], a[140:143], a[56:59], v[192:195]
    ds_read_b64_tr_b16 a[86:87], v10 offset:3744
    buffer_load_dwordx2 a[30:31], v8, s[44:47], s21 offen offset:384 sc1
    v_mfma_f32_16x16x32_bf16 v[224:227], a[144:147], a[56:59], v[224:227]
    ds_read_b64_tr_b16 a[88:89], v10 offset:192
    s_cmp_eq_u32 s17, 0
    s_cselect_b32 s20, s26, 0
    s_add_u32 s21, s20, 65536
    s_lshl_b32 s50, s94, 6
    v_mfma_f32_16x16x32_bf16 v[232:235], a[144:147], a[60:63], v[232:235]
    ds_read_b64_tr_b16 a[90:91], v10 offset:3776
    s_add_u32 s50, s50, 163584
    v_add_u32 v29, s50, v29
    v_mfma_f32_16x16x32_bf16 v[44:47], a[148:151], a[60:63], v[44:47]
    ds_read_b64_tr_b16 a[92:93], v10 offset:14464
    buffer_load_dwordx2 a[32:33], v8, s[44:47], s20 offen offset:256 sc1
    v_mfma_f32_16x16x32_bf16 v[36:39], a[148:151], a[56:59], v[36:39]
    ds_read_b64_tr_b16 a[94:95], v10 offset:18048
    v_mfma_f32_16x16x32_bf16 v[68:71], a[152:155], a[56:59], v[68:71]
    ds_read_b64_tr_b16 a[96:97], v10 offset:14496
    v_mfma_f32_16x16x32_bf16 v[76:79], a[152:155], a[60:63], v[76:79]
    ds_read_b64_tr_b16 a[98:99], v10 offset:18080
    buffer_load_dwordx2 a[34:35], v8, s[44:47], s21 offen offset:256 sc1
    v_mfma_f32_16x16x32_bf16 v[108:111], a[156:159], a[60:63], v[108:111]
    ds_read_b64_tr_b16 a[100:101], v10 offset:14528
    v_mfma_f32_16x16x32_bf16 v[100:103], a[156:159], a[56:59], v[100:103]
    ds_read_b64_tr_b16 a[102:103], v10 offset:18112
    v_mfma_f32_16x16x32_bf16 v[132:135], a[160:163], a[56:59], v[132:135]
    ds_read_b64_tr_b16 a[104:105], v10 offset:14560
    buffer_load_dwordx2 a[36:37], v8, s[44:47], s20 offen offset:384 sc1
    v_mfma_f32_16x16x32_bf16 v[140:143], a[160:163], a[60:63], v[140:143]
    ds_read_b64_tr_b16 a[106:107], v10 offset:18144
    v_mfma_f32_16x16x32_bf16 v[172:175], a[164:167], a[60:63], v[172:175]
    ds_read_b64_tr_b16 a[108:109], v10 offset:14592
    v_mfma_f32_16x16x32_bf16 v[164:167], a[164:167], a[56:59], v[164:167]
    ds_read_b64_tr_b16 a[110:111], v10 offset:18176
    buffer_load_dwordx2 a[38:39], v8, s[44:47], s21 offen offset:384 sc1
    v_mfma_f32_16x16x32_bf16 v[196:199], a[168:171], a[56:59], v[196:199]
    ds_read_b64_tr_b16 a[112:113], v10 offset:14624
    s_add_u32 s20, s20, 131072
    s_add_u32 s21, s20, 65536
    v_mfma_f32_16x16x32_bf16 v[204:207], a[168:171], a[60:63], v[204:207]
    ds_read_b64_tr_b16 a[114:115], v10 offset:18208
    v_mfma_f32_16x16x32_bf16 v[236:239], a[172:175], a[60:63], v[236:239]
    ds_read_b64_tr_b16 a[116:117], v10 offset:14656
    v_mfma_f32_16x16x32_bf16 v[228:231], a[172:175], a[56:59], v[228:231]
    ds_read_b64_tr_b16 a[118:119], v10 offset:18240
    s_waitcnt vmcnt(16) lgkmcnt(12)
    v_mfma_f32_16x16x32_bf16 v[48:51], a[64:67], a[0:3], 0
    ds_read_b64_tr_b16 a[120:121], v10 offset:7168
    v_mfma_f32_16x16x32_bf16 v[56:59], a[64:67], a[4:7], 0
    ds_read_b64_tr_b16 a[122:123], v10 offset:10752
    v_mfma_f32_16x16x32_bf16 v[88:91], a[68:71], a[4:7], 0
    ds_read_b64_tr_b16 a[124:125], v10 offset:7200
    buffer_load_dwordx2 a[40:41], v8, s[44:47], s20 offen offset:256 sc1
    v_mfma_f32_16x16x32_bf16 v[80:83], a[68:71], a[0:3], 0
    ds_read_b64_tr_b16 a[126:127], v10 offset:10784
    v_mfma_f32_16x16x32_bf16 v[112:115], a[72:75], a[0:3], 0
    ds_read_b64_tr_b16 a[128:129], v10 offset:7232
    v_mfma_f32_16x16x32_bf16 v[120:123], a[72:75], a[4:7], 0
    ds_read_b64_tr_b16 a[130:131], v10 offset:10816
    buffer_load_dwordx2 a[42:43], v8, s[44:47], s21 offen offset:256 sc1
    v_mfma_f32_16x16x32_bf16 v[152:155], a[76:79], a[4:7], 0
    ds_read_b64_tr_b16 a[132:133], v10 offset:7264
    v_mfma_f32_16x16x32_bf16 v[144:147], a[76:79], a[0:3], 0
    ds_read_b64_tr_b16 a[134:135], v10 offset:10848
    s_waitcnt lgkmcnt(8)
    v_mfma_f32_16x16x32_bf16 v[176:179], a[80:83], a[0:3], 0
    ds_read_b64_tr_b16 a[136:137], v10 offset:7296
    buffer_load_dwordx2 a[44:45], v8, s[44:47], s20 offen offset:384 sc1
    v_mfma_f32_16x16x32_bf16 v[184:187], a[80:83], a[4:7], 0
    ds_read_b64_tr_b16 a[138:139], v10 offset:10880
    v_mfma_f32_16x16x32_bf16 v[216:219], a[84:87], a[4:7], 0
    ds_read_b64_tr_b16 a[140:141], v10 offset:7328
    v_mfma_f32_16x16x32_bf16 v[208:211], a[84:87], a[0:3], 0
    ds_read_b64_tr_b16 a[142:143], v10 offset:10912
    buffer_load_dwordx2 a[46:47], v8, s[44:47], s21 offen offset:384 sc1
    v_mfma_f32_16x16x32_bf16 v[240:243], a[88:91], a[0:3], 0
    ds_read_b64_tr_b16 a[144:145], v10 offset:7360
    s_add_u32 s20, s20, 131072
    s_add_u32 s21, s20, 65536
    v_mfma_f32_16x16x32_bf16 v[248:251], a[88:91], a[4:7], 0
    ds_read_b64_tr_b16 a[146:147], v10 offset:10944
    v_mfma_f32_16x16x32_bf16 v[60:63], a[92:95], a[4:7], 0
    ds_read_b64_tr_b16 a[148:149], v10 offset:21632
    v_mfma_f32_16x16x32_bf16 v[52:55], a[92:95], a[0:3], 0
    ds_read_b64_tr_b16 a[150:151], v10 offset:25216
    v_mfma_f32_16x16x32_bf16 v[84:87], a[96:99], a[0:3], 0
    ds_read_b64_tr_b16 a[152:153], v10 offset:21664
    v_mfma_f32_16x16x32_bf16 v[92:95], a[96:99], a[4:7], 0
    ds_read_b64_tr_b16 a[154:155], v10 offset:25248
    v_mfma_f32_16x16x32_bf16 v[124:127], a[100:103], a[4:7], 0
    ds_read_b64_tr_b16 a[156:157], v10 offset:21696
    v_mfma_f32_16x16x32_bf16 v[116:119], a[100:103], a[0:3], 0
    ds_read_b64_tr_b16 a[158:159], v10 offset:25280
    v_mfma_f32_16x16x32_bf16 v[148:151], a[104:107], a[0:3], 0
    ds_read_b64_tr_b16 a[160:161], v10 offset:21728
    v_mfma_f32_16x16x32_bf16 v[156:159], a[104:107], a[4:7], 0
    ds_read_b64_tr_b16 a[162:163], v10 offset:25312
    v_mfma_f32_16x16x32_bf16 v[188:191], a[108:111], a[4:7], 0
    ds_read_b64_tr_b16 a[164:165], v10 offset:21760
    v_mfma_f32_16x16x32_bf16 v[180:183], a[108:111], a[0:3], 0
    ds_read_b64_tr_b16 a[166:167], v10 offset:25344
    v_mfma_f32_16x16x32_bf16 v[212:215], a[112:115], a[0:3], 0
    ds_read_b64_tr_b16 a[168:169], v10 offset:21792
    v_mfma_f32_16x16x32_bf16 v[220:223], a[112:115], a[4:7], 0
    ds_read_b64_tr_b16 a[170:171], v10 offset:25376
    v_mfma_f32_16x16x32_bf16 v[252:255], a[116:119], a[4:7], 0
    ds_read_b64_tr_b16 a[172:173], v10 offset:21824
    v_mfma_f32_16x16x32_bf16 v[244:247], a[116:119], a[0:3], 0
    ds_read_b64_tr_b16 a[174:175], v10 offset:25408
    s_waitcnt vmcnt(16) lgkmcnt(12)
    v_mfma_f32_16x16x32_bf16 v[48:51], a[120:123], a[8:11], v[48:51]
    ds_read_b64_tr_b16 a[64:65], v10 offset:28800
    v_mfma_f32_16x16x32_bf16 v[56:59], a[120:123], a[12:15], v[56:59]
    ds_read_b64_tr_b16 a[66:67], v10 offset:32384
    v_mfma_f32_16x16x32_bf16 v[88:91], a[124:127], a[12:15], v[88:91]
    ds_read_b64_tr_b16 a[68:69], v10 offset:28832
    buffer_load_dwordx2 a[48:49], v8, s[44:47], s20 offen offset:256 sc1
    v_mfma_f32_16x16x32_bf16 v[80:83], a[124:127], a[8:11], v[80:83]
    ds_read_b64_tr_b16 a[70:71], v10 offset:32416
    v_mfma_f32_16x16x32_bf16 v[112:115], a[128:131], a[8:11], v[112:115]
    ds_read_b64_tr_b16 a[72:73], v10 offset:28864
    v_mfma_f32_16x16x32_bf16 v[120:123], a[128:131], a[12:15], v[120:123]
    ds_read_b64_tr_b16 a[74:75], v10 offset:32448
    buffer_load_dwordx2 a[50:51], v8, s[44:47], s21 offen offset:256 sc1
    v_mfma_f32_16x16x32_bf16 v[152:155], a[132:135], a[12:15], v[152:155]
    ds_read_b64_tr_b16 a[76:77], v10 offset:28896
    v_mfma_f32_16x16x32_bf16 v[144:147], a[132:135], a[8:11], v[144:147]
    ds_read_b64_tr_b16 a[78:79], v10 offset:32480
    s_waitcnt lgkmcnt(8)
    s_barrier
    v_mfma_f32_16x16x32_bf16 v[176:179], a[136:139], a[8:11], v[176:179]
    ds_read_b64_tr_b16 a[80:81], v10 offset:28928
    buffer_load_dwordx2 a[52:53], v8, s[44:47], s20 offen offset:384 sc1
    v_mfma_f32_16x16x32_bf16 v[184:187], a[136:139], a[12:15], v[184:187]
    ds_read_b64_tr_b16 a[82:83], v10 offset:32512
    v_mfma_f32_16x16x32_bf16 v[216:219], a[140:143], a[12:15], v[216:219]
    ds_read_b64_tr_b16 a[84:85], v10 offset:28960
    v_mfma_f32_16x16x32_bf16 v[208:211], a[140:143], a[8:11], v[208:211]
    ds_read_b64_tr_b16 a[86:87], v10 offset:32544
    buffer_load_dwordx2 a[54:55], v8, s[44:47], s21 offen offset:384 sc1
    v_mfma_f32_16x16x32_bf16 v[240:243], a[144:147], a[8:11], v[240:243]
    ds_read_b64_tr_b16 a[88:89], v10 offset:28992
    s_add_u32 s20, s20, 131072
    s_add_u32 s21, s20, 65536
    v_mfma_f32_16x16x32_bf16 v[248:251], a[144:147], a[12:15], v[248:251]
    ds_read_b64_tr_b16 a[90:91], v10 offset:32576
    s_add_u32 m0, s24, 0
    v_mfma_f32_16x16x32_bf16 v[60:63], a[148:151], a[12:15], v[60:63]
    ds_read_b64_tr_b16 a[92:93], v10 offset:43264
    buffer_load_dwordx4 v1, s[4:7], s22 offen offset:0  lds
    v_mfma_f32_16x16x32_bf16 v[52:55], a[148:151], a[8:11], v[52:55]
    ds_read_b64_tr_b16 a[94:95], v10 offset:46848
    v_mfma_f32_16x16x32_bf16 v[84:87], a[152:155], a[8:11], v[84:87]
    ds_read_b64_tr_b16 a[96:97], v10 offset:43296
    v_mfma_f32_16x16x32_bf16 v[92:95], a[152:155], a[12:15], v[92:95]
    ds_read_b64_tr_b16 a[98:99], v10 offset:46880
    buffer_load_dwordx4 v2, s[4:7], s22 offen offset:1024  lds
    v_mfma_f32_16x16x32_bf16 v[124:127], a[156:159], a[12:15], v[124:127]
    ds_read_b64_tr_b16 a[100:101], v10 offset:43328
    v_mfma_f32_16x16x32_bf16 v[116:119], a[156:159], a[8:11], v[116:119]
    ds_read_b64_tr_b16 a[102:103], v10 offset:46912
    v_mfma_f32_16x16x32_bf16 v[148:151], a[160:163], a[8:11], v[148:151]
    ds_read_b64_tr_b16 a[104:105], v10 offset:43360
    buffer_load_dwordx4 v3, s[4:7], s22 offen offset:2048  lds
    v_mfma_f32_16x16x32_bf16 v[156:159], a[160:163], a[12:15], v[156:159]
    ds_read_b64_tr_b16 a[106:107], v10 offset:46944
    v_mfma_f32_16x16x32_bf16 v[188:191], a[164:167], a[12:15], v[188:191]
    ds_read_b64_tr_b16 a[108:109], v10 offset:43392
    v_mfma_f32_16x16x32_bf16 v[180:183], a[164:167], a[8:11], v[180:183]
    ds_read_b64_tr_b16 a[110:111], v10 offset:46976
    v_mfma_f32_16x16x32_bf16 v[212:215], a[168:171], a[8:11], v[212:215]
    ds_read_b64_tr_b16 a[112:113], v10 offset:43424
    v_mfma_f32_16x16x32_bf16 v[220:223], a[168:171], a[12:15], v[220:223]
    ds_read_b64_tr_b16 a[114:115], v10 offset:47008
    v_mfma_f32_16x16x32_bf16 v[252:255], a[172:175], a[12:15], v[252:255]
    ds_read_b64_tr_b16 a[116:117], v10 offset:43456
    v_mfma_f32_16x16x32_bf16 v[244:247], a[172:175], a[8:11], v[244:247]
    ds_read_b64_tr_b16 a[118:119], v10 offset:47040
    s_waitcnt vmcnt(19) lgkmcnt(12)
    v_mfma_f32_16x16x32_bf16 v[48:51], a[64:67], a[16:19], v[48:51]
    ds_read_b64_tr_b16 a[120:121], v10 offset:35968
    v_mfma_f32_16x16x32_bf16 v[56:59], a[64:67], a[20:23], v[56:59]
    ds_read_b64_tr_b16 a[122:123], v10 offset:39552
    v_mfma_f32_16x16x32_bf16 v[88:91], a[68:71], a[20:23], v[88:91]
    ds_read_b64_tr_b16 a[124:125], v10 offset:36000
    buffer_load_dwordx4 v[20:23], v16, s[44:47], s35 offen sc1
    v_mfma_f32_16x16x32_bf16 v[80:83], a[68:71], a[16:19], v[80:83]
    ds_read_b64_tr_b16 a[126:127], v10 offset:39584
    s_add_u32 s35, s35, 262144
    v_mfma_f32_16x16x32_bf16 v[112:115], a[72:75], a[16:19], v[112:115]
    ds_read_b64_tr_b16 a[128:129], v10 offset:36032
    v_mfma_f32_16x16x32_bf16 v[120:123], a[72:75], a[20:23], v[120:123]
    ds_read_b64_tr_b16 a[130:131], v10 offset:39616
    buffer_load_dwordx2 a[56:57], v8, s[44:47], s20 offen offset:256 sc1
    v_mfma_f32_16x16x32_bf16 v[152:155], a[76:79], a[20:23], v[152:155]
    ds_read_b64_tr_b16 a[132:133], v10 offset:36064
    v_mfma_f32_16x16x32_bf16 v[144:147], a[76:79], a[16:19], v[144:147]
    ds_read_b64_tr_b16 a[134:135], v10 offset:39648
    s_waitcnt lgkmcnt(8)
    v_mfma_f32_16x16x32_bf16 v[176:179], a[80:83], a[16:19], v[176:179]
    ds_read_b64_tr_b16 a[136:137], v10 offset:36096
    buffer_load_dwordx2 a[58:59], v8, s[44:47], s21 offen offset:256 sc1
    v_mfma_f32_16x16x32_bf16 v[184:187], a[80:83], a[20:23], v[184:187]
    ds_read_b64_tr_b16 a[138:139], v10 offset:39680
    v_mfma_f32_16x16x32_bf16 v[216:219], a[84:87], a[20:23], v[216:219]
    ds_read_b64_tr_b16 a[140:141], v10 offset:36128
    v_mfma_f32_16x16x32_bf16 v[208:211], a[84:87], a[16:19], v[208:211]
    ds_read_b64_tr_b16 a[142:143], v10 offset:39712
    buffer_load_dwordx2 a[60:61], v8, s[44:47], s20 offen offset:384 sc1
    v_mfma_f32_16x16x32_bf16 v[240:243], a[88:91], a[16:19], v[240:243]
    ds_read_b64_tr_b16 a[144:145], v10 offset:36160
    v_mfma_f32_16x16x32_bf16 v[248:251], a[88:91], a[20:23], v[248:251]
    ds_read_b64_tr_b16 a[146:147], v10 offset:39744
    v_mfma_f32_16x16x32_bf16 v[60:63], a[92:95], a[20:23], v[60:63]
    ds_read_b64_tr_b16 a[148:149], v10 offset:50432
    buffer_load_dwordx2 a[62:63], v8, s[44:47], s21 offen offset:384 sc1
    v_mfma_f32_16x16x32_bf16 v[52:55], a[92:95], a[16:19], v[52:55]
    ds_read_b64_tr_b16 a[150:151], v10 offset:54016
    s_add_u32 s20, s20, 131072
    s_cmp_eq_u32 s20, s17
    s_cselect_b32 s20, s26, s20
    s_add_u32 s21, s20, 65536
    v_mfma_f32_16x16x32_bf16 v[84:87], a[96:99], a[16:19], v[84:87]
    ds_read_b64_tr_b16 a[152:153], v10 offset:50464
    v_mfma_f32_16x16x32_bf16 v[92:95], a[96:99], a[20:23], v[92:95]
    ds_read_b64_tr_b16 a[154:155], v10 offset:54048
    buffer_load_dwordx4 v4, s[4:7], s22 offen offset:3072  lds
    v_mfma_f32_16x16x32_bf16 v[124:127], a[100:103], a[20:23], v[124:127]
    ds_read_b64_tr_b16 a[156:157], v10 offset:50496
    v_mfma_f32_16x16x32_bf16 v[116:119], a[100:103], a[16:19], v[116:119]
    ds_read_b64_tr_b16 a[158:159], v10 offset:54080
    s_add_u32 m0, s24, 4096
    v_mfma_f32_16x16x32_bf16 v[148:151], a[104:107], a[16:19], v[148:151]
    ds_read_b64_tr_b16 a[160:161], v10 offset:50528
    buffer_load_dwordx4 v5, s[4:7], s22 offen offset:0  lds
    v_mfma_f32_16x16x32_bf16 v[156:159], a[104:107], a[20:23], v[156:159]
    ds_read_b64_tr_b16 a[162:163], v10 offset:54112
    v_mfma_f32_16x16x32_bf16 v[188:191], a[108:111], a[20:23], v[188:191]
    ds_read_b64_tr_b16 a[164:165], v10 offset:50560
    v_mfma_f32_16x16x32_bf16 v[180:183], a[108:111], a[16:19], v[180:183]
    ds_read_b64_tr_b16 a[166:167], v10 offset:54144
    v_mfma_f32_16x16x32_bf16 v[212:215], a[112:115], a[16:19], v[212:215]
    ds_read_b64_tr_b16 a[168:169], v10 offset:50592
    v_mfma_f32_16x16x32_bf16 v[220:223], a[112:115], a[20:23], v[220:223]
    ds_read_b64_tr_b16 a[170:171], v10 offset:54176
    v_mfma_f32_16x16x32_bf16 v[252:255], a[116:119], a[20:23], v[252:255]
    ds_read_b64_tr_b16 a[172:173], v10 offset:50624
    v_mfma_f32_16x16x32_bf16 v[244:247], a[116:119], a[16:19], v[244:247]
    ds_read_b64_tr_b16 a[174:175], v10 offset:54208
    s_waitcnt vmcnt(22) lgkmcnt(12)
    v_mfma_f32_16x16x32_bf16 v[48:51], a[120:123], a[24:27], v[48:51]
    ds_read_b64_tr_b16 a[64:65], v11 offset:0
    v_mfma_f32_16x16x32_bf16 v[56:59], a[120:123], a[28:31], v[56:59]
    ds_read_b64_tr_b16 a[66:67], v11 offset:3584
    v_mfma_f32_16x16x32_bf16 v[88:91], a[124:127], a[28:31], v[88:91]
    ds_read_b64_tr_b16 a[68:69], v11 offset:32
    buffer_load_dwordx4 v[24:27], v16, s[44:47], s35 offen sc1
    v_mfma_f32_16x16x32_bf16 v[80:83], a[124:127], a[24:27], v[80:83]
    ds_read_b64_tr_b16 a[70:71], v11 offset:3616
    s_add_u32 s35, s35, 262144
    v_mfma_f32_16x16x32_bf16 v[112:115], a[128:131], a[24:27], v[112:115]
    ds_read_b64_tr_b16 a[72:73], v11 offset:64
    v_mfma_f32_16x16x32_bf16 v[120:123], a[128:131], a[28:31], v[120:123]
    ds_read_b64_tr_b16 a[74:75], v11 offset:3648
    buffer_load_dwordx2 a[0:1], v8, s[44:47], s20 offen offset:0 sc1
    v_mfma_f32_16x16x32_bf16 v[152:155], a[132:135], a[28:31], v[152:155]
    ds_read_b64_tr_b16 a[76:77], v11 offset:96
    v_mfma_f32_16x16x32_bf16 v[144:147], a[132:135], a[24:27], v[144:147]
    ds_read_b64_tr_b16 a[78:79], v11 offset:3680
    s_waitcnt lgkmcnt(8)
    s_barrier
    v_mfma_f32_16x16x32_bf16 v[176:179], a[136:139], a[24:27], v[176:179]
    ds_read_b64_tr_b16 a[80:81], v11 offset:128
    buffer_load_dwordx2 a[2:3], v8, s[44:47], s21 offen offset:0 sc1
    v_mfma_f32_16x16x32_bf16 v[184:187], a[136:139], a[28:31], v[184:187]
    ds_read_b64_tr_b16 a[82:83], v11 offset:3712
    v_mfma_f32_16x16x32_bf16 v[216:219], a[140:143], a[28:31], v[216:219]
    ds_read_b64_tr_b16 a[84:85], v11 offset:160
    v_mfma_f32_16x16x32_bf16 v[208:211], a[140:143], a[24:27], v[208:211]
    ds_read_b64_tr_b16 a[86:87], v11 offset:3744
    buffer_load_dwordx2 a[4:5], v8, s[44:47], s20 offen offset:128 sc1
    v_mfma_f32_16x16x32_bf16 v[240:243], a[144:147], a[24:27], v[240:243]
    ds_read_b64_tr_b16 a[88:89], v11 offset:192
    v_mfma_f32_16x16x32_bf16 v[248:251], a[144:147], a[28:31], v[248:251]
    ds_read_b64_tr_b16 a[90:91], v11 offset:3776
    v_mfma_f32_16x16x32_bf16 v[60:63], a[148:151], a[28:31], v[60:63]
    ds_read_b64_tr_b16 a[92:93], v11 offset:14464
    buffer_load_dwordx2 a[6:7], v8, s[44:47], s21 offen offset:128 sc1
    v_mfma_f32_16x16x32_bf16 v[52:55], a[148:151], a[24:27], v[52:55]
    ds_read_b64_tr_b16 a[94:95], v11 offset:18048
    v_mfma_f32_16x16x32_bf16 v[84:87], a[152:155], a[24:27], v[84:87]
    ds_read_b64_tr_b16 a[96:97], v11 offset:14496
    v_mfma_f32_16x16x32_bf16 v[92:95], a[152:155], a[28:31], v[92:95]
    ds_read_b64_tr_b16 a[98:99], v11 offset:18080
    buffer_load_dwordx4 v6, s[4:7], s22 offen offset:1024  lds
    v_mfma_f32_16x16x32_bf16 v[124:127], a[156:159], a[28:31], v[124:127]
    ds_read_b64_tr_b16 a[100:101], v11 offset:14528
    v_mfma_f32_16x16x32_bf16 v[116:119], a[156:159], a[24:27], v[116:119]
    ds_read_b64_tr_b16 a[102:103], v11 offset:18112
    v_mfma_f32_16x16x32_bf16 v[148:151], a[160:163], a[24:27], v[148:151]
    ds_read_b64_tr_b16 a[104:105], v11 offset:14560
    buffer_load_dwordx4 v7, s[4:7], s22 offen offset:2048  lds
    v_mfma_f32_16x16x32_bf16 v[156:159], a[160:163], a[28:31], v[156:159]
    ds_read_b64_tr_b16 a[106:107], v11 offset:18144
    s_add_u32 s22, s22, 458752
    v_mfma_f32_16x16x32_bf16 v[188:191], a[164:167], a[28:31], v[188:191]
    ds_read_b64_tr_b16 a[108:109], v11 offset:14592
    v_mfma_f32_16x16x32_bf16 v[180:183], a[164:167], a[24:27], v[180:183]
    ds_read_b64_tr_b16 a[110:111], v11 offset:18176
    v_mfma_f32_16x16x32_bf16 v[212:215], a[168:171], a[24:27], v[212:215]
    ds_read_b64_tr_b16 a[112:113], v11 offset:14624
    v_mfma_f32_16x16x32_bf16 v[220:223], a[168:171], a[28:31], v[220:223]
    ds_read_b64_tr_b16 a[114:115], v11 offset:18208
    v_mfma_f32_16x16x32_bf16 v[252:255], a[172:175], a[28:31], v[252:255]
    ds_read_b64_tr_b16 a[116:117], v11 offset:14656
    v_mfma_f32_16x16x32_bf16 v[244:247], a[172:175], a[24:27], v[244:247]
    ds_read_b64_tr_b16 a[118:119], v11 offset:18240
    s_waitcnt vmcnt(25) lgkmcnt(12)
    v_mfma_f32_16x16x32_bf16 v[48:51], a[64:67], a[32:35], v[48:51]
    ds_read_b64_tr_b16 a[120:121], v11 offset:7168
    v_mfma_f32_16x16x32_bf16 v[56:59], a[64:67], a[36:39], v[56:59]
    ds_read_b64_tr_b16 a[122:123], v11 offset:10752
    v_mfma_f32_16x16x32_bf16 v[88:91], a[68:71], a[36:39], v[88:91]
    ds_read_b64_tr_b16 a[124:125], v11 offset:7200
    buffer_load_dwordx2 a[8:9], v8, s[44:47], s20 offen offset:256 sc1
    v_mfma_f32_16x16x32_bf16 v[80:83], a[68:71], a[32:35], v[80:83]
    ds_read_b64_tr_b16 a[126:127], v11 offset:10784
    v_mfma_f32_16x16x32_bf16 v[112:115], a[72:75], a[32:35], v[112:115]
    ds_read_b64_tr_b16 a[128:129], v11 offset:7232
    v_mfma_f32_16x16x32_bf16 v[120:123], a[72:75], a[36:39], v[120:123]
    ds_read_b64_tr_b16 a[130:131], v11 offset:10816
    buffer_load_dwordx2 a[10:11], v8, s[44:47], s21 offen offset:256 sc1
    v_mfma_f32_16x16x32_bf16 v[152:155], a[76:79], a[36:39], v[152:155]
    ds_read_b64_tr_b16 a[132:133], v11 offset:7264
    v_mfma_f32_16x16x32_bf16 v[144:147], a[76:79], a[32:35], v[144:147]
    ds_read_b64_tr_b16 a[134:135], v11 offset:10848
    s_waitcnt lgkmcnt(8)
    v_mfma_f32_16x16x32_bf16 v[176:179], a[80:83], a[32:35], v[176:179]
    ds_read_b64_tr_b16 a[136:137], v11 offset:7296
    buffer_load_dwordx2 a[12:13], v8, s[44:47], s20 offen offset:384 sc1
    v_mfma_f32_16x16x32_bf16 v[184:187], a[80:83], a[36:39], v[184:187]
    ds_read_b64_tr_b16 a[138:139], v11 offset:10880
    v_mfma_f32_16x16x32_bf16 v[216:219], a[84:87], a[36:39], v[216:219]
    ds_read_b64_tr_b16 a[140:141], v11 offset:7328
    v_mfma_f32_16x16x32_bf16 v[208:211], a[84:87], a[32:35], v[208:211]
    ds_read_b64_tr_b16 a[142:143], v11 offset:10912
    buffer_load_dwordx2 a[14:15], v8, s[44:47], s21 offen offset:384 sc1
    v_mfma_f32_16x16x32_bf16 v[240:243], a[88:91], a[32:35], v[240:243]
    ds_read_b64_tr_b16 a[144:145], v11 offset:7360
    s_add_u32 s20, s20, 131072
    s_add_u32 s21, s20, 65536
    v_mfma_f32_16x16x32_bf16 v[248:251], a[88:91], a[36:39], v[248:251]
    ds_read_b64_tr_b16 a[146:147], v11 offset:10944
    s_add_u32 m0, s24, 28800
    v_mfma_f32_16x16x32_bf16 v[60:63], a[92:95], a[36:39], v[60:63]
    ds_read_b64_tr_b16 a[148:149], v11 offset:21632
    buffer_load_dwordx4 v1, s[4:7], s22 offen offset:0  lds
    v_mfma_f32_16x16x32_bf16 v[52:55], a[92:95], a[32:35], v[52:55]
    ds_read_b64_tr_b16 a[150:151], v11 offset:25216
    v_mfma_f32_16x16x32_bf16 v[84:87], a[96:99], a[32:35], v[84:87]
    ds_read_b64_tr_b16 a[152:153], v11 offset:21664
    v_mfma_f32_16x16x32_bf16 v[92:95], a[96:99], a[36:39], v[92:95]
    ds_read_b64_tr_b16 a[154:155], v11 offset:25248
    buffer_load_dwordx4 v2, s[4:7], s22 offen offset:1024  lds
    v_mfma_f32_16x16x32_bf16 v[124:127], a[100:103], a[36:39], v[124:127]
    ds_read_b64_tr_b16 a[156:157], v11 offset:21696
    v_mfma_f32_16x16x32_bf16 v[116:119], a[100:103], a[32:35], v[116:119]
    ds_read_b64_tr_b16 a[158:159], v11 offset:25280
    v_mfma_f32_16x16x32_bf16 v[148:151], a[104:107], a[32:35], v[148:151]
    ds_read_b64_tr_b16 a[160:161], v11 offset:21728
    buffer_load_dwordx4 v3, s[4:7], s22 offen offset:2048  lds
    v_mfma_f32_16x16x32_bf16 v[156:159], a[104:107], a[36:39], v[156:159]
    ds_read_b64_tr_b16 a[162:163], v11 offset:25312
    v_mfma_f32_16x16x32_bf16 v[188:191], a[108:111], a[36:39], v[188:191]
    ds_read_b64_tr_b16 a[164:165], v11 offset:21760
    v_mfma_f32_16x16x32_bf16 v[180:183], a[108:111], a[32:35], v[180:183]
    ds_read_b64_tr_b16 a[166:167], v11 offset:25344
    v_mfma_f32_16x16x32_bf16 v[212:215], a[112:115], a[32:35], v[212:215]
    ds_read_b64_tr_b16 a[168:169], v11 offset:21792
    v_mfma_f32_16x16x32_bf16 v[220:223], a[112:115], a[36:39], v[220:223]
    ds_read_b64_tr_b16 a[170:171], v11 offset:25376
    v_mfma_f32_16x16x32_bf16 v[252:255], a[116:119], a[36:39], v[252:255]
    ds_read_b64_tr_b16 a[172:173], v11 offset:21824
    v_mfma_f32_16x16x32_bf16 v[244:247], a[116:119], a[32:35], v[244:247]
    ds_read_b64_tr_b16 a[174:175], v11 offset:25408
    s_waitcnt vmcnt(20) lgkmcnt(12)
    v_mfma_f32_16x16x32_bf16 v[48:51], a[120:123], a[40:43], v[48:51]
    ds_read_b64_tr_b16 a[64:65], v11 offset:28800
    v_lshlrev_b32 v18, 16, v20
    v_lshlrev_b32 v19, 16, v22
    v_mfma_f32_16x16x32_bf16 v[56:59], a[120:123], a[44:47], v[56:59]
    ds_read_b64_tr_b16 a[66:67], v11 offset:32384
    v_and_b32 v20, s3, v20
    v_and_b32 v22, s3, v22
    v_mfma_f32_16x16x32_bf16 v[88:91], a[124:127], a[44:47], v[88:91]
    ds_read_b64_tr_b16 a[68:69], v11 offset:28832
    buffer_load_dwordx2 a[16:17], v8, s[44:47], s20 offen offset:0 sc1
    v_mfma_f32_16x16x32_bf16 v[80:83], a[124:127], a[40:43], v[80:83]
    ds_read_b64_tr_b16 a[70:71], v11 offset:32416
    v_add_f32 v12, v18, v20
    v_add_f32 v13, v19, v22
    v_mfma_f32_16x16x32_bf16 v[112:115], a[128:131], a[40:43], v[112:115]
    ds_read_b64_tr_b16 a[72:73], v11 offset:28864
    v_mul_f32 v14, v18, v18
    v_mul_f32 v15, v19, v19
    v_mfma_f32_16x16x32_bf16 v[120:123], a[128:131], a[44:47], v[120:123]
    ds_read_b64_tr_b16 a[74:75], v11 offset:32448
    buffer_load_dwordx2 a[18:19], v8, s[44:47], s21 offen offset:0 sc1
    v_mfma_f32_16x16x32_bf16 v[152:155], a[132:135], a[44:47], v[152:155]
    ds_read_b64_tr_b16 a[76:77], v11 offset:28896
    v_fmac_f32 v14, v20, v20
    v_fmac_f32 v15, v22, v22
    v_mfma_f32_16x16x32_bf16 v[144:147], a[132:135], a[40:43], v[144:147]
    ds_read_b64_tr_b16 a[78:79], v11 offset:32480
    s_waitcnt lgkmcnt(8)
    s_barrier
    v_lshlrev_b32 v18, 16, v21
    v_mfma_f32_16x16x32_bf16 v[176:179], a[136:139], a[40:43], v[176:179]
    ds_read_b64_tr_b16 a[80:81], v11 offset:28928
    buffer_load_dwordx2 a[20:21], v8, s[44:47], s20 offen offset:128 sc1
    v_mfma_f32_16x16x32_bf16 v[184:187], a[136:139], a[44:47], v[184:187]
    ds_read_b64_tr_b16 a[82:83], v11 offset:32512
    v_lshlrev_b32 v19, 16, v23
    v_and_b32 v21, s3, v21
    v_mfma_f32_16x16x32_bf16 v[216:219], a[140:143], a[44:47], v[216:219]
    ds_read_b64_tr_b16 a[84:85], v11 offset:28960
    v_and_b32 v23, s3, v23
    v_add_f32 v12, v12, v18
    v_mfma_f32_16x16x32_bf16 v[208:211], a[140:143], a[40:43], v[208:211]
    ds_read_b64_tr_b16 a[86:87], v11 offset:32544
    buffer_load_dwordx2 a[22:23], v8, s[44:47], s21 offen offset:128 sc1
    v_mfma_f32_16x16x32_bf16 v[240:243], a[144:147], a[40:43], v[240:243]
    ds_read_b64_tr_b16 a[88:89], v11 offset:28992
    v_add_f32 v13, v13, v19
    v_fmac_f32 v14, v18, v18
    v_mfma_f32_16x16x32_bf16 v[248:251], a[144:147], a[44:47], v[248:251]
    ds_read_b64_tr_b16 a[90:91], v11 offset:32576
    v_fmac_f32 v15, v19, v19
    v_add_f32 v12, v12, v21
    v_mfma_f32_16x16x32_bf16 v[60:63], a[148:151], a[44:47], v[60:63]
    ds_read_b64_tr_b16 a[92:93], v11 offset:43264
    buffer_load_dwordx4 v4, s[4:7], s22 offen offset:3072  lds
    v_mfma_f32_16x16x32_bf16 v[52:55], a[148:151], a[40:43], v[52:55]
    ds_read_b64_tr_b16 a[94:95], v11 offset:46848
    v_add_f32 v13, v13, v23
    v_fmac_f32 v14, v21, v21
    v_mfma_f32_16x16x32_bf16 v[84:87], a[152:155], a[40:43], v[84:87]
    ds_read_b64_tr_b16 a[96:97], v11 offset:43296
    s_add_u32 m0, s24, 32896
    v_fmac_f32 v15, v23, v23
    v_mfma_f32_16x16x32_bf16 v[92:95], a[152:155], a[44:47], v[92:95]
    ds_read_b64_tr_b16 a[98:99], v11 offset:46880
    buffer_load_dwordx4 v5, s[4:7], s22 offen offset:0  lds
    v_mfma_f32_16x16x32_bf16 v[124:127], a[156:159], a[44:47], v[124:127]
    ds_read_b64_tr_b16 a[100:101], v11 offset:43328
    v_mfma_f32_16x16x32_bf16 v[116:119], a[156:159], a[40:43], v[116:119]
    ds_read_b64_tr_b16 a[102:103], v11 offset:46912
    v_mfma_f32_16x16x32_bf16 v[148:151], a[160:163], a[40:43], v[148:151]
    ds_read_b64_tr_b16 a[104:105], v11 offset:43360
    buffer_load_dwordx4 v6, s[4:7], s22 offen offset:1024  lds
    v_mfma_f32_16x16x32_bf16 v[156:159], a[160:163], a[44:47], v[156:159]
    ds_read_b64_tr_b16 a[106:107], v11 offset:46944
    v_mfma_f32_16x16x32_bf16 v[188:191], a[164:167], a[44:47], v[188:191]
    ds_read_b64_tr_b16 a[108:109], v11 offset:43392
    v_mfma_f32_16x16x32_bf16 v[180:183], a[164:167], a[40:43], v[180:183]
    ds_read_b64_tr_b16 a[110:111], v11 offset:46976
    v_mfma_f32_16x16x32_bf16 v[212:215], a[168:171], a[40:43], v[212:215]
    ds_read_b64_tr_b16 a[112:113], v11 offset:43424
    v_mfma_f32_16x16x32_bf16 v[220:223], a[168:171], a[44:47], v[220:223]
    ds_read_b64_tr_b16 a[114:115], v11 offset:47008
    v_mfma_f32_16x16x32_bf16 v[252:255], a[172:175], a[44:47], v[252:255]
    ds_read_b64_tr_b16 a[116:117], v11 offset:43456
    v_mfma_f32_16x16x32_bf16 v[244:247], a[172:175], a[40:43], v[244:247]
    ds_read_b64_tr_b16 a[118:119], v11 offset:47040
    s_waitcnt vmcnt(31) lgkmcnt(12)
    v_mfma_f32_16x16x32_bf16 v[48:51], a[64:67], a[48:51], v[48:51]
    ds_read_b64_tr_b16 a[120:121], v11 offset:35968
    v_mfma_f32_16x16x32_bf16 v[56:59], a[64:67], a[52:55], v[56:59]
    ds_read_b64_tr_b16 a[122:123], v11 offset:39552
    v_mfma_f32_16x16x32_bf16 v[88:91], a[68:71], a[52:55], v[88:91]
    ds_read_b64_tr_b16 a[124:125], v11 offset:36000
    buffer_load_dwordx4 v[20:23], v16, s[44:47], s35 offen sc1
    v_mfma_f32_16x16x32_bf16 v[80:83], a[68:71], a[48:51], v[80:83]
    ds_read_b64_tr_b16 a[126:127], v11 offset:39584
    s_add_u32 s35, s35, 262144
    v_mfma_f32_16x16x32_bf16 v[112:115], a[72:75], a[48:51], v[112:115]
    ds_read_b64_tr_b16 a[128:129], v11 offset:36032
    v_mfma_f32_16x16x32_bf16 v[120:123], a[72:75], a[52:55], v[120:123]
    ds_read_b64_tr_b16 a[130:131], v11 offset:39616
    buffer_load_dwordx2 a[24:25], v8, s[44:47], s20 offen offset:256 sc1
    v_mfma_f32_16x16x32_bf16 v[152:155], a[76:79], a[52:55], v[152:155]
    ds_read_b64_tr_b16 a[132:133], v11 offset:36064
    v_mfma_f32_16x16x32_bf16 v[144:147], a[76:79], a[48:51], v[144:147]
    ds_read_b64_tr_b16 a[134:135], v11 offset:39648
    s_waitcnt lgkmcnt(8)
    v_mfma_f32_16x16x32_bf16 v[176:179], a[80:83], a[48:51], v[176:179]
    ds_read_b64_tr_b16 a[136:137], v11 offset:36096
    buffer_load_dwordx2 a[26:27], v8, s[44:47], s21 offen offset:256 sc1
    v_mfma_f32_16x16x32_bf16 v[184:187], a[80:83], a[52:55], v[184:187]
    ds_read_b64_tr_b16 a[138:139], v11 offset:39680
    v_mfma_f32_16x16x32_bf16 v[216:219], a[84:87], a[52:55], v[216:219]
    ds_read_b64_tr_b16 a[140:141], v11 offset:36128
    v_mfma_f32_16x16x32_bf16 v[208:211], a[84:87], a[48:51], v[208:211]
    ds_read_b64_tr_b16 a[142:143], v11 offset:39712
    buffer_load_dwordx2 a[28:29], v8, s[44:47], s20 offen offset:384 sc1
    v_mfma_f32_16x16x32_bf16 v[240:243], a[88:91], a[48:51], v[240:243]
    ds_read_b64_tr_b16 a[144:145], v11 offset:36160
    v_mfma_f32_16x16x32_bf16 v[248:251], a[88:91], a[52:55], v[248:251]
    ds_read_b64_tr_b16 a[146:147], v11 offset:39744
    v_mfma_f32_16x16x32_bf16 v[60:63], a[92:95], a[52:55], v[60:63]
    ds_read_b64_tr_b16 a[148:149], v11 offset:50432
    buffer_load_dwordx2 a[30:31], v8, s[44:47], s21 offen offset:384 sc1
    v_mfma_f32_16x16x32_bf16 v[52:55], a[92:95], a[48:51], v[52:55]
    ds_read_b64_tr_b16 a[150:151], v11 offset:54016
    s_add_u32 s20, s20, 131072
    s_add_u32 s21, s20, 65536
    v_mfma_f32_16x16x32_bf16 v[84:87], a[96:99], a[48:51], v[84:87]
    ds_read_b64_tr_b16 a[152:153], v11 offset:50464
    v_mfma_f32_16x16x32_bf16 v[92:95], a[96:99], a[52:55], v[92:95]
    ds_read_b64_tr_b16 a[154:155], v11 offset:54048
    buffer_load_dwordx4 v7, s[4:7], s22 offen offset:2048  lds
    v_mfma_f32_16x16x32_bf16 v[124:127], a[100:103], a[52:55], v[124:127]
    ds_read_b64_tr_b16 a[156:157], v11 offset:50496
    s_add_u32 s22, s22, 458752
    s_cmp_eq_u32 s22, s19
    s_cselect_b32 s22, s18, s22
    v_mfma_f32_16x16x32_bf16 v[116:119], a[100:103], a[48:51], v[116:119]
    ds_read_b64_tr_b16 a[158:159], v11 offset:54080
    s_add_u32 m0, s24, 57600
    v_mfma_f32_16x16x32_bf16 v[148:151], a[104:107], a[48:51], v[148:151]
    ds_read_b64_tr_b16 a[160:161], v11 offset:50528
    buffer_load_dwordx4 v1, s[4:7], s22 offen offset:0  lds
    v_mfma_f32_16x16x32_bf16 v[156:159], a[104:107], a[52:55], v[156:159]
    ds_read_b64_tr_b16 a[162:163], v11 offset:54112
    v_mfma_f32_16x16x32_bf16 v[188:191], a[108:111], a[52:55], v[188:191]
    ds_read_b64_tr_b16 a[164:165], v11 offset:50560
    v_mfma_f32_16x16x32_bf16 v[180:183], a[108:111], a[48:51], v[180:183]
    ds_read_b64_tr_b16 a[166:167], v11 offset:54144
    v_mfma_f32_16x16x32_bf16 v[212:215], a[112:115], a[48:51], v[212:215]
    ds_read_b64_tr_b16 a[168:169], v11 offset:50592
    v_mfma_f32_16x16x32_bf16 v[220:223], a[112:115], a[52:55], v[220:223]
    ds_read_b64_tr_b16 a[170:171], v11 offset:54176
    v_mfma_f32_16x16x32_bf16 v[252:255], a[116:119], a[52:55], v[252:255]
    ds_read_b64_tr_b16 a[172:173], v11 offset:50624
    v_mfma_f32_16x16x32_bf16 v[244:247], a[116:119], a[48:51], v[244:247]
    ds_read_b64_tr_b16 a[174:175], v11 offset:54208
    s_waitcnt vmcnt(21) lgkmcnt(12)
    s_barrier
    v_mfma_f32_16x16x32_bf16 v[48:51], a[120:123], a[56:59], v[48:51]
    ds_read_b64_tr_b16 a[64:65], v10 offset:0
    v_lshlrev_b32 v18, 16, v24
    v_mfma_f32_16x16x32_bf16 v[56:59], a[120:123], a[60:63], v[56:59]
    ds_read_b64_tr_b16 a[66:67], v10 offset:3584
    v_lshlrev_b32 v19, 16, v26
    v_mfma_f32_16x16x32_bf16 v[88:91], a[124:127], a[60:63], v[88:91]
    buffer_load_dwordx2 a[32:33], v8, s[44:47], s20 offen offset:0 sc1
    v_mfma_f32_16x16x32_bf16 v[80:83], a[124:127], a[56:59], v[80:83]
    ds_read_b64_tr_b16 a[68:69], v10 offset:32
    v_and_b32 v24, s3, v24
    v_mfma_f32_16x16x32_bf16 v[112:115], a[128:131], a[56:59], v[112:115]
    ds_read_b64_tr_b16 a[70:71], v10 offset:3616
    v_and_b32 v26, s3, v26
    v_mfma_f32_16x16x32_bf16 v[120:123], a[128:131], a[60:63], v[120:123]
    buffer_load_dwordx2 a[34:35], v8, s[44:47], s21 offen offset:0 sc1
    v_mfma_f32_16x16x32_bf16 v[152:155], a[132:135], a[60:63], v[152:155]
    ds_read_b64_tr_b16 a[72:73], v10 offset:64
    v_add_f32 v12, v12, v18
    v_mfma_f32_16x16x32_bf16 v[144:147], a[132:135], a[56:59], v[144:147]
    ds_read_b64_tr_b16 a[74:75], v10 offset:3648
    s_waitcnt lgkmcnt(6)
    s_barrier
    v_mfma_f32_16x16x32_bf16 v[176:179], a[136:139], a[56:59], v[176:179]
    buffer_load_dwordx2 a[36:37], v8, s[44:47], s20 offen offset:128 sc1
    v_mfma_f32_16x16x32_bf16 v[184:187], a[136:139], a[60:63], v[184:187]
    ds_read_b64_tr_b16 a[76:77], v10 offset:96
    v_add_f32 v13, v13, v19
    v_mfma_f32_16x16x32_bf16 v[216:219], a[140:143], a[60:63], v[216:219]
    ds_read_b64_tr_b16 a[78:79], v10 offset:3680
    v_fmac_f32 v14, v18, v18
    v_mfma_f32_16x16x32_bf16 v[208:211], a[140:143], a[56:59], v[208:211]
    buffer_load_dwordx2 a[38:39], v8, s[44:47], s21 offen offset:128 sc1
    v_mfma_f32_16x16x32_bf16 v[240:243], a[144:147], a[56:59], v[240:243]
    ds_read_b64_tr_b16 a[80:81], v10 offset:128
    v_fmac_f32 v15, v19, v19
    v_mfma_f32_16x16x32_bf16 v[248:251], a[144:147], a[60:63], v[248:251]
    ds_read_b64_tr_b16 a[82:83], v10 offset:3712
    v_add_f32 v12, v12, v24
    v_mfma_f32_16x16x32_bf16 v[60:63], a[148:151], a[60:63], v[60:63]
    buffer_load_dwordx4 v2, s[4:7], s22 offen offset:1024  lds
    v_mfma_f32_16x16x32_bf16 v[52:55], a[148:151], a[56:59], v[52:55]
    ds_read_b64_tr_b16 a[84:85], v10 offset:160
    v_add_f32 v13, v13, v26
    v_mfma_f32_16x16x32_bf16 v[84:87], a[152:155], a[56:59], v[84:87]
    ds_read_b64_tr_b16 a[86:87], v10 offset:3744
    v_fmac_f32 v14, v24, v24
    v_mfma_f32_16x16x32_bf16 v[92:95], a[152:155], a[60:63], v[92:95]
    v_fmac_f32 v15, v26, v26
    v_lshlrev_b32 v18, 16, v25
    v_mfma_f32_16x16x32_bf16 v[124:127], a[156:159], a[60:63], v[124:127]
    ds_read_b64_tr_b16 a[88:89], v10 offset:192
    v_lshlrev_b32 v19, 16, v27
    v_mfma_f32_16x16x32_bf16 v[116:119], a[156:159], a[56:59], v[116:119]
    ds_read_b64_tr_b16 a[90:91], v10 offset:3776
    v_and_b32 v25, s3, v25
    v_mfma_f32_16x16x32_bf16 v[148:151], a[160:163], a[56:59], v[148:151]
    v_and_b32 v27, s3, v27
    v_add_f32 v12, v12, v18
    v_mfma_f32_16x16x32_bf16 v[156:159], a[160:163], a[60:63], v[156:159]
    v_add_f32 v13, v13, v19
    v_fmac_f32 v14, v18, v18
    v_mfma_f32_16x16x32_bf16 v[188:191], a[164:167], a[60:63], v[188:191]
    v_fmac_f32 v15, v19, v19
    v_add_f32 v12, v12, v25
    v_mfma_f32_16x16x32_bf16 v[180:183], a[164:167], a[56:59], v[180:183]
    v_add_f32 v13, v13, v27
    v_fmac_f32 v14, v25, v25
    v_mfma_f32_16x16x32_bf16 v[212:215], a[168:171], a[56:59], v[212:215]
    v_fmac_f32 v15, v27, v27
    v_mfma_f32_16x16x32_bf16 v[220:223], a[168:171], a[60:63], v[220:223]
    v_mfma_f32_16x16x32_bf16 v[252:255], a[172:175], a[60:63], v[252:255]
    v_mfma_f32_16x16x32_bf16 v[244:247], a[172:175], a[56:59], v[244:247]
    s_waitcnt vmcnt(22) lgkmcnt(0)
    v_mfma_f32_16x16x32_bf16 v[32:35], a[64:67], a[0:3], v[32:35]
    ds_read_b64_tr_b16 a[92:93], v10 offset:14464
    v_mfma_f32_16x16x32_bf16 v[40:43], a[64:67], a[4:7], v[40:43]
    ds_read_b64_tr_b16 a[94:95], v10 offset:18048
    v_mfma_f32_16x16x32_bf16 v[48:51], a[64:67], a[8:11], v[48:51]
    buffer_load_dwordx4 v[24:27], v16, s[44:47], s35 offen sc1
    v_mfma_f32_16x16x32_bf16 v[56:59], a[64:67], a[12:15], v[56:59]
    ds_read_b64_tr_b16 a[96:97], v10 offset:14496
    s_add_u32 s35, s35, 262144
    v_mfma_f32_16x16x32_bf16 v[88:91], a[68:71], a[12:15], v[88:91]
    ds_read_b64_tr_b16 a[98:99], v10 offset:18080
    v_mfma_f32_16x16x32_bf16 v[80:83], a[68:71], a[8:11], v[80:83]
    buffer_load_dwordx2 a[40:41], v8, s[44:47], s20 offen offset:256 sc1
    v_mfma_f32_16x16x32_bf16 v[72:75], a[68:71], a[4:7], v[72:75]
    ds_read_b64_tr_b16 a[100:101], v10 offset:14528
    v_mfma_f32_16x16x32_bf16 v[64:67], a[68:71], a[0:3], v[64:67]
    ds_read_b64_tr_b16 a[102:103], v10 offset:18112
    v_mfma_f32_16x16x32_bf16 v[96:99], a[72:75], a[0:3], v[96:99]
    buffer_load_dwordx2 a[42:43], v8, s[44:47], s21 offen offset:256 sc1
    v_mfma_f32_16x16x32_bf16 v[104:107], a[72:75], a[4:7], v[104:107]
    ds_read_b64_tr_b16 a[104:105], v10 offset:14560
    v_mfma_f32_16x16x32_bf16 v[112:115], a[72:75], a[8:11], v[112:115]
    ds_read_b64_tr_b16 a[106:107], v10 offset:18144
    v_mfma_f32_16x16x32_bf16 v[120:123], a[72:75], a[12:15], v[120:123]
    buffer_load_dwordx2 a[44:45], v8, s[44:47], s20 offen offset:384 sc1
    v_mfma_f32_16x16x32_bf16 v[152:155], a[76:79], a[12:15], v[152:155]
    ds_read_b64_tr_b16 a[108:109], v10 offset:14592
    v_mfma_f32_16x16x32_bf16 v[144:147], a[76:79], a[8:11], v[144:147]
    ds_read_b64_tr_b16 a[110:111], v10 offset:18176
    v_mfma_f32_16x16x32_bf16 v[136:139], a[76:79], a[4:7], v[136:139]
    buffer_load_dwordx2 a[46:47], v8, s[44:47], s21 offen offset:384 sc1
    v_mfma_f32_16x16x32_bf16 v[128:131], a[76:79], a[0:3], v[128:131]
    ds_read_b64_tr_b16 a[112:113], v10 offset:14624
    s_add_u32 s20, s20, 131072
    s_add_u32 s21, s20, 65536
    v_mfma_f32_16x16x32_bf16 v[160:163], a[80:83], a[0:3], v[160:163]
    ds_read_b64_tr_b16 a[114:115], v10 offset:18208
    v_mfma_f32_16x16x32_bf16 v[168:171], a[80:83], a[4:7], v[168:171]
    buffer_load_dwordx4 v3, s[4:7], s22 offen offset:2048  lds
    v_mfma_f32_16x16x32_bf16 v[176:179], a[80:83], a[8:11], v[176:179]
    ds_read_b64_tr_b16 a[116:117], v10 offset:14656
    v_mfma_f32_16x16x32_bf16 v[184:187], a[80:83], a[12:15], v[184:187]
    ds_read_b64_tr_b16 a[118:119], v10 offset:18240
    v_mfma_f32_16x16x32_bf16 v[216:219], a[84:87], a[12:15], v[216:219]
    buffer_load_dwordx4 v4, s[4:7], s22 offen offset:3072  lds
    v_mfma_f32_16x16x32_bf16 v[208:211], a[84:87], a[8:11], v[208:211]
    s_add_u32 s28, s24, s23
    v_mfma_f32_16x16x32_bf16 v[200:203], a[84:87], a[4:7], v[200:203]
    v_mfma_f32_16x16x32_bf16 v[192:195], a[84:87], a[0:3], v[192:195]
    s_sub_u32 s23, 57600, s23
    v_mfma_f32_16x16x32_bf16 v[224:227], a[88:91], a[0:3], v[224:227]
    v_mfma_f32_16x16x32_bf16 v[232:235], a[88:91], a[4:7], v[232:235]
    s_add_u32 s29, s24, s23
    v_mfma_f32_16x16x32_bf16 v[240:243], a[88:91], a[8:11], v[240:243]
    v_mfma_f32_16x16x32_bf16 v[248:251], a[88:91], a[12:15], v[248:251]
    s_waitcnt vmcnt(29) lgkmcnt(0)
    v_mfma_f32_16x16x32_bf16 v[36:39], a[92:95], a[0:3], v[36:39]
    ds_read_b64_tr_b16 a[64:65], v10 offset:7168
    v_mfma_f32_16x16x32_bf16 v[44:47], a[92:95], a[4:7], v[44:47]
    ds_read_b64_tr_b16 a[66:67], v10 offset:10752
    v_mfma_f32_16x16x32_bf16 v[52:55], a[92:95], a[8:11], v[52:55]
    buffer_load_dwordx2 a[48:49], v8, s[44:47], s20 offen offset:0 sc1
    v_mfma_f32_16x16x32_bf16 v[60:63], a[92:95], a[12:15], v[60:63]
    ds_read_b64_tr_b16 a[68:69], v10 offset:7200
    v_mfma_f32_16x16x32_bf16 v[92:95], a[96:99], a[12:15], v[92:95]
    ds_read_b64_tr_b16 a[70:71], v10 offset:10784
    v_mfma_f32_16x16x32_bf16 v[84:87], a[96:99], a[8:11], v[84:87]
    buffer_load_dwordx2 a[50:51], v8, s[44:47], s21 offen offset:0 sc1
    v_mfma_f32_16x16x32_bf16 v[76:79], a[96:99], a[4:7], v[76:79]
    ds_read_b64_tr_b16 a[72:73], v10 offset:7232
    v_mfma_f32_16x16x32_bf16 v[68:71], a[96:99], a[0:3], v[68:71]
    ds_read_b64_tr_b16 a[74:75], v10 offset:10816
    v_mfma_f32_16x16x32_bf16 v[100:103], a[100:103], a[0:3], v[100:103]
    buffer_load_dwordx2 a[52:53], v8, s[44:47], s20 offen offset:128 sc1
    v_mfma_f32_16x16x32_bf16 v[108:111], a[100:103], a[4:7], v[108:111]
    ds_read_b64_tr_b16 a[76:77], v10 offset:7264
    v_mfma_f32_16x16x32_bf16 v[116:119], a[100:103], a[8:11], v[116:119]
    ds_read_b64_tr_b16 a[78:79], v10 offset:10848
    v_mfma_f32_16x16x32_bf16 v[124:127], a[100:103], a[12:15], v[124:127]
    buffer_load_dwordx2 a[54:55], v8, s[44:47], s21 offen offset:128 sc1
    v_mfma_f32_16x16x32_bf16 v[156:159], a[104:107], a[12:15], v[156:159]
    ds_read_b64_tr_b16 a[80:81], v10 offset:7296
    v_mfma_f32_16x16x32_bf16 v[148:151], a[104:107], a[8:11], v[148:151]
    ds_read_b64_tr_b16 a[82:83], v10 offset:10880
    s_add_u32 m0, s29, 4096
    v_mfma_f32_16x16x32_bf16 v[140:143], a[104:107], a[4:7], v[140:143]
    buffer_load_dwordx4 v5, s[4:7], s22 offen offset:0  lds
    v_mfma_f32_16x16x32_bf16 v[132:135], a[104:107], a[0:3], v[132:135]
    ds_read_b64_tr_b16 a[84:85], v10 offset:7328
    v_mfma_f32_16x16x32_bf16 v[164:167], a[108:111], a[0:3], v[164:167]
    ds_read_b64_tr_b16 a[86:87], v10 offset:10912
    v_mfma_f32_16x16x32_bf16 v[172:175], a[108:111], a[4:7], v[172:175]
    buffer_load_dwordx4 v6, s[4:7], s22 offen offset:1024  lds
    v_mfma_f32_16x16x32_bf16 v[180:183], a[108:111], a[8:11], v[180:183]
    ds_read_b64_tr_b16 a[88:89], v10 offset:7360
    v_mfma_f32_16x16x32_bf16 v[188:191], a[108:111], a[12:15], v[188:191]
    ds_read_b64_tr_b16 a[90:91], v10 offset:10944
    v_mfma_f32_16x16x32_bf16 v[220:223], a[112:115], a[12:15], v[220:223]
    v_mfma_f32_16x16x32_bf16 v[212:215], a[112:115], a[8:11], v[212:215]
    v_mfma_f32_16x16x32_bf16 v[204:207], a[112:115], a[4:7], v[204:207]
    v_mfma_f32_16x16x32_bf16 v[196:199], a[112:115], a[0:3], v[196:199]
    v_mfma_f32_16x16x32_bf16 v[228:231], a[116:119], a[0:3], v[228:231]
    v_mfma_f32_16x16x32_bf16 v[236:239], a[116:119], a[4:7], v[236:239]
    v_mfma_f32_16x16x32_bf16 v[244:247], a[116:119], a[8:11], v[244:247]
    v_mfma_f32_16x16x32_bf16 v[252:255], a[116:119], a[12:15], v[252:255]
    s_waitcnt vmcnt(20) lgkmcnt(0)
    v_mfma_f32_16x16x32_bf16 v[32:35], a[64:67], a[16:19], v[32:35]
    ds_read_b64_tr_b16 a[92:93], v10 offset:21632
    v_lshlrev_b32 v18, 16, v20
    v_mfma_f32_16x16x32_bf16 v[40:43], a[64:67], a[20:23], v[40:43]
    ds_read_b64_tr_b16 a[94:95], v10 offset:25216
    v_lshlrev_b32 v19, 16, v22
    v_mfma_f32_16x16x32_bf16 v[48:51], a[64:67], a[24:27], v[48:51]
    buffer_load_dwordx2 a[56:57], v8, s[44:47], s20 offen offset:256 sc1
    v_mfma_f32_16x16x32_bf16 v[56:59], a[64:67], a[28:31], v[56:59]
    ds_read_b64_tr_b16 a[96:97], v10 offset:21664
    v_and_b32 v20, s3, v20
    v_mfma_f32_16x16x32_bf16 v[88:91], a[68:71], a[28:31], v[88:91]
    ds_read_b64_tr_b16 a[98:99], v10 offset:25248
    v_and_b32 v22, s3, v22
    v_mfma_f32_16x16x32_bf16 v[80:83], a[68:71], a[24:27], v[80:83]
    buffer_load_dwordx2 a[58:59], v8, s[44:47], s21 offen offset:256 sc1
    v_mfma_f32_16x16x32_bf16 v[72:75], a[68:71], a[20:23], v[72:75]
    ds_read_b64_tr_b16 a[100:101], v10 offset:21696
    v_add_f32 v12, v12, v18
    v_mfma_f32_16x16x32_bf16 v[64:67], a[68:71], a[16:19], v[64:67]
    ds_read_b64_tr_b16 a[102:103], v10 offset:25280
    v_add_f32 v13, v13, v19
    v_mfma_f32_16x16x32_bf16 v[96:99], a[72:75], a[16:19], v[96:99]
    buffer_load_dwordx2 a[60:61], v8, s[44:47], s20 offen offset:384 sc1
    v_mfma_f32_16x16x32_bf16 v[104:107], a[72:75], a[20:23], v[104:107]
    ds_read_b64_tr_b16 a[104:105], v10 offset:21728
    v_fmac_f32 v14, v18, v18
    v_mfma_f32_16x16x32_bf16 v[112:115], a[72:75], a[24:27], v[112:115]
    ds_read_b64_tr_b16 a[106:107], v10 offset:25312
    v_fmac_f32 v15, v19, v19
    v_mfma_f32_16x16x32_bf16 v[120:123], a[72:75], a[28:31], v[120:123]
    buffer_load_dwordx2 a[62:63], v8, s[44:47], s21 offen offset:384 sc1
    v_mfma_f32_16x16x32_bf16 v[152:155], a[76:79], a[28:31], v[152:155]
    ds_read_b64_tr_b16 a[108:109], v10 offset:21760
    s_add_u32 s20, s20, 131072
    s_cmp_eq_u32 s20, s17
    s_cselect_b32 s20, s26, s20
    s_add_u32 s21, s20, 65536
    v_mfma_f32_16x16x32_bf16 v[144:147], a[76:79], a[24:27], v[144:147]
    ds_read_b64_tr_b16 a[110:111], v10 offset:25344
    v_add_f32 v12, v12, v20
    v_mfma_f32_16x16x32_bf16 v[136:139], a[76:79], a[20:23], v[136:139]
    buffer_load_dwordx4 v7, s[4:7], s22 offen offset:2048  lds
    v_mfma_f32_16x16x32_bf16 v[128:131], a[76:79], a[16:19], v[128:131]
    ds_read_b64_tr_b16 a[112:113], v10 offset:21792
    s_add_u32 s22, s22, 458752
    v_mfma_f32_16x16x32_bf16 v[160:163], a[80:83], a[16:19], v[160:163]
    ds_read_b64_tr_b16 a[114:115], v10 offset:25376
    v_add_f32 v13, v13, v22
    v_mfma_f32_16x16x32_bf16 v[168:171], a[80:83], a[20:23], v[168:171]
    v_fmac_f32 v14, v20, v20
    v_fmac_f32 v15, v22, v22
    v_mfma_f32_16x16x32_bf16 v[176:179], a[80:83], a[24:27], v[176:179]
    ds_read_b64_tr_b16 a[116:117], v10 offset:21824
    v_lshlrev_b32 v18, 16, v21
    v_mfma_f32_16x16x32_bf16 v[184:187], a[80:83], a[28:31], v[184:187]
    ds_read_b64_tr_b16 a[118:119], v10 offset:25408
    v_lshlrev_b32 v19, 16, v23
    v_mfma_f32_16x16x32_bf16 v[216:219], a[84:87], a[28:31], v[216:219]
    v_and_b32 v21, s3, v21
    v_and_b32 v23, s3, v23
    v_mfma_f32_16x16x32_bf16 v[208:211], a[84:87], a[24:27], v[208:211]
    v_add_f32 v12, v12, v18
    v_add_f32 v13, v13, v19
    v_mfma_f32_16x16x32_bf16 v[200:203], a[84:87], a[20:23], v[200:203]
    v_fmac_f32 v14, v18, v18
    v_fmac_f32 v15, v19, v19
    v_mfma_f32_16x16x32_bf16 v[192:195], a[84:87], a[16:19], v[192:195]
    v_add_f32 v12, v12, v21
    v_add_f32 v13, v13, v23
    v_mfma_f32_16x16x32_bf16 v[224:227], a[88:91], a[16:19], v[224:227]
    v_fmac_f32 v14, v21, v21
    v_fmac_f32 v15, v23, v23
    v_mfma_f32_16x16x32_bf16 v[232:235], a[88:91], a[20:23], v[232:235]
    v_mfma_f32_16x16x32_bf16 v[240:243], a[88:91], a[24:27], v[240:243]
    v_mfma_f32_16x16x32_bf16 v[248:251], a[88:91], a[28:31], v[248:251]
    s_waitcnt vmcnt(17) lgkmcnt(0)
    s_barrier
    v_mfma_f32_16x16x32_bf16 v[36:39], a[92:95], a[16:19], v[36:39]
    ds_read_b64_tr_b16 a[64:65], v10 offset:28800
    v_lshlrev_b32 v18, 16, v24
    v_mfma_f32_16x16x32_bf16 v[44:47], a[92:95], a[20:23], v[44:47]
    ds_read_b64_tr_b16 a[66:67], v10 offset:32384
    v_lshlrev_b32 v19, 16, v26
    v_mfma_f32_16x16x32_bf16 v[52:55], a[92:95], a[24:27], v[52:55]
    buffer_load_dwordx2 a[0:1], v8, s[44:47], s20 offen offset:0 sc1
    v_mfma_f32_16x16x32_bf16 v[60:63], a[92:95], a[28:31], v[60:63]
    ds_read_b64_tr_b16 a[68:69], v10 offset:28832
    v_and_b32 v24, s3, v24
    v_mfma_f32_16x16x32_bf16 v[92:95], a[96:99], a[28:31], v[92:95]
    ds_read_b64_tr_b16 a[70:71], v10 offset:32416
    v_and_b32 v26, s3, v26
    v_mfma_f32_16x16x32_bf16 v[84:87], a[96:99], a[24:27], v[84:87]
    buffer_load_dwordx2 a[2:3], v8, s[44:47], s21 offen offset:0 sc1
    v_mfma_f32_16x16x32_bf16 v[76:79], a[96:99], a[20:23], v[76:79]
    ds_read_b64_tr_b16 a[72:73], v10 offset:28864
    v_add_f32 v12, v12, v18
    v_mfma_f32_16x16x32_bf16 v[68:71], a[96:99], a[16:19], v[68:71]
    ds_read_b64_tr_b16 a[74:75], v10 offset:32448
    v_add_f32 v13, v13, v19
    v_mfma_f32_16x16x32_bf16 v[100:103], a[100:103], a[16:19], v[100:103]
    buffer_load_dwordx2 a[4:5], v8, s[44:47], s20 offen offset:128 sc1
    v_mfma_f32_16x16x32_bf16 v[108:111], a[100:103], a[20:23], v[108:111]
    ds_read_b64_tr_b16 a[76:77], v10 offset:28896
    v_fmac_f32 v14, v18, v18
    v_mfma_f32_16x16x32_bf16 v[116:119], a[100:103], a[24:27], v[116:119]
    ds_read_b64_tr_b16 a[78:79], v10 offset:32480
    v_fmac_f32 v15, v19, v19
    v_mfma_f32_16x16x32_bf16 v[124:127], a[100:103], a[28:31], v[124:127]
    buffer_load_dwordx2 a[6:7], v8, s[44:47], s21 offen offset:128 sc1
    v_mfma_f32_16x16x32_bf16 v[156:159], a[104:107], a[28:31], v[156:159]
    ds_read_b64_tr_b16 a[80:81], v10 offset:28928
    v_add_f32 v12, v12, v24
    v_mfma_f32_16x16x32_bf16 v[148:151], a[104:107], a[24:27], v[148:151]
    ds_read_b64_tr_b16 a[82:83], v10 offset:32512
    s_add_u32 m0, s29, 28800
    v_mfma_f32_16x16x32_bf16 v[140:143], a[104:107], a[20:23], v[140:143]
    buffer_load_dwordx4 v1, s[4:7], s22 offen offset:0  lds
    v_mfma_f32_16x16x32_bf16 v[132:135], a[104:107], a[16:19], v[132:135]
    ds_read_b64_tr_b16 a[84:85], v10 offset:28960
    v_add_f32 v13, v13, v26
    v_mfma_f32_16x16x32_bf16 v[164:167], a[108:111], a[16:19], v[164:167]
    ds_read_b64_tr_b16 a[86:87], v10 offset:32544
    v_fmac_f32 v14, v24, v24
    v_mfma_f32_16x16x32_bf16 v[172:175], a[108:111], a[20:23], v[172:175]
    buffer_load_dwordx4 v2, s[4:7], s22 offen offset:1024  lds
    v_mfma_f32_16x16x32_bf16 v[180:183], a[108:111], a[24:27], v[180:183]
    ds_read_b64_tr_b16 a[88:89], v10 offset:28992
    v_fmac_f32 v15, v26, v26
    v_mfma_f32_16x16x32_bf16 v[188:191], a[108:111], a[28:31], v[188:191]
    ds_read_b64_tr_b16 a[90:91], v10 offset:32576
    v_lshlrev_b32 v18, 16, v25
    v_mfma_f32_16x16x32_bf16 v[220:223], a[112:115], a[28:31], v[220:223]
    v_lshlrev_b32 v19, 16, v27
    v_and_b32 v25, s3, v25
    v_mfma_f32_16x16x32_bf16 v[212:215], a[112:115], a[24:27], v[212:215]
    v_and_b32 v27, s3, v27
    v_add_f32 v12, v12, v18
    v_mfma_f32_16x16x32_bf16 v[204:207], a[112:115], a[20:23], v[204:207]
    v_add_f32 v13, v13, v19
    v_fmac_f32 v14, v18, v18
    v_mfma_f32_16x16x32_bf16 v[196:199], a[112:115], a[16:19], v[196:199]
    v_fmac_f32 v15, v19, v19
    v_add_f32 v12, v12, v25
    v_mfma_f32_16x16x32_bf16 v[228:231], a[116:119], a[16:19], v[228:231]
    v_add_f32 v13, v13, v27
    v_fmac_f32 v14, v25, v25
    v_mfma_f32_16x16x32_bf16 v[236:239], a[116:119], a[20:23], v[236:239]
    v_fmac_f32 v15, v27, v27
    v_mfma_f32_16x16x32_bf16 v[244:247], a[116:119], a[24:27], v[244:247]
    v_mfma_f32_16x16x32_bf16 v[252:255], a[116:119], a[28:31], v[252:255]
    s_waitcnt vmcnt(19) lgkmcnt(0)
    v_mfma_f32_16x16x32_bf16 v[32:35], a[64:67], a[32:35], v[32:35]
    ds_read_b64_tr_b16 a[92:93], v10 offset:43264
    v_add_f32_dpp v12, v12, v12 row_ror:4 row_mask:0xf bank_mask:0xf
    v_add_f32_dpp v13, v13, v13 row_ror:4 row_mask:0xf bank_mask:0xf
    v_mfma_f32_16x16x32_bf16 v[40:43], a[64:67], a[36:39], v[40:43]
    ds_read_b64_tr_b16 a[94:95], v10 offset:46848
    v_add_f32_dpp v14, v14, v14 row_ror:4 row_mask:0xf bank_mask:0xf
    v_add_f32_dpp v15, v15, v15 row_ror:4 row_mask:0xf bank_mask:0xf
    v_mfma_f32_16x16x32_bf16 v[48:51], a[64:67], a[40:43], v[48:51]
    buffer_load_dwordx2 a[8:9], v8, s[44:47], s20 offen offset:256 sc1
    v_add_f32_dpp v12, v12, v12 row_ror:8 row_mask:0xf bank_mask:0xf
    v_mfma_f32_16x16x32_bf16 v[56:59], a[64:67], a[44:47], v[56:59]
    ds_read_b64_tr_b16 a[96:97], v10 offset:43296
    v_add_f32_dpp v13, v13, v13 row_ror:8 row_mask:0xf bank_mask:0xf
    v_add_f32_dpp v14, v14, v14 row_ror:8 row_mask:0xf bank_mask:0xf
    v_mfma_f32_16x16x32_bf16 v[88:91], a[68:71], a[44:47], v[88:91]
    ds_read_b64_tr_b16 a[98:99], v10 offset:46880
    v_add_f32_dpp v15, v15, v15 row_ror:8 row_mask:0xf bank_mask:0xf
    v_mov_b32 v16, v12
    v_mfma_f32_16x16x32_bf16 v[80:83], a[68:71], a[40:43], v[80:83]
    buffer_load_dwordx2 a[10:11], v8, s[44:47], s21 offen offset:256 sc1
    v_mov_b32 v17, v13
    v_mfma_f32_16x16x32_bf16 v[72:75], a[68:71], a[36:39], v[72:75]
    ds_read_b64_tr_b16 a[100:101], v10 offset:43328
    v_mov_b32 v18, v14
    v_mov_b32 v19, v15
    v_mfma_f32_16x16x32_bf16 v[64:67], a[68:71], a[32:35], v[64:67]
    ds_read_b64_tr_b16 a[102:103], v10 offset:46912
    v_permlane16_swap_b32 v16, v12
    v_mfma_f32_16x16x32_bf16 v[96:99], a[72:75], a[32:35], v[96:99]
    buffer_load_dwordx2 a[12:13], v8, s[44:47], s20 offen offset:384 sc1
    v_mfma_f32_16x16x32_bf16 v[104:107], a[72:75], a[36:39], v[104:107]
    ds_read_b64_tr_b16 a[104:105], v10 offset:43360
    v_permlane16_swap_b32 v17, v13
    v_mfma_f32_16x16x32_bf16 v[112:115], a[72:75], a[40:43], v[112:115]
    ds_read_b64_tr_b16 a[106:107], v10 offset:46944
    v_permlane16_swap_b32 v18, v14
    v_mfma_f32_16x16x32_bf16 v[120:123], a[72:75], a[44:47], v[120:123]
    buffer_load_dwordx2 a[14:15], v8, s[44:47], s21 offen offset:384 sc1
    v_mfma_f32_16x16x32_bf16 v[152:155], a[76:79], a[44:47], v[152:155]
    ds_read_b64_tr_b16 a[108:109], v10 offset:43392
    s_add_u32 s20, s20, 131072
    s_add_u32 s21, s20, 65536
    v_mfma_f32_16x16x32_bf16 v[144:147], a[76:79], a[40:43], v[144:147]
    ds_read_b64_tr_b16 a[110:111], v10 offset:46976
    v_permlane16_swap_b32 v19, v15
    v_mfma_f32_16x16x32_bf16 v[136:139], a[76:79], a[36:39], v[136:139]
    buffer_load_dwordx4 v3, s[4:7], s22 offen offset:2048  lds
    v_add_f32 v12, v12, v16
    v_mfma_f32_16x16x32_bf16 v[128:131], a[76:79], a[32:35], v[128:131]
    ds_read_b64_tr_b16 a[112:113], v10 offset:43424
    v_add_f32 v13, v13, v17
    v_add_f32 v14, v14, v18
    v_mfma_f32_16x16x32_bf16 v[160:163], a[80:83], a[32:35], v[160:163]
    ds_read_b64_tr_b16 a[114:115], v10 offset:47008
    v_add_f32 v15, v15, v19
    v_mov_b32 v16, v12
    v_mfma_f32_16x16x32_bf16 v[168:171], a[80:83], a[36:39], v[168:171]
    buffer_load_dwordx4 v4, s[4:7], s22 offen offset:3072  lds
    v_mov_b32 v17, v13
    v_mfma_f32_16x16x32_bf16 v[176:179], a[80:83], a[40:43], v[176:179]
    ds_read_b64_tr_b16 a[116:117], v10 offset:43456
    v_mov_b32 v18, v14
    v_mov_b32 v19, v15
    v_mfma_f32_16x16x32_bf16 v[184:187], a[80:83], a[44:47], v[184:187]
    ds_read_b64_tr_b16 a[118:119], v10 offset:47040
    v_permlane32_swap_b32 v16, v12
    v_mfma_f32_16x16x32_bf16 v[216:219], a[84:87], a[44:47], v[216:219]
    v_permlane32_swap_b32 v17, v13
    v_mfma_f32_16x16x32_bf16 v[208:211], a[84:87], a[40:43], v[208:211]
    v_permlane32_swap_b32 v18, v14
    v_mfma_f32_16x16x32_bf16 v[200:203], a[84:87], a[36:39], v[200:203]
    v_permlane32_swap_b32 v19, v15
    v_add_f32 v12, v12, v16
    v_mfma_f32_16x16x32_bf16 v[192:195], a[84:87], a[32:35], v[192:195]
    v_add_f32 v13, v13, v17
    v_add_f32 v14, v14, v18
    v_add_f32 v15, v15, v19
    v_mfma_f32_16x16x32_bf16 v[224:227], a[88:91], a[32:35], v[224:227]
    ds_write_b128 v29, v[12:15]
    v_mfma_f32_16x16x32_bf16 v[232:235], a[88:91], a[36:39], v[232:235]
    v_mfma_f32_16x16x32_bf16 v[240:243], a[88:91], a[40:43], v[240:243]
    v_mfma_f32_16x16x32_bf16 v[248:251], a[88:91], a[44:47], v[248:251]
    s_waitcnt vmcnt(25) lgkmcnt(0)
    s_barrier
    s_cmp_lg_u32 s94, 0
    s_cbranch_scc1 L_mk_fl_24
    s_lshl_b32 s48, s2, 6
    s_add_u32 s48, s48, 49152
    v_mov_b32 v22, s92
    v_mov_b32 v23, s93
    v_mov_b32 v24, 0
    s_mov_b64 exec, 1
    buffer_store_dwordx2 v[22:23], v24, s[60:63], s48 offen sc1
    s_mov_b64 exec, -1
L_mk_fl_24:
    v_mfma_f32_16x16x32_bf16 v[36:39], a[92:95], a[32:35], v[36:39]
    ds_read_b64_tr_b16 a[64:65], v10 offset:35968
    v_mfma_f32_16x16x32_bf16 v[44:47], a[92:95], a[36:39], v[44:47]
    ds_read_b64_tr_b16 a[66:67], v10 offset:39552
    v_mfma_f32_16x16x32_bf16 v[52:55], a[92:95], a[40:43], v[52:55]
    buffer_load_dwordx2 a[16:17], v8, s[44:47], s20 offen offset:0 sc1
    v_mfma_f32_16x16x32_bf16 v[60:63], a[92:95], a[44:47], v[60:63]
    ds_read_b64_tr_b16 a[68:69], v10 offset:36000
    v_mfma_f32_16x16x32_bf16 v[92:95], a[96:99], a[44:47], v[92:95]
    ds_read_b64_tr_b16 a[70:71], v10 offset:39584
    v_mfma_f32_16x16x32_bf16 v[84:87], a[96:99], a[40:43], v[84:87]
    buffer_load_dwordx2 a[18:19], v8, s[44:47], s21 offen offset:0 sc1
    v_mfma_f32_16x16x32_bf16 v[76:79], a[96:99], a[36:39], v[76:79]
    ds_read_b64_tr_b16 a[72:73], v10 offset:36032
    v_mfma_f32_16x16x32_bf16 v[68:71], a[96:99], a[32:35], v[68:71]
    ds_read_b64_tr_b16 a[74:75], v10 offset:39616
    v_mfma_f32_16x16x32_bf16 v[100:103], a[100:103], a[32:35], v[100:103]
    buffer_load_dwordx2 a[20:21], v8, s[44:47], s20 offen offset:128 sc1
    v_mfma_f32_16x16x32_bf16 v[108:111], a[100:103], a[36:39], v[108:111]
    ds_read_b64_tr_b16 a[76:77], v10 offset:36064
    v_mfma_f32_16x16x32_bf16 v[116:119], a[100:103], a[40:43], v[116:119]
    ds_read_b64_tr_b16 a[78:79], v10 offset:39648
    v_mfma_f32_16x16x32_bf16 v[124:127], a[100:103], a[44:47], v[124:127]
    buffer_load_dwordx2 a[22:23], v8, s[44:47], s21 offen offset:128 sc1
    v_mfma_f32_16x16x32_bf16 v[156:159], a[104:107], a[44:47], v[156:159]
    ds_read_b64_tr_b16 a[80:81], v10 offset:36096
    v_mfma_f32_16x16x32_bf16 v[148:151], a[104:107], a[40:43], v[148:151]
    ds_read_b64_tr_b16 a[82:83], v10 offset:39680
    s_add_u32 m0, s29, 32896
    v_mfma_f32_16x16x32_bf16 v[140:143], a[104:107], a[36:39], v[140:143]
    buffer_load_dwordx4 v5, s[4:7], s22 offen offset:0  lds
    v_mfma_f32_16x16x32_bf16 v[132:135], a[104:107], a[32:35], v[132:135]
    ds_read_b64_tr_b16 a[84:85], v10 offset:36128
    v_mfma_f32_16x16x32_bf16 v[164:167], a[108:111], a[32:35], v[164:167]
    ds_read_b64_tr_b16 a[86:87], v10 offset:39712
    v_mfma_f32_16x16x32_bf16 v[172:175], a[108:111], a[36:39], v[172:175]
    buffer_load_dwordx4 v6, s[4:7], s22 offen offset:1024  lds
    v_mfma_f32_16x16x32_bf16 v[180:183], a[108:111], a[40:43], v[180:183]
    ds_read_b64_tr_b16 a[88:89], v10 offset:36160
    v_mfma_f32_16x16x32_bf16 v[188:191], a[108:111], a[44:47], v[188:191]
    ds_read_b64_tr_b16 a[90:91], v10 offset:39744
    v_mfma_f32_16x16x32_bf16 v[220:223], a[112:115], a[44:47], v[220:223]
    ds_read_b128 v[16:19], v29 offset:64
    ds_read_b128 v[20:23], v29 offset:128
    v_mfma_f32_16x16x32_bf16 v[212:215], a[112:115], a[40:43], v[212:215]
    ds_read_b128 v[24:27], v29 offset:192
    v_mfma_f32_16x16x32_bf16 v[204:207], a[112:115], a[36:39], v[204:207]
    v_mfma_f32_16x16x32_bf16 v[196:199], a[112:115], a[32:35], v[196:199]
    v_mfma_f32_16x16x32_bf16 v[228:231], a[116:119], a[32:35], v[228:231]
    v_mfma_f32_16x16x32_bf16 v[236:239], a[116:119], a[36:39], v[236:239]
    v_mfma_f32_16x16x32_bf16 v[244:247], a[116:119], a[40:43], v[244:247]
    v_mfma_f32_16x16x32_bf16 v[252:255], a[116:119], a[44:47], v[252:255]
    s_waitcnt vmcnt(19) lgkmcnt(0)
    v_mfma_f32_16x16x32_bf16 v[32:35], a[64:67], a[48:51], v[32:35]
    ds_read_b64_tr_b16 a[92:93], v10 offset:50432
    v_add_f32 v12, v12, v16
    v_add_f32 v13, v13, v17
    v_mfma_f32_16x16x32_bf16 v[40:43], a[64:67], a[52:55], v[40:43]
    ds_read_b64_tr_b16 a[94:95], v10 offset:54016
    v_add_f32 v14, v14, v18
    v_add_f32 v15, v15, v19
    v_mfma_f32_16x16x32_bf16 v[48:51], a[64:67], a[56:59], v[48:51]
    buffer_load_dwordx2 a[24:25], v8, s[44:47], s20 offen offset:256 sc1
    v_add_f32 v20, v20, v24
    v_mfma_f32_16x16x32_bf16 v[56:59], a[64:67], a[60:63], v[56:59]
    ds_read_b64_tr_b16 a[96:97], v10 offset:50464
    v_add_f32 v21, v21, v25
    v_add_f32 v22, v22, v26
    v_mfma_f32_16x16x32_bf16 v[88:91], a[68:71], a[60:63], v[88:91]
    ds_read_b64_tr_b16 a[98:99], v10 offset:54048
    v_add_f32 v23, v23, v27
    v_add_f32 v12, v12, v20
    v_mfma_f32_16x16x32_bf16 v[80:83], a[68:71], a[56:59], v[80:83]
    buffer_load_dwordx2 a[26:27], v8, s[44:47], s21 offen offset:256 sc1
    v_add_f32 v13, v13, v21
    v_mfma_f32_16x16x32_bf16 v[72:75], a[68:71], a[52:55], v[72:75]
    ds_read_b64_tr_b16 a[100:101], v10 offset:50496
    v_add_f32 v14, v14, v22
    v_add_f32 v15, v15, v23
    v_mfma_f32_16x16x32_bf16 v[64:67], a[68:71], a[48:51], v[64:67]
    ds_read_b64_tr_b16 a[102:103], v10 offset:54080
    v_mul_f32 v12, 0x3a800000, v12
    v_mul_f32 v13, 0x3a800000, v13
    v_mfma_f32_16x16x32_bf16 v[96:99], a[72:75], a[48:51], v[96:99]
    buffer_load_dwordx2 a[28:29], v8, s[44:47], s20 offen offset:384 sc1
    v_mul_f32 v14, 0x3a800000, v14
    v_mfma_f32_16x16x32_bf16 v[104:107], a[72:75], a[52:55], v[104:107]
    ds_read_b64_tr_b16 a[104:105], v10 offset:50528
    v_mul_f32 v15, 0x3a800000, v15
    v_fma_f32 v14, -v12, v12, v14
    v_mfma_f32_16x16x32_bf16 v[112:115], a[72:75], a[56:59], v[112:115]
    ds_read_b64_tr_b16 a[106:107], v10 offset:54112
    v_fma_f32 v15, -v13, v13, v15
    v_max_f32 v14, 0, v14
    v_mfma_f32_16x16x32_bf16 v[120:123], a[72:75], a[60:63], v[120:123]
    buffer_load_dwordx2 a[30:31], v8, s[44:47], s21 offen offset:384 sc1
    v_max_f32 v15, 0, v15
    v_mfma_f32_16x16x32_bf16 v[152:155], a[76:79], a[60:63], v[152:155]
    ds_read_b64_tr_b16 a[108:109], v10 offset:50560
    s_add_u32 s20, s20, 131072
    s_add_u32 s21, s20, 65536
    v_cvt_pk_bf16_f32 v16, v14, v15
    v_mfma_f32_16x16x32_bf16 v[144:147], a[76:79], a[56:59], v[144:147]
    ds_read_b64_tr_b16 a[110:111], v10 offset:54144
    v_lshlrev_b32 v14, 16, v16
    v_and_b32 v15, s3, v16
    v_mfma_f32_16x16x32_bf16 v[136:139], a[76:79], a[52:55], v[136:139]
    buffer_load_dwordx4 v7, s[4:7], s22 offen offset:2048  lds
    v_add_f32 v14, 0x3727c5ac, v14
    v_mfma_f32_16x16x32_bf16 v[128:131], a[76:79], a[48:51], v[128:131]
    ds_read_b64_tr_b16 a[112:113], v10 offset:50592
    s_add_u32 s22, s22, 458752
    s_cmp_eq_u32 s22, s19
    s_cselect_b32 s22, s18, s22
    v_mfma_f32_16x16x32_bf16 v[160:163], a[80:83], a[48:51], v[160:163]
    ds_read_b64_tr_b16 a[114:115], v10 offset:54176
    v_add_f32 v15, 0x3727c5ac, v15
    v_cvt_pk_bf16_f32 v16, v14, v15
    v_mfma_f32_16x16x32_bf16 v[168:171], a[80:83], a[52:55], v[168:171]
    v_lshlrev_b32 v14, 16, v16
    v_and_b32 v15, s3, v16
    v_mfma_f32_16x16x32_bf16 v[176:179], a[80:83], a[56:59], v[176:179]
    ds_read_b64_tr_b16 a[116:117], v10 offset:50624
    v_sqrt_f32 v14, v14
    v_mfma_f32_16x16x32_bf16 v[184:187], a[80:83], a[60:63], v[184:187]
    ds_read_b64_tr_b16 a[118:119], v10 offset:54208
    v_sqrt_f32 v15, v15
    v_mfma_f32_16x16x32_bf16 v[216:219], a[84:87], a[60:63], v[216:219]
    v_cvt_pk_bf16_f32 v16, v12, v13
    v_lshlrev_b32 v12, 16, v16
    v_and_b32 v13, s3, v16
    v_mfma_f32_16x16x32_bf16 v[208:211], a[84:87], a[56:59], v[208:211]
    v_cvt_pk_bf16_f32 v16, v14, v15
    v_lshlrev_b32 v14, 16, v16
    v_and_b32 v15, s3, v16
    v_mfma_f32_16x16x32_bf16 v[200:203], a[84:87], a[52:55], v[200:203]
    v_rcp_f32 v14, v14
    v_mfma_f32_16x16x32_bf16 v[192:195], a[84:87], a[48:51], v[192:195]
    v_rcp_f32 v15, v15
    s_nop 0
    v_mfma_f32_16x16x32_bf16 v[224:227], a[88:91], a[48:51], v[224:227]
    v_mfma_f32_16x16x32_bf16 v[232:235], a[88:91], a[52:55], v[232:235]
    v_mfma_f32_16x16x32_bf16 v[240:243], a[88:91], a[56:59], v[240:243]
    v_mfma_f32_16x16x32_bf16 v[248:251], a[88:91], a[60:63], v[248:251]
    s_waitcnt vmcnt(23) lgkmcnt(0)
    s_barrier
    v_mfma_f32_16x16x32_bf16 v[36:39], a[92:95], a[48:51], v[36:39]
    ds_read_b64_tr_b16 a[64:65], v11 offset:0
    v_cmp_gt_u32 vcc, 4, v30
    v_mfma_f32_16x16x32_bf16 v[44:47], a[92:95], a[52:55], v[44:47]
    ds_read_b64_tr_b16 a[66:67], v11 offset:3584
    v_and_b32 v29, 3, v30
    v_mfma_f32_16x16x32_bf16 v[52:55], a[92:95], a[56:59], v[52:55]
    buffer_load_dwordx2 a[32:33], v8, s[44:47], s20 offen offset:0 sc1
    v_mfma_f32_16x16x32_bf16 v[60:63], a[92:95], a[60:63], v[60:63]
    ds_read_b64_tr_b16 a[68:69], v11 offset:32
    v_lshlrev_b32 v29, 5, v29
    v_mfma_f32_16x16x32_bf16 v[92:95], a[96:99], a[60:63], v[92:95]
    ds_read_b64_tr_b16 a[70:71], v11 offset:3616
    v_bfe_u32 v21, v30, 2, 1
    v_mfma_f32_16x16x32_bf16 v[84:87], a[96:99], a[56:59], v[84:87]
    buffer_load_dwordx2 a[34:35], v8, s[44:47], s21 offen offset:0 sc1
    v_mfma_f32_16x16x32_bf16 v[76:79], a[96:99], a[52:55], v[76:79]
    ds_read_b64_tr_b16 a[72:73], v11 offset:64
    v_lshl_add_u32 v29, v21, 4, v29
    v_mfma_f32_16x16x32_bf16 v[68:71], a[96:99], a[48:51], v[68:71]
    ds_read_b64_tr_b16 a[74:75], v11 offset:3648
    v_cndmask_b32 v16, v13, v12, vcc
    v_mfma_f32_16x16x32_bf16 v[100:103], a[100:103], a[48:51], v[100:103]
    buffer_load_dwordx2 a[36:37], v8, s[44:47], s20 offen offset:128 sc1
    v_mfma_f32_16x16x32_bf16 v[108:111], a[100:103], a[52:55], v[108:111]
    ds_read_b64_tr_b16 a[76:77], v11 offset:96
    v_cndmask_b32 v17, v15, v14, vcc
    v_mfma_f32_16x16x32_bf16 v[116:119], a[100:103], a[56:59], v[116:119]
    ds_read_b64_tr_b16 a[78:79], v11 offset:3680
    v_cmp_gt_u32 vcc, 8, v0
    v_mfma_f32_16x16x32_bf16 v[124:127], a[100:103], a[60:63], v[124:127]
    buffer_load_dwordx2 a[38:39], v8, s[44:47], s21 offen offset:128 sc1
    v_mfma_f32_16x16x32_bf16 v[156:159], a[104:107], a[60:63], v[156:159]
    ds_read_b64_tr_b16 a[80:81], v11 offset:128
    v_mov_b32 v18, s92
    v_mfma_f32_16x16x32_bf16 v[148:151], a[104:107], a[56:59], v[148:151]
    ds_read_b64_tr_b16 a[82:83], v11 offset:3712
    s_add_u32 m0, s28, 0
    v_mfma_f32_16x16x32_bf16 v[140:143], a[104:107], a[52:55], v[140:143]
    buffer_load_dwordx4 v1, s[4:7], s22 offen offset:0  lds
    v_mfma_f32_16x16x32_bf16 v[132:135], a[104:107], a[48:51], v[132:135]
    ds_read_b64_tr_b16 a[84:85], v11 offset:160
    v_mov_b32 v19, s93
    v_mfma_f32_16x16x32_bf16 v[164:167], a[108:111], a[48:51], v[164:167]
    ds_read_b64_tr_b16 a[86:87], v11 offset:3744
    v_mov_b32 v21, 0x7fff0000
    v_mfma_f32_16x16x32_bf16 v[172:175], a[108:111], a[52:55], v[172:175]
    buffer_load_dwordx4 v2, s[4:7], s22 offen offset:1024  lds
    v_mfma_f32_16x16x32_bf16 v[180:183], a[108:111], a[56:59], v[180:183]
    ds_read_b64_tr_b16 a[88:89], v11 offset:192
    v_cndmask_b32 v21, v21, v29, vcc
    v_mfma_f32_16x16x32_bf16 v[188:191], a[108:111], a[60:63], v[188:191]
    ds_read_b64_tr_b16 a[90:91], v11 offset:3776
    s_lshl_b32 s48, s31, 4
    v_mfma_f32_16x16x32_bf16 v[220:223], a[112:115], a[60:63], v[220:223]
    buffer_store_dwordx4 v[16:19], v21, s[36:39], s48 offen sc1
    v_mfma_f32_16x16x32_bf16 v[212:215], a[112:115], a[56:59], v[212:215]
    v_swap_b32 v10, v11
    v_lshlrev_b32 v29, 4, v0
    v_mfma_f32_16x16x32_bf16 v[204:207], a[112:115], a[52:55], v[204:207]
    v_and_b32 v26, 15, v30
    v_lshlrev_b32 v26, 4, v26
    v_mfma_f32_16x16x32_bf16 v[196:199], a[112:115], a[48:51], v[196:199]
    v_lshrrev_b32_e64 v27, 4, v30
    v_lshl_add_u32 v26, v27, 11, v26
    v_mfma_f32_16x16x32_bf16 v[228:231], a[116:119], a[48:51], v[228:231]
    v_and_b32 v27, 7, v30
    v_lshlrev_b32 v27, 9, v27
    v_mfma_f32_16x16x32_bf16 v[236:239], a[116:119], a[52:55], v[236:239]
    s_and_b32 s48, s2, 0xc7
    s_lshl_b32 s48, s48, 6
    s_add_u32 s48, s48, 49152
    v_mfma_f32_16x16x32_bf16 v[244:247], a[116:119], a[56:59], v[244:247]
    v_add_u32 v27, s48, v27
    v_mfma_f32_16x16x32_bf16 v[252:255], a[116:119], a[60:63], v[252:255]
    s_getpc_b64 s[56:57]
L_cpf2:
    s_mov_b32 s58, 29664
    s_mov_b32 s59, 0x20000
    s_bfe_u32 s50, s2, 0x30003
    s_lshl_b32 s50, s50, 12
L_mk_g1loop_25:
    s_waitcnt vmcnt(19) lgkmcnt(0)
    v_mfma_f32_16x16x32_bf16 v[32:35], a[64:67], a[0:3], v[32:35]
    ds_read_b64_tr_b16 a[92:93], v10 offset:14464
    v_mfma_f32_16x16x32_bf16 v[40:43], a[64:67], a[4:7], v[40:43]
    ds_read_b64_tr_b16 a[94:95], v10 offset:18048
    v_mfma_f32_16x16x32_bf16 v[48:51], a[64:67], a[8:11], v[48:51]
    buffer_load_dwordx2 a[40:41], v8, s[44:47], s20 offen offset:256 sc1
    v_mfma_f32_16x16x32_bf16 v[56:59], a[64:67], a[12:15], v[56:59]
    ds_read_b64_tr_b16 a[96:97], v10 offset:14496
    v_mfma_f32_16x16x32_bf16 v[88:91], a[68:71], a[12:15], v[88:91]
    ds_read_b64_tr_b16 a[98:99], v10 offset:18080
    v_mfma_f32_16x16x32_bf16 v[80:83], a[68:71], a[8:11], v[80:83]
    buffer_load_dwordx2 a[42:43], v8, s[44:47], s21 offen offset:256 sc1
    v_mfma_f32_16x16x32_bf16 v[72:75], a[68:71], a[4:7], v[72:75]
    ds_read_b64_tr_b16 a[100:101], v10 offset:14528
    v_mfma_f32_16x16x32_bf16 v[64:67], a[68:71], a[0:3], v[64:67]
    ds_read_b64_tr_b16 a[102:103], v10 offset:18112
    v_mfma_f32_16x16x32_bf16 v[96:99], a[72:75], a[0:3], v[96:99]
    buffer_load_dwordx2 a[44:45], v8, s[44:47], s20 offen offset:384 sc1
    v_mfma_f32_16x16x32_bf16 v[104:107], a[72:75], a[4:7], v[104:107]
    ds_read_b64_tr_b16 a[104:105], v10 offset:14560
    v_mfma_f32_16x16x32_bf16 v[112:115], a[72:75], a[8:11], v[112:115]
    ds_read_b64_tr_b16 a[106:107], v10 offset:18144
    v_mfma_f32_16x16x32_bf16 v[120:123], a[72:75], a[12:15], v[120:123]
    buffer_load_dwordx2 a[46:47], v8, s[44:47], s21 offen offset:384 sc1
    v_mfma_f32_16x16x32_bf16 v[152:155], a[76:79], a[12:15], v[152:155]
    ds_read_b64_tr_b16 a[108:109], v10 offset:14592
    s_add_u32 s20, s20, 131072
    s_add_u32 s21, s20, 65536
    v_mfma_f32_16x16x32_bf16 v[144:147], a[76:79], a[8:11], v[144:147]
    ds_read_b64_tr_b16 a[110:111], v10 offset:18176
    v_mfma_f32_16x16x32_bf16 v[136:139], a[76:79], a[4:7], v[136:139]
    buffer_load_dwordx4 v3, s[4:7], s22 offen offset:2048  lds
    v_mfma_f32_16x16x32_bf16 v[128:131], a[76:79], a[0:3], v[128:131]
    ds_read_b64_tr_b16 a[112:113], v10 offset:14624
    v_mfma_f32_16x16x32_bf16 v[160:163], a[80:83], a[0:3], v[160:163]
    ds_read_b64_tr_b16 a[114:115], v10 offset:18208
    v_mfma_f32_16x16x32_bf16 v[168:171], a[80:83], a[4:7], v[168:171]
    buffer_load_dwordx4 v4, s[4:7], s22 offen offset:3072  lds
    v_mfma_f32_16x16x32_bf16 v[176:179], a[80:83], a[8:11], v[176:179]
    ds_read_b64_tr_b16 a[116:117], v10 offset:14656
    v_mfma_f32_16x16x32_bf16 v[184:187], a[80:83], a[12:15], v[184:187]
    ds_read_b64_tr_b16 a[118:119], v10 offset:18240
    v_mfma_f32_16x16x32_bf16 v[216:219], a[84:87], a[12:15], v[216:219]
    v_mfma_f32_16x16x32_bf16 v[208:211], a[84:87], a[8:11], v[208:211]
    s_add_u32 s28, s24, s23
    v_mfma_f32_16x16x32_bf16 v[200:203], a[84:87], a[4:7], v[200:203]
    v_mfma_f32_16x16x32_bf16 v[192:195], a[84:87], a[0:3], v[192:195]
    s_sub_u32 s23, 57600, s23
    v_mfma_f32_16x16x32_bf16 v[224:227], a[88:91], a[0:3], v[224:227]
    v_mfma_f32_16x16x32_bf16 v[232:235], a[88:91], a[4:7], v[232:235]
    s_add_u32 s29, s24, s23
    v_mfma_f32_16x16x32_bf16 v[240:243], a[88:91], a[8:11], v[240:243]
    v_mfma_f32_16x16x32_bf16 v[248:251], a[88:91], a[12:15], v[248:251]
    s_waitcnt vmcnt(25) lgkmcnt(0)
    v_mfma_f32_16x16x32_bf16 v[36:39], a[92:95], a[0:3], v[36:39]
    ds_read_b64_tr_b16 a[64:65], v10 offset:7168
    v_mfma_f32_16x16x32_bf16 v[44:47], a[92:95], a[4:7], v[44:47]
    ds_read_b64_tr_b16 a[66:67], v10 offset:10752
    v_mfma_f32_16x16x32_bf16 v[52:55], a[92:95], a[8:11], v[52:55]
    buffer_load_dwordx2 a[48:49], v8, s[44:47], s20 offen offset:0 sc1
    v_mfma_f32_16x16x32_bf16 v[60:63], a[92:95], a[12:15], v[60:63]
    ds_read_b64_tr_b16 a[68:69], v10 offset:7200
    v_mfma_f32_16x16x32_bf16 v[92:95], a[96:99], a[12:15], v[92:95]
    ds_read_b64_tr_b16 a[70:71], v10 offset:10784
    v_mfma_f32_16x16x32_bf16 v[84:87], a[96:99], a[8:11], v[84:87]
    buffer_load_dwordx2 a[50:51], v8, s[44:47], s21 offen offset:0 sc1
    v_mfma_f32_16x16x32_bf16 v[76:79], a[96:99], a[4:7], v[76:79]
    ds_read_b64_tr_b16 a[72:73], v10 offset:7232
    v_mfma_f32_16x16x32_bf16 v[68:71], a[96:99], a[0:3], v[68:71]
    ds_read_b64_tr_b16 a[74:75], v10 offset:10816
    v_mfma_f32_16x16x32_bf16 v[100:103], a[100:103], a[0:3], v[100:103]
    buffer_load_dwordx2 a[52:53], v8, s[44:47], s20 offen offset:128 sc1
    v_mfma_f32_16x16x32_bf16 v[108:111], a[100:103], a[4:7], v[108:111]
    ds_read_b64_tr_b16 a[76:77], v10 offset:7264
    v_mfma_f32_16x16x32_bf16 v[116:119], a[100:103], a[8:11], v[116:119]
    ds_read_b64_tr_b16 a[78:79], v10 offset:10848
    v_mfma_f32_16x16x32_bf16 v[124:127], a[100:103], a[12:15], v[124:127]
    buffer_load_dwordx2 a[54:55], v8, s[44:47], s21 offen offset:128 sc1
    v_mfma_f32_16x16x32_bf16 v[156:159], a[104:107], a[12:15], v[156:159]
    ds_read_b64_tr_b16 a[80:81], v10 offset:7296
    v_mfma_f32_16x16x32_bf16 v[148:151], a[104:107], a[8:11], v[148:151]
    ds_read_b64_tr_b16 a[82:83], v10 offset:10880
    s_add_u32 m0, s29, 4096
    v_mfma_f32_16x16x32_bf16 v[140:143], a[104:107], a[4:7], v[140:143]
    buffer_load_dwordx4 v5, s[4:7], s22 offen offset:0  lds
    v_mfma_f32_16x16x32_bf16 v[132:135], a[104:107], a[0:3], v[132:135]
    ds_read_b64_tr_b16 a[84:85], v10 offset:7328
    v_mfma_f32_16x16x32_bf16 v[164:167], a[108:111], a[0:3], v[164:167]
    ds_read_b64_tr_b16 a[86:87], v10 offset:10912
    v_mfma_f32_16x16x32_bf16 v[172:175], a[108:111], a[4:7], v[172:175]
    buffer_load_dwordx4 v6, s[4:7], s22 offen offset:1024  lds
    v_mfma_f32_16x16x32_bf16 v[180:183], a[108:111], a[8:11], v[180:183]
    ds_read_b64_tr_b16 a[88:89], v10 offset:7360
    v_mfma_f32_16x16x32_bf16 v[188:191], a[108:111], a[12:15], v[188:191]
    ds_read_b64_tr_b16 a[90:91], v10 offset:10944
    v_mfma_f32_16x16x32_bf16 v[220:223], a[112:115], a[12:15], v[220:223]
    buffer_load_dwordx2 a[252:253], v27, s[60:63], 0 offen sc1
    v_mfma_f32_16x16x32_bf16 v[212:215], a[112:115], a[8:11], v[212:215]
    v_mfma_f32_16x16x32_bf16 v[204:207], a[112:115], a[4:7], v[204:207]
    v_mfma_f32_16x16x32_bf16 v[196:199], a[112:115], a[0:3], v[196:199]
    v_mfma_f32_16x16x32_bf16 v[228:231], a[116:119], a[0:3], v[228:231]
    v_mfma_f32_16x16x32_bf16 v[236:239], a[116:119], a[4:7], v[236:239]
    v_mfma_f32_16x16x32_bf16 v[244:247], a[116:119], a[8:11], v[244:247]
    v_mfma_f32_16x16x32_bf16 v[252:255], a[116:119], a[12:15], v[252:255]
    s_waitcnt vmcnt(20) lgkmcnt(0)
    v_mfma_f32_16x16x32_bf16 v[32:35], a[64:67], a[16:19], v[32:35]
    ds_read_b64_tr_b16 a[92:93], v10 offset:21632
    v_mfma_f32_16x16x32_bf16 v[40:43], a[64:67], a[20:23], v[40:43]
    ds_read_b64_tr_b16 a[94:95], v10 offset:25216
    v_mfma_f32_16x16x32_bf16 v[48:51], a[64:67], a[24:27], v[48:51]
    buffer_load_dwordx2 a[56:57], v8, s[44:47], s20 offen offset:256 sc1
    v_mfma_f32_16x16x32_bf16 v[56:59], a[64:67], a[28:31], v[56:59]
    ds_read_b64_tr_b16 a[96:97], v10 offset:21664
    v_mfma_f32_16x16x32_bf16 v[88:91], a[68:71], a[28:31], v[88:91]
    ds_read_b64_tr_b16 a[98:99], v10 offset:25248
    v_mfma_f32_16x16x32_bf16 v[80:83], a[68:71], a[24:27], v[80:83]
    buffer_load_dwordx2 a[58:59], v8, s[44:47], s21 offen offset:256 sc1
    v_mfma_f32_16x16x32_bf16 v[72:75], a[68:71], a[20:23], v[72:75]
    ds_read_b64_tr_b16 a[100:101], v10 offset:21696
    v_mfma_f32_16x16x32_bf16 v[64:67], a[68:71], a[16:19], v[64:67]
    ds_read_b64_tr_b16 a[102:103], v10 offset:25280
    v_mfma_f32_16x16x32_bf16 v[96:99], a[72:75], a[16:19], v[96:99]
    buffer_load_dwordx2 a[60:61], v8, s[44:47], s20 offen offset:384 sc1
    v_mfma_f32_16x16x32_bf16 v[104:107], a[72:75], a[20:23], v[104:107]
    ds_read_b64_tr_b16 a[104:105], v10 offset:21728
    v_mfma_f32_16x16x32_bf16 v[112:115], a[72:75], a[24:27], v[112:115]
    ds_read_b64_tr_b16 a[106:107], v10 offset:25312
    v_mfma_f32_16x16x32_bf16 v[120:123], a[72:75], a[28:31], v[120:123]
    buffer_load_dwordx2 a[62:63], v8, s[44:47], s21 offen offset:384 sc1
    v_mfma_f32_16x16x32_bf16 v[152:155], a[76:79], a[28:31], v[152:155]
    ds_read_b64_tr_b16 a[108:109], v10 offset:21760
    s_add_u32 s20, s20, 131072
    s_cmp_eq_u32 s20, s17
    s_cselect_b32 s20, s26, s20
    s_add_u32 s21, s20, 65536
    v_mfma_f32_16x16x32_bf16 v[144:147], a[76:79], a[24:27], v[144:147]
    ds_read_b64_tr_b16 a[110:111], v10 offset:25344
    v_mfma_f32_16x16x32_bf16 v[136:139], a[76:79], a[20:23], v[136:139]
    buffer_load_dwordx4 v7, s[4:7], s22 offen offset:2048  lds
    v_mfma_f32_16x16x32_bf16 v[128:131], a[76:79], a[16:19], v[128:131]
    ds_read_b64_tr_b16 a[112:113], v10 offset:21792
    s_add_u32 s22, s22, 458752
    v_mfma_f32_16x16x32_bf16 v[160:163], a[80:83], a[16:19], v[160:163]
    ds_read_b64_tr_b16 a[114:115], v10 offset:25376
    v_mfma_f32_16x16x32_bf16 v[168:171], a[80:83], a[20:23], v[168:171]
    v_mfma_f32_16x16x32_bf16 v[176:179], a[80:83], a[24:27], v[176:179]
    ds_read_b64_tr_b16 a[116:117], v10 offset:21824
    v_mfma_f32_16x16x32_bf16 v[184:187], a[80:83], a[28:31], v[184:187]
    ds_read_b64_tr_b16 a[118:119], v10 offset:25408
    v_mfma_f32_16x16x32_bf16 v[216:219], a[84:87], a[28:31], v[216:219]
    v_mfma_f32_16x16x32_bf16 v[208:211], a[84:87], a[24:27], v[208:211]
    v_mfma_f32_16x16x32_bf16 v[200:203], a[84:87], a[20:23], v[200:203]
    v_mfma_f32_16x16x32_bf16 v[192:195], a[84:87], a[16:19], v[192:195]
    v_mfma_f32_16x16x32_bf16 v[224:227], a[88:91], a[16:19], v[224:227]
    v_mfma_f32_16x16x32_bf16 v[232:235], a[88:91], a[20:23], v[232:235]
    v_mfma_f32_16x16x32_bf16 v[240:243], a[88:91], a[24:27], v[240:243]
    v_mfma_f32_16x16x32_bf16 v[248:251], a[88:91], a[28:31], v[248:251]
    s_waitcnt vmcnt(24) lgkmcnt(0)
    s_barrier
    v_mfma_f32_16x16x32_bf16 v[36:39], a[92:95], a[16:19], v[36:39]
    ds_read_b64_tr_b16 a[64:65], v10 offset:28800
    v_mfma_f32_16x16x32_bf16 v[44:47], a[92:95], a[20:23], v[44:47]
    ds_read_b64_tr_b16 a[66:67], v10 offset:32384
    v_mfma_f32_16x16x32_bf16 v[52:55], a[92:95], a[24:27], v[52:55]
    buffer_load_dwordx2 a[0:1], v8, s[44:47], s20 offen offset:0 sc1
    v_mfma_f32_16x16x32_bf16 v[60:63], a[92:95], a[28:31], v[60:63]
    ds_read_b64_tr_b16 a[68:69], v10 offset:28832
    v_mfma_f32_16x16x32_bf16 v[92:95], a[96:99], a[28:31], v[92:95]
    ds_read_b64_tr_b16 a[70:71], v10 offset:32416
    v_mfma_f32_16x16x32_bf16 v[84:87], a[96:99], a[24:27], v[84:87]
    buffer_load_dwordx2 a[2:3], v8, s[44:47], s21 offen offset:0 sc1
    v_mfma_f32_16x16x32_bf16 v[76:79], a[96:99], a[20:23], v[76:79]
    ds_read_b64_tr_b16 a[72:73], v10 offset:28864
    v_mfma_f32_16x16x32_bf16 v[68:71], a[96:99], a[16:19], v[68:71]
    ds_read_b64_tr_b16 a[74:75], v10 offset:32448
    v_mfma_f32_16x16x32_bf16 v[100:103], a[100:103], a[16:19], v[100:103]
    buffer_load_dwordx2 a[4:5], v8, s[44:47], s20 offen offset:128 sc1
    v_mfma_f32_16x16x32_bf16 v[108:111], a[100:103], a[20:23], v[108:111]
    ds_read_b64_tr_b16 a[76:77], v10 offset:28896
    v_mfma_f32_16x16x32_bf16 v[116:119], a[100:103], a[24:27], v[116:119]
    ds_read_b64_tr_b16 a[78:79], v10 offset:32480
    v_mfma_f32_16x16x32_bf16 v[124:127], a[100:103], a[28:31], v[124:127]
    buffer_load_dwordx2 a[6:7], v8, s[44:47], s21 offen offset:128 sc1
    v_mfma_f32_16x16x32_bf16 v[156:159], a[104:107], a[28:31], v[156:159]
    ds_read_b64_tr_b16 a[80:81], v10 offset:28928
    v_mfma_f32_16x16x32_bf16 v[148:151], a[104:107], a[24:27], v[148:151]
    ds_read_b64_tr_b16 a[82:83], v10 offset:32512
    s_add_u32 m0, s29, 28800
    v_mfma_f32_16x16x32_bf16 v[140:143], a[104:107], a[20:23], v[140:143]
    buffer_load_dwordx4 v1, s[4:7], s22 offen offset:0  lds
    v_mfma_f32_16x16x32_bf16 v[132:135], a[104:107], a[16:19], v[132:135]
    ds_read_b64_tr_b16 a[84:85], v10 offset:28960
    v_mfma_f32_16x16x32_bf16 v[164:167], a[108:111], a[16:19], v[164:167]
    ds_read_b64_tr_b16 a[86:87], v10 offset:32544
    v_mfma_f32_16x16x32_bf16 v[172:175], a[108:111], a[20:23], v[172:175]
    buffer_load_dwordx4 v2, s[4:7], s22 offen offset:1024  lds
    v_mfma_f32_16x16x32_bf16 v[180:183], a[108:111], a[24:27], v[180:183]
    ds_read_b64_tr_b16 a[88:89], v10 offset:28992
    v_mfma_f32_16x16x32_bf16 v[188:191], a[108:111], a[28:31], v[188:191]
    ds_read_b64_tr_b16 a[90:91], v10 offset:32576
    v_mfma_f32_16x16x32_bf16 v[220:223], a[112:115], a[28:31], v[220:223]
    v_mfma_f32_16x16x32_bf16 v[212:215], a[112:115], a[24:27], v[212:215]
    v_mfma_f32_16x16x32_bf16 v[204:207], a[112:115], a[20:23], v[204:207]
    v_mfma_f32_16x16x32_bf16 v[196:199], a[112:115], a[16:19], v[196:199]
    v_mfma_f32_16x16x32_bf16 v[228:231], a[116:119], a[16:19], v[228:231]
    v_mfma_f32_16x16x32_bf16 v[236:239], a[116:119], a[20:23], v[236:239]
    v_mfma_f32_16x16x32_bf16 v[244:247], a[116:119], a[24:27], v[244:247]
    v_mfma_f32_16x16x32_bf16 v[252:255], a[116:119], a[28:31], v[252:255]
    s_waitcnt vmcnt(20) lgkmcnt(0)
    v_mfma_f32_16x16x32_bf16 v[32:35], a[64:67], a[32:35], v[32:35]
    ds_read_b64_tr_b16 a[92:93], v10 offset:43264
    v_mfma_f32_16x16x32_bf16 v[40:43], a[64:67], a[36:39], v[40:43]
    ds_read_b64_tr_b16 a[94:95], v10 offset:46848
    v_mfma_f32_16x16x32_bf16 v[48:51], a[64:67], a[40:43], v[48:51]
    buffer_load_dwordx2 a[8:9], v8, s[44:47], s20 offen offset:256 sc1
    v_mfma_f32_16x16x32_bf16 v[56:59], a[64:67], a[44:47], v[56:59]
    ds_read_b64_tr_b16 a[96:97], v10 offset:43296
    v_mfma_f32_16x16x32_bf16 v[88:91], a[68:71], a[44:47], v[88:91]
    ds_read_b64_tr_b16 a[98:99], v10 offset:46880
    v_mfma_f32_16x16x32_bf16 v[80:83], a[68:71], a[40:43], v[80:83]
    buffer_load_dwordx2 a[10:11], v8, s[44:47], s21 offen offset:256 sc1
    v_mfma_f32_16x16x32_bf16 v[72:75], a[68:71], a[36:39], v[72:75]
    ds_read_b64_tr_b16 a[100:101], v10 offset:43328
    v_mfma_f32_16x16x32_bf16 v[64:67], a[68:71], a[32:35], v[64:67]
    ds_read_b64_tr_b16 a[102:103], v10 offset:46912
    v_mfma_f32_16x16x32_bf16 v[96:99], a[72:75], a[32:35], v[96:99]
    buffer_load_dwordx2 a[12:13], v8, s[44:47], s20 offen offset:384 sc1
    v_mfma_f32_16x16x32_bf16 v[104:107], a[72:75], a[36:39], v[104:107]
    ds_read_b64_tr_b16 a[104:105], v10 offset:43360
    v_mfma_f32_16x16x32_bf16 v[112:115], a[72:75], a[40:43], v[112:115]
    ds_read_b64_tr_b16 a[106:107], v10 offset:46944
    v_mfma_f32_16x16x32_bf16 v[120:123], a[72:75], a[44:47], v[120:123]
    buffer_load_dwordx2 a[14:15], v8, s[44:47], s21 offen offset:384 sc1
    v_mfma_f32_16x16x32_bf16 v[152:155], a[76:79], a[44:47], v[152:155]
    ds_read_b64_tr_b16 a[108:109], v10 offset:43392
    s_add_u32 s20, s20, 131072
    s_add_u32 s21, s20, 65536
    v_mfma_f32_16x16x32_bf16 v[144:147], a[76:79], a[40:43], v[144:147]
    ds_read_b64_tr_b16 a[110:111], v10 offset:46976
    v_mfma_f32_16x16x32_bf16 v[136:139], a[76:79], a[36:39], v[136:139]
    buffer_load_dwordx4 v3, s[4:7], s22 offen offset:2048  lds
    v_mfma_f32_16x16x32_bf16 v[128:131], a[76:79], a[32:35], v[128:131]
    ds_read_b64_tr_b16 a[112:113], v10 offset:43424
    v_mfma_f32_16x16x32_bf16 v[160:163], a[80:83], a[32:35], v[160:163]
    ds_read_b64_tr_b16 a[114:115], v10 offset:47008
    v_mfma_f32_16x16x32_bf16 v[168:171], a[80:83], a[36:39], v[168:171]
    buffer_load_dwordx4 v4, s[4:7], s22 offen offset:3072  lds
    v_mfma_f32_16x16x32_bf16 v[176:179], a[80:83], a[40:43], v[176:179]
    ds_read_b64_tr_b16 a[116:117], v10 offset:43456
    v_mfma_f32_16x16x32_bf16 v[184:187], a[80:83], a[44:47], v[184:187]
    ds_read_b64_tr_b16 a[118:119], v10 offset:47040
    v_mfma_f32_16x16x32_bf16 v[216:219], a[84:87], a[44:47], v[216:219]
    v_mfma_f32_16x16x32_bf16 v[208:211], a[84:87], a[40:43], v[208:211]
    v_mfma_f32_16x16x32_bf16 v[200:203], a[84:87], a[36:39], v[200:203]
    v_mfma_f32_16x16x32_bf16 v[192:195], a[84:87], a[32:35], v[192:195]
    v_mfma_f32_16x16x32_bf16 v[224:227], a[88:91], a[32:35], v[224:227]
    v_mfma_f32_16x16x32_bf16 v[232:235], a[88:91], a[36:39], v[232:235]
    v_mfma_f32_16x16x32_bf16 v[240:243], a[88:91], a[40:43], v[240:243]
    v_mfma_f32_16x16x32_bf16 v[248:251], a[88:91], a[44:47], v[248:251]
    s_waitcnt vmcnt(26) lgkmcnt(0)
    v_mfma_f32_16x16x32_bf16 v[36:39], a[92:95], a[32:35], v[36:39]
    ds_read_b64_tr_b16 a[64:65], v10 offset:35968
    v_mfma_f32_16x16x32_bf16 v[44:47], a[92:95], a[36:39], v[44:47]
    ds_read_b64_tr_b16 a[66:67], v10 offset:39552
    v_mfma_f32_16x16x32_bf16 v[52:55], a[92:95], a[40:43], v[52:55]
    buffer_load_dwordx2 a[16:17], v8, s[44:47], s20 offen offset:0 sc1
    v_mfma_f32_16x16x32_bf16 v[60:63], a[92:95], a[44:47], v[60:63]
    ds_read_b64_tr_b16 a[68:69], v10 offset:36000
    v_mfma_f32_16x16x32_bf16 v[92:95], a[96:99], a[44:47], v[92:95]
    ds_read_b64_tr_b16 a[70:71], v10 offset:39584
    v_mfma_f32_16x16x32_bf16 v[84:87], a[96:99], a[40:43], v[84:87]
    buffer_load_dwordx2 a[18:19], v8, s[44:47], s21 offen offset:0 sc1
    v_mfma_f32_16x16x32_bf16 v[76:79], a[96:99], a[36:39], v[76:79]
    ds_read_b64_tr_b16 a[72:73], v10 offset:36032
    v_mfma_f32_16x16x32_bf16 v[68:71], a[96:99], a[32:35], v[68:71]
    ds_read_b64_tr_b16 a[74:75], v10 offset:39616
    v_mfma_f32_16x16x32_bf16 v[100:103], a[100:103], a[32:35], v[100:103]
    buffer_load_dwordx2 a[20:21], v8, s[44:47], s20 offen offset:128 sc1
    v_mfma_f32_16x16x32_bf16 v[108:111], a[100:103], a[36:39], v[108:111]
    ds_read_b64_tr_b16 a[76:77], v10 offset:36064
    v_mfma_f32_16x16x32_bf16 v[116:119], a[100:103], a[40:43], v[116:119]
    ds_read_b64_tr_b16 a[78:79], v10 offset:39648
    v_mfma_f32_16x16x32_bf16 v[124:127], a[100:103], a[44:47], v[124:127]
    buffer_load_dwordx2 a[22:23], v8, s[44:47], s21 offen offset:128 sc1
    v_mfma_f32_16x16x32_bf16 v[156:159], a[104:107], a[44:47], v[156:159]
    ds_read_b64_tr_b16 a[80:81], v10 offset:36096
    v_mfma_f32_16x16x32_bf16 v[148:151], a[104:107], a[40:43], v[148:151]
    ds_read_b64_tr_b16 a[82:83], v10 offset:39680
    s_add_u32 m0, s29, 32896
    v_mfma_f32_16x16x32_bf16 v[140:143], a[104:107], a[36:39], v[140:143]
    buffer_load_dwordx4 v5, s[4:7], s22 offen offset:0  lds
    v_mfma_f32_16x16x32_bf16 v[132:135], a[104:107], a[32:35], v[132:135]
    ds_read_b64_tr_b16 a[84:85], v10 offset:36128
    v_mfma_f32_16x16x32_bf16 v[164:167], a[108:111], a[32:35], v[164:167]
    ds_read_b64_tr_b16 a[86:87], v10 offset:39712
    v_mfma_f32_16x16x32_bf16 v[172:175], a[108:111], a[36:39], v[172:175]
    buffer_load_dwordx4 v6, s[4:7], s22 offen offset:1024  lds
    v_mfma_f32_16x16x32_bf16 v[180:183], a[108:111], a[40:43], v[180:183]
    ds_read_b64_tr_b16 a[88:89], v10 offset:36160
    v_mfma_f32_16x16x32_bf16 v[188:191], a[108:111], a[44:47], v[188:191]
    ds_read_b64_tr_b16 a[90:91], v10 offset:39744
    v_mfma_f32_16x16x32_bf16 v[220:223], a[112:115], a[44:47], v[220:223]
    buffer_load_dwordx4 a[212:215], v29, s[56:59], s50 offen
    v_mfma_f32_16x16x32_bf16 v[212:215], a[112:115], a[40:43], v[212:215]
    v_mfma_f32_16x16x32_bf16 v[204:207], a[112:115], a[36:39], v[204:207]
    v_mfma_f32_16x16x32_bf16 v[196:199], a[112:115], a[32:35], v[196:199]
    v_mfma_f32_16x16x32_bf16 v[228:231], a[116:119], a[32:35], v[228:231]
    v_mfma_f32_16x16x32_bf16 v[236:239], a[116:119], a[36:39], v[236:239]
    v_mfma_f32_16x16x32_bf16 v[244:247], a[116:119], a[40:43], v[244:247]
    v_mfma_f32_16x16x32_bf16 v[252:255], a[116:119], a[44:47], v[252:255]
    s_waitcnt vmcnt(20) lgkmcnt(0)
    v_mfma_f32_16x16x32_bf16 v[32:35], a[64:67], a[48:51], v[32:35]
    ds_read_b64_tr_b16 a[92:93], v10 offset:50432
    v_mfma_f32_16x16x32_bf16 v[40:43], a[64:67], a[52:55], v[40:43]
    ds_read_b64_tr_b16 a[94:95], v10 offset:54016
    v_mfma_f32_16x16x32_bf16 v[48:51], a[64:67], a[56:59], v[48:51]
    buffer_load_dwordx2 a[24:25], v8, s[44:47], s20 offen offset:256 sc1
    v_mfma_f32_16x16x32_bf16 v[56:59], a[64:67], a[60:63], v[56:59]
    ds_read_b64_tr_b16 a[96:97], v10 offset:50464
    v_mfma_f32_16x16x32_bf16 v[88:91], a[68:71], a[60:63], v[88:91]
    ds_read_b64_tr_b16 a[98:99], v10 offset:54048
    v_mfma_f32_16x16x32_bf16 v[80:83], a[68:71], a[56:59], v[80:83]
    buffer_load_dwordx2 a[26:27], v8, s[44:47], s21 offen offset:256 sc1
    v_mfma_f32_16x16x32_bf16 v[72:75], a[68:71], a[52:55], v[72:75]
    ds_read_b64_tr_b16 a[100:101], v10 offset:50496
    v_mfma_f32_16x16x32_bf16 v[64:67], a[68:71], a[48:51], v[64:67]
    ds_read_b64_tr_b16 a[102:103], v10 offset:54080
    v_mfma_f32_16x16x32_bf16 v[96:99], a[72:75], a[48:51], v[96:99]
    buffer_load_dwordx2 a[28:29], v8, s[44:47], s20 offen offset:384 sc1
    v_mfma_f32_16x16x32_bf16 v[104:107], a[72:75], a[52:55], v[104:107]
    ds_read_b64_tr_b16 a[104:105], v10 offset:50528
    v_mfma_f32_16x16x32_bf16 v[112:115], a[72:75], a[56:59], v[112:115]
    ds_read_b64_tr_b16 a[106:107], v10 offset:54112
    v_mfma_f32_16x16x32_bf16 v[120:123], a[72:75], a[60:63], v[120:123]
    buffer_load_dwordx2 a[30:31], v8, s[44:47], s21 offen offset:384 sc1
    v_mfma_f32_16x16x32_bf16 v[152:155], a[76:79], a[60:63], v[152:155]
    ds_read_b64_tr_b16 a[108:109], v10 offset:50560
    s_add_u32 s20, s20, 131072
    s_add_u32 s21, s20, 65536
    v_mfma_f32_16x16x32_bf16 v[144:147], a[76:79], a[56:59], v[144:147]
    ds_read_b64_tr_b16 a[110:111], v10 offset:54144
    v_mfma_f32_16x16x32_bf16 v[136:139], a[76:79], a[52:55], v[136:139]
    buffer_load_dwordx4 v7, s[4:7], s22 offen offset:2048  lds
    v_mfma_f32_16x16x32_bf16 v[128:131], a[76:79], a[48:51], v[128:131]
    ds_read_b64_tr_b16 a[112:113], v10 offset:50592
    s_add_u32 s22, s22, 458752
    s_cmp_eq_u32 s22, s19
    s_cselect_b32 s22, s18, s22
    v_mfma_f32_16x16x32_bf16 v[160:163], a[80:83], a[48:51], v[160:163]
    ds_read_b64_tr_b16 a[114:115], v10 offset:54176
    v_mfma_f32_16x16x32_bf16 v[168:171], a[80:83], a[52:55], v[168:171]
    v_mfma_f32_16x16x32_bf16 v[176:179], a[80:83], a[56:59], v[176:179]
    ds_read_b64_tr_b16 a[116:117], v10 offset:50624
    v_mfma_f32_16x16x32_bf16 v[184:187], a[80:83], a[60:63], v[184:187]
    ds_read_b64_tr_b16 a[118:119], v10 offset:54208
    v_mfma_f32_16x16x32_bf16 v[216:219], a[84:87], a[60:63], v[216:219]
    v_mfma_f32_16x16x32_bf16 v[208:211], a[84:87], a[56:59], v[208:211]
    v_mfma_f32_16x16x32_bf16 v[200:203], a[84:87], a[52:55], v[200:203]
    v_mfma_f32_16x16x32_bf16 v[192:195], a[84:87], a[48:51], v[192:195]
    v_mfma_f32_16x16x32_bf16 v[224:227], a[88:91], a[48:51], v[224:227]
    v_mfma_f32_16x16x32_bf16 v[232:235], a[88:91], a[52:55], v[232:235]
    v_mfma_f32_16x16x32_bf16 v[240:243], a[88:91], a[56:59], v[240:243]
    v_mfma_f32_16x16x32_bf16 v[248:251], a[88:91], a[60:63], v[248:251]
    s_waitcnt vmcnt(24) lgkmcnt(0)
    s_barrier
    v_mfma_f32_16x16x32_bf16 v[36:39], a[92:95], a[48:51], v[36:39]
    ds_read_b64_tr_b16 a[64:65], v11 offset:0
    v_mfma_f32_16x16x32_bf16 v[44:47], a[92:95], a[52:55], v[44:47]
    ds_read_b64_tr_b16 a[66:67], v11 offset:3584
    v_mfma_f32_16x16x32_bf16 v[52:55], a[92:95], a[56:59], v[52:55]
    buffer_load_dwordx2 a[32:33], v8, s[44:47], s20 offen offset:0 sc1
    v_mfma_f32_16x16x32_bf16 v[60:63], a[92:95], a[60:63], v[60:63]
    ds_read_b64_tr_b16 a[68:69], v11 offset:32
    v_mfma_f32_16x16x32_bf16 v[92:95], a[96:99], a[60:63], v[92:95]
    ds_read_b64_tr_b16 a[70:71], v11 offset:3616
    v_mfma_f32_16x16x32_bf16 v[84:87], a[96:99], a[56:59], v[84:87]
    buffer_load_dwordx2 a[34:35], v8, s[44:47], s21 offen offset:0 sc1
    v_mfma_f32_16x16x32_bf16 v[76:79], a[96:99], a[52:55], v[76:79]
    ds_read_b64_tr_b16 a[72:73], v11 offset:64
    v_mfma_f32_16x16x32_bf16 v[68:71], a[96:99], a[48:51], v[68:71]
    ds_read_b64_tr_b16 a[74:75], v11 offset:3648
    v_mfma_f32_16x16x32_bf16 v[100:103], a[100:103], a[48:51], v[100:103]
    buffer_load_dwordx2 a[36:37], v8, s[44:47], s20 offen offset:128 sc1
    v_mfma_f32_16x16x32_bf16 v[108:111], a[100:103], a[52:55], v[108:111]
    ds_read_b64_tr_b16 a[76:77], v11 offset:96
    v_mfma_f32_16x16x32_bf16 v[116:119], a[100:103], a[56:59], v[116:119]
    ds_read_b64_tr_b16 a[78:79], v11 offset:3680
    v_mfma_f32_16x16x32_bf16 v[124:127], a[100:103], a[60:63], v[124:127]
    buffer_load_dwordx2 a[38:39], v8, s[44:47], s21 offen offset:128 sc1
    v_mfma_f32_16x16x32_bf16 v[156:159], a[104:107], a[60:63], v[156:159]
    ds_read_b64_tr_b16 a[80:81], v11 offset:128
    v_mfma_f32_16x16x32_bf16 v[148:151], a[104:107], a[56:59], v[148:151]
    ds_read_b64_tr_b16 a[82:83], v11 offset:3712
    s_add_u32 m0, s28, 0
    v_mfma_f32_16x16x32_bf16 v[140:143], a[104:107], a[52:55], v[140:143]
    buffer_load_dwordx4 v1, s[4:7], s22 offen offset:0  lds
    v_mfma_f32_16x16x32_bf16 v[132:135], a[104:107], a[48:51], v[132:135]
    ds_read_b64_tr_b16 a[84:85], v11 offset:160
    v_mfma_f32_16x16x32_bf16 v[164:167], a[108:111], a[48:51], v[164:167]
    ds_read_b64_tr_b16 a[86:87], v11 offset:3744
    v_mfma_f32_16x16x32_bf16 v[172:175], a[108:111], a[52:55], v[172:175]
    buffer_load_dwordx4 v2, s[4:7], s22 offen offset:1024  lds
    v_mfma_f32_16x16x32_bf16 v[180:183], a[108:111], a[56:59], v[180:183]
    ds_read_b64_tr_b16 a[88:89], v11 offset:192
    v_mfma_f32_16x16x32_bf16 v[188:191], a[108:111], a[60:63], v[188:191]
    ds_read_b64_tr_b16 a[90:91], v11 offset:3776
    v_mfma_f32_16x16x32_bf16 v[220:223], a[112:115], a[60:63], v[220:223]
    v_mfma_f32_16x16x32_bf16 v[212:215], a[112:115], a[56:59], v[212:215]
    v_swap_b32 v10, v11
    v_mfma_f32_16x16x32_bf16 v[204:207], a[112:115], a[52:55], v[204:207]
    v_mfma_f32_16x16x32_bf16 v[196:199], a[112:115], a[48:51], v[196:199]
    v_mfma_f32_16x16x32_bf16 v[228:231], a[116:119], a[48:51], v[228:231]
    v_mfma_f32_16x16x32_bf16 v[236:239], a[116:119], a[52:55], v[236:239]
    v_mfma_f32_16x16x32_bf16 v[244:247], a[116:119], a[56:59], v[244:247]
    v_mfma_f32_16x16x32_bf16 v[252:255], a[116:119], a[60:63], v[252:255]
    s_add_u32 s25, s25, 1
    s_cmp_lt_u32 s25, 8
    s_cbranch_scc1 L_mk_g1loop_25
    s_waitcnt vmcnt(20) lgkmcnt(0)
    v_mfma_f32_16x16x32_bf16 v[32:35], a[64:67], a[0:3], v[32:35]
    ds_read_b64_tr_b16 a[92:93], v10 offset:14464
    v_mfma_f32_16x16x32_bf16 v[40:43], a[64:67], a[4:7], v[40:43]
    ds_read_b64_tr_b16 a[94:95], v10 offset:18048
    buffer_load_dwordx2 a[40:41], v8, s[44:47], s20 offen offset:256 sc1
    v_mfma_f32_16x16x32_bf16 v[48:51], a[64:67], a[8:11], v[48:51]
    v_mfma_f32_16x16x32_bf16 v[56:59], a[64:67], a[12:15], v[56:59]
    ds_read_b64_tr_b16 a[96:97], v10 offset:14496
    buffer_load_dwordx2 a[42:43], v8, s[44:47], s21 offen offset:256 sc1
    v_mfma_f32_16x16x32_bf16 v[88:91], a[68:71], a[12:15], v[88:91]
    ds_read_b64_tr_b16 a[98:99], v10 offset:18080
    v_mfma_f32_16x16x32_bf16 v[80:83], a[68:71], a[8:11], v[80:83]
    buffer_load_dwordx2 a[44:45], v8, s[44:47], s20 offen offset:384 sc1
    v_mfma_f32_16x16x32_bf16 v[72:75], a[68:71], a[4:7], v[72:75]
    ds_read_b64_tr_b16 a[100:101], v10 offset:14528
    v_mfma_f32_16x16x32_bf16 v[64:67], a[68:71], a[0:3], v[64:67]
    ds_read_b64_tr_b16 a[102:103], v10 offset:18112
    buffer_load_dwordx2 a[46:47], v8, s[44:47], s21 offen offset:384 sc1
    v_mfma_f32_16x16x32_bf16 v[96:99], a[72:75], a[0:3], v[96:99]
    s_add_u32 s20, s20, 131072
    s_add_u32 s21, s20, 65536
    v_mfma_f32_16x16x32_bf16 v[104:107], a[72:75], a[4:7], v[104:107]
    ds_read_b64_tr_b16 a[104:105], v10 offset:14560
    buffer_load_dwordx4 a[120:123], v26, s[40:43], s32 offen offset:0 sc1
    v_mfma_f32_16x16x32_bf16 v[112:115], a[72:75], a[8:11], v[112:115]
    ds_read_b64_tr_b16 a[106:107], v10 offset:18144
    v_mfma_f32_16x16x32_bf16 v[120:123], a[72:75], a[12:15], v[120:123]
    buffer_load_dwordx4 a[124:127], v26, s[40:43], s32 offen offset:256 sc1
    v_mfma_f32_16x16x32_bf16 v[152:155], a[76:79], a[12:15], v[152:155]
    ds_read_b64_tr_b16 a[108:109], v10 offset:14592
    v_mfma_f32_16x16x32_bf16 v[144:147], a[76:79], a[8:11], v[144:147]
    ds_read_b64_tr_b16 a[110:111], v10 offset:18176
    buffer_load_dwordx4 a[128:131], v26, s[40:43], s32 offen offset:512 sc1
    v_mfma_f32_16x16x32_bf16 v[136:139], a[76:79], a[4:7], v[136:139]
    v_mfma_f32_16x16x32_bf16 v[128:131], a[76:79], a[0:3], v[128:131]
    ds_read_b64_tr_b16 a[112:113], v10 offset:14624
    buffer_load_dwordx4 a[132:135], v26, s[40:43], s32 offen offset:768 sc1
    v_mfma_f32_16x16x32_bf16 v[160:163], a[80:83], a[0:3], v[160:163]
    ds_read_b64_tr_b16 a[114:115], v10 offset:18208
    v_mfma_f32_16x16x32_bf16 v[168:171], a[80:83], a[4:7], v[168:171]
    buffer_load_dwordx4 a[136:139], v26, s[40:43], s32 offen offset:1024 sc1
    v_mfma_f32_16x16x32_bf16 v[176:179], a[80:83], a[8:11], v[176:179]
    ds_read_b64_tr_b16 a[116:117], v10 offset:14656
    v_mfma_f32_16x16x32_bf16 v[184:187], a[80:83], a[12:15], v[184:187]
    ds_read_b64_tr_b16 a[118:119], v10 offset:18240
    buffer_load_dwordx4 a[140:143], v26, s[40:43], s32 offen offset:1280 sc1
    v_mfma_f32_16x16x32_bf16 v[216:219], a[84:87], a[12:15], v[216:219]
    v_mfma_f32_16x16x32_bf16 v[208:211], a[84:87], a[8:11], v[208:211]
    buffer_load_dwordx4 a[144:147], v26, s[40:43], s32 offen offset:1536 sc1
    v_mfma_f32_16x16x32_bf16 v[200:203], a[84:87], a[4:7], v[200:203]
    v_mfma_f32_16x16x32_bf16 v[192:195], a[84:87], a[0:3], v[192:195]
    buffer_load_dwordx4 a[148:151], v26, s[40:43], s32 offen offset:1792 sc1
    v_mfma_f32_16x16x32_bf16 v[224:227], a[88:91], a[0:3], v[224:227]
    v_mfma_f32_16x16x32_bf16 v[232:235], a[88:91], a[4:7], v[232:235]
    v_mfma_f32_16x16x32_bf16 v[240:243], a[88:91], a[8:11], v[240:243]
    v_mfma_f32_16x16x32_bf16 v[248:251], a[88:91], a[12:15], v[248:251]
    s_waitcnt vmcnt(32) lgkmcnt(0)
    v_mfma_f32_16x16x32_bf16 v[36:39], a[92:95], a[0:3], v[36:39]
    ds_read_b64_tr_b16 a[64:65], v10 offset:7168
    v_mfma_f32_16x16x32_bf16 v[44:47], a[92:95], a[4:7], v[44:47]
    ds_read_b64_tr_b16 a[66:67], v10 offset:10752
    v_mfma_f32_16x16x32_bf16 v[52:55], a[92:95], a[8:11], v[52:55]
    buffer_load_dwordx2 a[48:49], v8, s[44:47], s20 offen offset:0 sc1
    v_mfma_f32_16x16x32_bf16 v[60:63], a[92:95], a[12:15], v[60:63]
    ds_read_b64_tr_b16 a[68:69], v10 offset:7200
    v_mfma_f32_16x16x32_bf16 v[92:95], a[96:99], a[12:15], v[92:95]
    ds_read_b64_tr_b16 a[70:71], v10 offset:10784
    v_mfma_f32_16x16x32_bf16 v[84:87], a[96:99], a[8:11], v[84:87]
    buffer_load_dwordx2 a[50:51], v8, s[44:47], s21 offen offset:0 sc1
    v_mfma_f32_16x16x32_bf16 v[76:79], a[96:99], a[4:7], v[76:79]
    ds_read_b64_tr_b16 a[72:73], v10 offset:7232
    v_mfma_f32_16x16x32_bf16 v[68:71], a[96:99], a[0:3], v[68:71]
    ds_read_b64_tr_b16 a[74:75], v10 offset:10816
    v_mfma_f32_16x16x32_bf16 v[100:103], a[100:103], a[0:3], v[100:103]
    buffer_load_dwordx2 a[52:53], v8, s[44:47], s20 offen offset:128 sc1
    v_mfma_f32_16x16x32_bf16 v[108:111], a[100:103], a[4:7], v[108:111]
    ds_read_b64_tr_b16 a[76:77], v10 offset:7264
    v_mfma_f32_16x16x32_bf16 v[116:119], a[100:103], a[8:11], v[116:119]
    ds_read_b64_tr_b16 a[78:79], v10 offset:10848
    v_mfma_f32_16x16x32_bf16 v[124:127], a[100:103], a[12:15], v[124:127]
    buffer_load_dwordx2 a[54:55], v8, s[44:47], s21 offen offset:128 sc1
    v_mfma_f32_16x16x32_bf16 v[156:159], a[104:107], a[12:15], v[156:159]
    ds_read_b64_tr_b16 a[80:81], v10 offset:7296
    v_mfma_f32_16x16x32_bf16 v[148:151], a[104:107], a[8:11], v[148:151]
    ds_read_b64_tr_b16 a[82:83], v10 offset:10880
    v_mfma_f32_16x16x32_bf16 v[140:143], a[104:107], a[4:7], v[140:143]
    buffer_load_dwordx4 v[12:15], v9, s[36:39], 0 offen offset:0 sc1
    v_mfma_f32_16x16x32_bf16 v[132:135], a[104:107], a[0:3], v[132:135]
    ds_read_b64_tr_b16 a[84:85], v10 offset:7328
    v_mfma_f32_16x16x32_bf16 v[164:167], a[108:111], a[0:3], v[164:167]
    ds_read_b64_tr_b16 a[86:87], v10 offset:10912
    v_mfma_f32_16x16x32_bf16 v[172:175], a[108:111], a[4:7], v[172:175]
    buffer_load_dwordx4 v[16:19], v9, s[36:39], 0 offen offset:256 sc1
    v_mfma_f32_16x16x32_bf16 v[180:183], a[108:111], a[8:11], v[180:183]
    ds_read_b64_tr_b16 a[88:89], v10 offset:7360
    v_mfma_f32_16x16x32_bf16 v[188:191], a[108:111], a[12:15], v[188:191]
    ds_read_b64_tr_b16 a[90:91], v10 offset:10944
    v_mfma_f32_16x16x32_bf16 v[220:223], a[112:115], a[12:15], v[220:223]
    buffer_load_dwordx4 v[20:23], v9, s[36:39], 0 offen offset:512 sc1
    v_mfma_f32_16x16x32_bf16 v[212:215], a[112:115], a[8:11], v[212:215]
    v_mfma_f32_16x16x32_bf16 v[204:207], a[112:115], a[4:7], v[204:207]
    buffer_load_dwordx4 v[24:27], v9, s[36:39], 0 offen offset:768 sc1
    v_mfma_f32_16x16x32_bf16 v[196:199], a[112:115], a[0:3], v[196:199]
    v_mfma_f32_16x16x32_bf16 v[228:231], a[116:119], a[0:3], v[228:231]
    v_mfma_f32_16x16x32_bf16 v[236:239], a[116:119], a[4:7], v[236:239]
    v_mfma_f32_16x16x32_bf16 v[244:247], a[116:119], a[8:11], v[244:247]
    v_mfma_f32_16x16x32_bf16 v[252:255], a[116:119], a[12:15], v[252:255]
    s_waitcnt vmcnt(27) lgkmcnt(0)
    v_mfma_f32_16x16x32_bf16 v[32:35], a[64:67], a[16:19], v[32:35]
    ds_read_b64_tr_b16 a[92:93], v10 offset:21632
    v_mfma_f32_16x16x32_bf16 v[40:43], a[64:67], a[20:23], v[40:43]
    ds_read_b64_tr_b16 a[94:95], v10 offset:25216
    v_mfma_f32_16x16x32_bf16 v[48:51], a[64:67], a[24:27], v[48:51]
    buffer_load_dwordx2 a[56:57], v8, s[44:47], s20 offen offset:256 sc1
    v_mfma_f32_16x16x32_bf16 v[56:59], a[64:67], a[28:31], v[56:59]
    ds_read_b64_tr_b16 a[96:97], v10 offset:21664
    v_mfma_f32_16x16x32_bf16 v[88:91], a[68:71], a[28:31], v[88:91]
    ds_read_b64_tr_b16 a[98:99], v10 offset:25248
    v_mfma_f32_16x16x32_bf16 v[80:83], a[68:71], a[24:27], v[80:83]
    buffer_load_dwordx2 a[58:59], v8, s[44:47], s21 offen offset:256 sc1
    v_mfma_f32_16x16x32_bf16 v[72:75], a[68:71], a[20:23], v[72:75]
    ds_read_b64_tr_b16 a[100:101], v10 offset:21696
    v_mfma_f32_16x16x32_bf16 v[64:67], a[68:71], a[16:19], v[64:67]
    ds_read_b64_tr_b16 a[102:103], v10 offset:25280
    s_bfe_u32 s54, s2, 0x20001
    v_mfma_f32_16x16x32_bf16 v[96:99], a[72:75], a[16:19], v[96:99]
    s_bfe_u32 s52, s2, 0x30003
    buffer_load_dwordx2 a[60:61], v8, s[44:47], s20 offen offset:384 sc1
    v_mfma_f32_16x16x32_bf16 v[104:107], a[72:75], a[20:23], v[104:107]
    ds_read_b64_tr_b16 a[104:105], v10 offset:21728
    s_and_b32 s53, s2, 1
    v_mfma_f32_16x16x32_bf16 v[112:115], a[72:75], a[24:27], v[112:115]
    ds_read_b64_tr_b16 a[106:107], v10 offset:25312
    s_lshr_b32 s48, s2, 6
    v_mfma_f32_16x16x32_bf16 v[120:123], a[72:75], a[28:31], v[120:123]
    s_lshl2_add_u32 s53, s53, s48
    buffer_load_dwordx2 a[62:63], v8, s[44:47], s21 offen offset:384 sc1
    v_mfma_f32_16x16x32_bf16 v[152:155], a[76:79], a[28:31], v[152:155]
    ds_read_b64_tr_b16 a[108:109], v10 offset:21760
    v_lshrrev_b32 v6, 4, v30
    s_add_u32 s20, s20, 131072
    s_cmp_eq_u32 s20, s17
    s_cselect_b32 s20, s26, s20
    s_add_u32 s21, s20, 65536
    v_mfma_f32_16x16x32_bf16 v[144:147], a[76:79], a[24:27], v[144:147]
    ds_read_b64_tr_b16 a[110:111], v10 offset:25344
    s_mul_i32 s48, s54, 896
    v_mfma_f32_16x16x32_bf16 v[136:139], a[76:79], a[20:23], v[136:139]
    s_lshl_b32 s34, s94, 3
    v_mfma_f32_16x16x32_bf16 v[128:131], a[76:79], a[16:19], v[128:131]
    ds_read_b64_tr_b16 a[112:113], v10 offset:21792
    s_mul_i32 s35, s53, 112
    v_mfma_f32_16x16x32_bf16 v[160:163], a[80:83], a[16:19], v[160:163]
    ds_read_b64_tr_b16 a[114:115], v10 offset:25376
    v_add_u32 v1, s48, v6
    v_mfma_f32_16x16x32_bf16 v[168:171], a[80:83], a[20:23], v[168:171]
    v_lshlrev_b32 v1, 11, v1
    v_mfma_f32_16x16x32_bf16 v[176:179], a[80:83], a[24:27], v[176:179]
    ds_read_b64_tr_b16 a[116:117], v10 offset:21824
    v_lshlrev_b32 v6, 1, v6
    v_mfma_f32_16x16x32_bf16 v[184:187], a[80:83], a[28:31], v[184:187]
    ds_read_b64_tr_b16 a[118:119], v10 offset:25408
    v_and_b32 v7, 15, v30
    v_mfma_f32_16x16x32_bf16 v[216:219], a[84:87], a[28:31], v[216:219]
    v_xor_b32 v6, v6, v7
    v_mfma_f32_16x16x32_bf16 v[208:211], a[84:87], a[24:27], v[208:211]
    v_lshl_add_u32 v1, v6, 4, v1
    v_mfma_f32_16x16x32_bf16 v[200:203], a[84:87], a[20:23], v[200:203]
    s_lshl_b32 s48, s53, 8
    v_mfma_f32_16x16x32_bf16 v[192:195], a[84:87], a[16:19], v[192:195]
    v_add_u32 v1, s48, v1
    v_mfma_f32_16x16x32_bf16 v[224:227], a[88:91], a[16:19], v[224:227]
    s_lshl_b32 s24, s94, 12
    v_mfma_f32_16x16x32_bf16 v[232:235], a[88:91], a[20:23], v[232:235]
    v_xor_b32 v0, 128, v1
    v_mfma_f32_16x16x32_bf16 v[240:243], a[88:91], a[24:27], v[240:243]
    s_lshl2_add_u32 s16, s52, s94
    s_mul_i32 s16, s16, 57344
    v_mfma_f32_16x16x32_bf16 v[248:251], a[88:91], a[28:31], v[248:251]
    s_waitcnt vmcnt(24) lgkmcnt(0)
    s_barrier
    v_mfma_f32_16x16x32_bf16 v[36:39], a[92:95], a[16:19], v[36:39]
    ds_read_b64_tr_b16 a[64:65], v10 offset:28800
    v_mfma_f32_16x16x32_bf16 v[44:47], a[92:95], a[20:23], v[44:47]
    ds_read_b64_tr_b16 a[66:67], v10 offset:32384
    v_mfma_f32_16x16x32_bf16 v[52:55], a[92:95], a[24:27], v[52:55]
    buffer_load_dwordx4 a[212:215], v1, s[12:15], s16 offen
    v_mfma_f32_16x16x32_bf16 v[60:63], a[92:95], a[28:31], v[60:63]
    ds_read_b64_tr_b16 a[68:69], v10 offset:28832
    s_add_u32 s16, s16, 8192
    v_mfma_f32_16x16x32_bf16 v[92:95], a[96:99], a[28:31], v[92:95]
    ds_read_b64_tr_b16 a[70:71], v10 offset:32416
    v_mfma_f32_16x16x32_bf16 v[84:87], a[96:99], a[24:27], v[84:87]
    buffer_load_dwordx4 a[212:215], v1, s[12:15], s16 offen
    v_mfma_f32_16x16x32_bf16 v[76:79], a[96:99], a[20:23], v[76:79]
    ds_read_b64_tr_b16 a[72:73], v10 offset:28864
    s_add_u32 s16, s16, 8192
    v_mfma_f32_16x16x32_bf16 v[68:71], a[96:99], a[16:19], v[68:71]
    ds_read_b64_tr_b16 a[74:75], v10 offset:32448
    v_mfma_f32_16x16x32_bf16 v[100:103], a[100:103], a[16:19], v[100:103]
    buffer_load_dwordx4 a[212:215], v1, s[12:15], s16 offen
    v_mfma_f32_16x16x32_bf16 v[108:111], a[100:103], a[20:23], v[108:111]
    ds_read_b64_tr_b16 a[76:77], v10 offset:28896
    s_add_u32 s16, s16, 8192
    v_mfma_f32_16x16x32_bf16 v[116:119], a[100:103], a[24:27], v[116:119]
    ds_read_b64_tr_b16 a[78:79], v10 offset:32480
    v_mfma_f32_16x16x32_bf16 v[124:127], a[100:103], a[28:31], v[124:127]
    buffer_load_dwordx4 a[212:215], v1, s[12:15], s16 offen
    v_mfma_f32_16x16x32_bf16 v[156:159], a[104:107], a[28:31], v[156:159]
    ds_read_b64_tr_b16 a[80:81], v10 offset:28928
    s_add_u32 s16, s16, 8192
    v_mfma_f32_16x16x32_bf16 v[148:151], a[104:107], a[24:27], v[148:151]
    ds_read_b64_tr_b16 a[82:83], v10 offset:32512
    v_mfma_f32_16x16x32_bf16 v[140:143], a[104:107], a[20:23], v[140:143]
    buffer_load_dwordx4 a[212:215], v1, s[12:15], s16 offen
    v_mfma_f32_16x16x32_bf16 v[132:135], a[104:107], a[16:19], v[132:135]
    ds_read_b64_tr_b16 a[84:85], v10 offset:28960
    s_add_u32 s16, s16, 8192
    v_mfma_f32_16x16x32_bf16 v[164:167], a[108:111], a[16:19], v[164:167]
    ds_read_b64_tr_b16 a[86:87], v10 offset:32544
    v_mfma_f32_16x16x32_bf16 v[172:175], a[108:111], a[20:23], v[172:175]
    buffer_load_dwordx4 a[212:215], v1, s[12:15], s16 offen
    v_mfma_f32_16x16x32_bf16 v[180:183], a[108:111], a[24:27], v[180:183]
    ds_read_b64_tr_b16 a[88:89], v10 offset:28992
    s_add_u32 s16, s16, 8192
    v_mfma_f32_16x16x32_bf16 v[188:191], a[108:111], a[28:31], v[188:191]
    ds_read_b64_tr_b16 a[90:91], v10 offset:32576
    v_mfma_f32_16x16x32_bf16 v[220:223], a[112:115], a[28:31], v[220:223]
    buffer_load_dwordx4 a[212:215], v1, s[12:15], s16 offen
    v_mfma_f32_16x16x32_bf16 v[212:215], a[112:115], a[24:27], v[212:215]
    s_add_u32 s16, s16, 8192
    v_mfma_f32_16x16x32_bf16 v[204:207], a[112:115], a[20:23], v[204:207]
    v_mfma_f32_16x16x32_bf16 v[196:199], a[112:115], a[16:19], v[196:199]
    v_mfma_f32_16x16x32_bf16 v[228:231], a[116:119], a[16:19], v[228:231]
    v_mfma_f32_16x16x32_bf16 v[236:239], a[116:119], a[20:23], v[236:239]
    v_mfma_f32_16x16x32_bf16 v[244:247], a[116:119], a[24:27], v[244:247]
    v_mfma_f32_16x16x32_bf16 v[252:255], a[116:119], a[28:31], v[252:255]
    s_waitcnt vmcnt(27) lgkmcnt(0)
    v_mfma_f32_16x16x32_bf16 v[32:35], a[64:67], a[32:35], v[32:35]
    ds_read_b64_tr_b16 a[92:93], v10 offset:43264
    v_mfma_f32_16x16x32_bf16 v[40:43], a[64:67], a[36:39], v[40:43]
    ds_read_b64_tr_b16 a[94:95], v10 offset:46848
    v_mfma_f32_16x16x32_bf16 v[48:51], a[64:67], a[40:43], v[48:51]
    v_mfma_f32_16x16x32_bf16 v[56:59], a[64:67], a[44:47], v[56:59]
    ds_read_b64_tr_b16 a[96:97], v10 offset:43296
    v_mfma_f32_16x16x32_bf16 v[88:91], a[68:71], a[44:47], v[88:91]
    ds_read_b64_tr_b16 a[98:99], v10 offset:46880
    v_mfma_f32_16x16x32_bf16 v[80:83], a[68:71], a[40:43], v[80:83]
    v_mfma_f32_16x16x32_bf16 v[72:75], a[68:71], a[36:39], v[72:75]
    ds_read_b64_tr_b16 a[100:101], v10 offset:43328
    v_mfma_f32_16x16x32_bf16 v[64:67], a[68:71], a[32:35], v[64:67]
    ds_read_b64_tr_b16 a[102:103], v10 offset:46912
    v_mfma_f32_16x16x32_bf16 v[96:99], a[72:75], a[32:35], v[96:99]
    v_mfma_f32_16x16x32_bf16 v[104:107], a[72:75], a[36:39], v[104:107]
    ds_read_b64_tr_b16 a[104:105], v10 offset:43360
    v_mfma_f32_16x16x32_bf16 v[112:115], a[72:75], a[40:43], v[112:115]
    ds_read_b64_tr_b16 a[106:107], v10 offset:46944
    v_mfma_f32_16x16x32_bf16 v[120:123], a[72:75], a[44:47], v[120:123]
    v_mfma_f32_16x16x32_bf16 v[152:155], a[76:79], a[44:47], v[152:155]
    ds_read_b64_tr_b16 a[108:109], v10 offset:43392
    v_mfma_f32_16x16x32_bf16 v[144:147], a[76:79], a[40:43], v[144:147]
    ds_read_b64_tr_b16 a[110:111], v10 offset:46976
    v_mfma_f32_16x16x32_bf16 v[136:139], a[76:79], a[36:39], v[136:139]
    v_mfma_f32_16x16x32_bf16 v[128:131], a[76:79], a[32:35], v[128:131]
    ds_read_b64_tr_b16 a[112:113], v10 offset:43424
    v_mfma_f32_16x16x32_bf16 v[160:163], a[80:83], a[32:35], v[160:163]
    ds_read_b64_tr_b16 a[114:115], v10 offset:47008
    v_mfma_f32_16x16x32_bf16 v[168:171], a[80:83], a[36:39], v[168:171]
    v_mfma_f32_16x16x32_bf16 v[176:179], a[80:83], a[40:43], v[176:179]
    ds_read_b64_tr_b16 a[116:117], v10 offset:43456
    v_mfma_f32_16x16x32_bf16 v[184:187], a[80:83], a[44:47], v[184:187]
    ds_read_b64_tr_b16 a[118:119], v10 offset:47040
    v_mfma_f32_16x16x32_bf16 v[216:219], a[84:87], a[44:47], v[216:219]
    v_mfma_f32_16x16x32_bf16 v[208:211], a[84:87], a[40:43], v[208:211]
    v_mfma_f32_16x16x32_bf16 v[200:203], a[84:87], a[36:39], v[200:203]
    v_mfma_f32_16x16x32_bf16 v[192:195], a[84:87], a[32:35], v[192:195]
    v_mfma_f32_16x16x32_bf16 v[224:227], a[88:91], a[32:35], v[224:227]
    v_mfma_f32_16x16x32_bf16 v[232:235], a[88:91], a[36:39], v[232:235]
    v_mfma_f32_16x16x32_bf16 v[240:243], a[88:91], a[40:43], v[240:243]
    v_mfma_f32_16x16x32_bf16 v[248:251], a[88:91], a[44:47], v[248:251]
    s_waitcnt vmcnt(11) lgkmcnt(0)
    v_mfma_f32_16x16x32_bf16 v[36:39], a[92:95], a[32:35], v[36:39]
    ds_read_b64_tr_b16 a[64:65], v10 offset:35968
    s_add_u32 m0, s24, 0
    s_lshr_b32 s23, 0x3020100, s34
    s_and_b32 s23, s23, 0xff
    v_mfma_f32_16x16x32_bf16 v[44:47], a[92:95], a[36:39], v[44:47]
    ds_read_b64_tr_b16 a[66:67], v10 offset:39552
    s_lshl4_add_u32 s23, s23, s35
    s_sub_u32 s22, s23, 896
    s_cselect_b32 s23, s23, s22
    s_lshl_b32 s23, s23, 11
    v_mfma_f32_16x16x32_bf16 v[52:55], a[92:95], a[40:43], v[52:55]
    v_accvgpr_mov_b32 a152, a120
    buffer_load_dwordx4 v1, s[12:15], s23 offen offset:0 lds
    v_mfma_f32_16x16x32_bf16 v[60:63], a[92:95], a[44:47], v[60:63]
    ds_read_b64_tr_b16 a[68:69], v10 offset:36000
    v_mfma_f32_16x16x32_bf16 v[92:95], a[96:99], a[44:47], v[92:95]
    ds_read_b64_tr_b16 a[70:71], v10 offset:39584
    s_add_u32 s23, s23, 7168
    v_mfma_f32_16x16x32_bf16 v[84:87], a[96:99], a[40:43], v[84:87]
    v_accvgpr_mov_b32 a153, a136
    buffer_load_dwordx4 v1, s[12:15], s23 offen offset:1024 lds
    v_mfma_f32_16x16x32_bf16 v[76:79], a[96:99], a[36:39], v[76:79]
    ds_read_b64_tr_b16 a[72:73], v10 offset:36032
    v_mfma_f32_16x16x32_bf16 v[68:71], a[96:99], a[32:35], v[68:71]
    ds_read_b64_tr_b16 a[74:75], v10 offset:39616
    s_add_u32 s23, s23, 7168
    v_mfma_f32_16x16x32_bf16 v[100:103], a[100:103], a[32:35], v[100:103]
    v_accvgpr_mov_b32 a154, a121
    buffer_load_dwordx4 v0, s[12:15], s23 offen offset:2048 lds
    v_mfma_f32_16x16x32_bf16 v[108:111], a[100:103], a[36:39], v[108:111]
    ds_read_b64_tr_b16 a[76:77], v10 offset:36064
    v_mfma_f32_16x16x32_bf16 v[116:119], a[100:103], a[40:43], v[116:119]
    ds_read_b64_tr_b16 a[78:79], v10 offset:39648
    s_add_u32 s23, s23, 7168
    v_mfma_f32_16x16x32_bf16 v[124:127], a[100:103], a[44:47], v[124:127]
    v_accvgpr_mov_b32 a155, a137
    buffer_load_dwordx4 v0, s[12:15], s23 offen offset:3072 lds
    v_mfma_f32_16x16x32_bf16 v[156:159], a[104:107], a[44:47], v[156:159]
    ds_read_b64_tr_b16 a[80:81], v10 offset:36096
    v_mfma_f32_16x16x32_bf16 v[148:151], a[104:107], a[40:43], v[148:151]
    ds_read_b64_tr_b16 a[82:83], v10 offset:39680
    v_mfma_f32_16x16x32_bf16 v[140:143], a[104:107], a[36:39], v[140:143]
    v_accvgpr_mov_b32 a156, a122
    v_mfma_f32_16x16x32_bf16 v[132:135], a[104:107], a[32:35], v[132:135]
    ds_read_b64_tr_b16 a[84:85], v10 offset:36128
    v_mfma_f32_16x16x32_bf16 v[164:167], a[108:111], a[32:35], v[164:167]
    ds_read_b64_tr_b16 a[86:87], v10 offset:39712
    v_mfma_f32_16x16x32_bf16 v[172:175], a[108:111], a[36:39], v[172:175]
    v_accvgpr_mov_b32 a157, a138
    v_mfma_f32_16x16x32_bf16 v[180:183], a[108:111], a[40:43], v[180:183]
    ds_read_b64_tr_b16 a[88:89], v10 offset:36160
    v_mfma_f32_16x16x32_bf16 v[188:191], a[108:111], a[44:47], v[188:191]
    ds_read_b64_tr_b16 a[90:91], v10 offset:39744
    v_mfma_f32_16x16x32_bf16 v[220:223], a[112:115], a[44:47], v[220:223]
    v_accvgpr_mov_b32 a158, a123
    v_mfma_f32_16x16x32_bf16 v[212:215], a[112:115], a[40:43], v[212:215]
    v_accvgpr_mov_b32 a159, a139
    v_mfma_f32_16x16x32_bf16 v[204:207], a[112:115], a[36:39], v[204:207]
    v_accvgpr_mov_b32 a160, a124
    v_mfma_f32_16x16x32_bf16 v[196:199], a[112:115], a[32:35], v[196:199]
    v_accvgpr_mov_b32 a161, a140
    v_mfma_f32_16x16x32_bf16 v[228:231], a[116:119], a[32:35], v[228:231]
    v_accvgpr_mov_b32 a162, a125
    v_mfma_f32_16x16x32_bf16 v[236:239], a[116:119], a[36:39], v[236:239]
    v_accvgpr_mov_b32 a163, a141
    v_mfma_f32_16x16x32_bf16 v[244:247], a[116:119], a[40:43], v[244:247]
    v_accvgpr_mov_b32 a164, a126
    v_mfma_f32_16x16x32_bf16 v[252:255], a[116:119], a[44:47], v[252:255]
    v_accvgpr_mov_b32 a165, a142
    s_waitcnt vmcnt(11) lgkmcnt(0)
    v_mfma_f32_16x16x32_bf16 v[32:35], a[64:67], a[48:51], v[32:35]
    ds_read_b64_tr_b16 a[92:93], v10 offset:50432
    s_add_u32 m0, s24, 16384
    s_lshr_b32 s23, 0x8070504, s34
    s_and_b32 s23, s23, 0xff
    v_mfma_f32_16x16x32_bf16 v[40:43], a[64:67], a[52:55], v[40:43]
    ds_read_b64_tr_b16 a[94:95], v10 offset:54016
    s_lshl4_add_u32 s23, s23, s35
    s_sub_u32 s22, s23, 896
    s_cselect_b32 s23, s23, s22
    s_lshl_b32 s23, s23, 11
    v_mfma_f32_16x16x32_bf16 v[48:51], a[64:67], a[56:59], v[48:51]
    v_accvgpr_mov_b32 a166, a127
    buffer_load_dwordx4 v1, s[12:15], s23 offen offset:0 lds
    v_mfma_f32_16x16x32_bf16 v[56:59], a[64:67], a[60:63], v[56:59]
    ds_read_b64_tr_b16 a[96:97], v10 offset:50464
    v_mfma_f32_16x16x32_bf16 v[88:91], a[68:71], a[60:63], v[88:91]
    ds_read_b64_tr_b16 a[98:99], v10 offset:54048
    s_add_u32 s23, s23, 7168
    v_mfma_f32_16x16x32_bf16 v[80:83], a[68:71], a[56:59], v[80:83]
    v_accvgpr_mov_b32 a167, a143
    buffer_load_dwordx4 v1, s[12:15], s23 offen offset:1024 lds
    v_mfma_f32_16x16x32_bf16 v[72:75], a[68:71], a[52:55], v[72:75]
    ds_read_b64_tr_b16 a[100:101], v10 offset:50496
    v_mfma_f32_16x16x32_bf16 v[64:67], a[68:71], a[48:51], v[64:67]
    ds_read_b64_tr_b16 a[102:103], v10 offset:54080
    s_add_u32 s23, s23, 7168
    v_mfma_f32_16x16x32_bf16 v[96:99], a[72:75], a[48:51], v[96:99]
    v_accvgpr_mov_b32 a168, a128
    buffer_load_dwordx4 v0, s[12:15], s23 offen offset:2048 lds
    v_mfma_f32_16x16x32_bf16 v[104:107], a[72:75], a[52:55], v[104:107]
    ds_read_b64_tr_b16 a[104:105], v10 offset:50528
    v_mfma_f32_16x16x32_bf16 v[112:115], a[72:75], a[56:59], v[112:115]
    ds_read_b64_tr_b16 a[106:107], v10 offset:54112
    s_add_u32 s23, s23, 7168
    v_mfma_f32_16x16x32_bf16 v[120:123], a[72:75], a[60:63], v[120:123]
    v_accvgpr_mov_b32 a169, a144
    buffer_load_dwordx4 v0, s[12:15], s23 offen offset:3072 lds
    v_mfma_f32_16x16x32_bf16 v[152:155], a[76:79], a[60:63], v[152:155]
    ds_read_b64_tr_b16 a[108:109], v10 offset:50560
    v_mfma_f32_16x16x32_bf16 v[144:147], a[76:79], a[56:59], v[144:147]
    ds_read_b64_tr_b16 a[110:111], v10 offset:54144
    v_mfma_f32_16x16x32_bf16 v[136:139], a[76:79], a[52:55], v[136:139]
    v_accvgpr_mov_b32 a170, a129
    v_mfma_f32_16x16x32_bf16 v[128:131], a[76:79], a[48:51], v[128:131]
    ds_read_b64_tr_b16 a[112:113], v10 offset:50592
    v_mfma_f32_16x16x32_bf16 v[160:163], a[80:83], a[48:51], v[160:163]
    ds_read_b64_tr_b16 a[114:115], v10 offset:54176
    v_mfma_f32_16x16x32_bf16 v[168:171], a[80:83], a[52:55], v[168:171]
    v_accvgpr_mov_b32 a171, a145
    v_mfma_f32_16x16x32_bf16 v[176:179], a[80:83], a[56:59], v[176:179]
    ds_read_b64_tr_b16 a[116:117], v10 offset:50624
    v_mfma_f32_16x16x32_bf16 v[184:187], a[80:83], a[60:63], v[184:187]
    ds_read_b64_tr_b16 a[118:119], v10 offset:54208
    v_mfma_f32_16x16x32_bf16 v[216:219], a[84:87], a[60:63], v[216:219]
    v_accvgpr_mov_b32 a172, a130
    v_mfma_f32_16x16x32_bf16 v[208:211], a[84:87], a[56:59], v[208:211]
    v_accvgpr_mov_b32 a173, a146
    v_mfma_f32_16x16x32_bf16 v[200:203], a[84:87], a[52:55], v[200:203]
    v_accvgpr_mov_b32 a174, a131
    v_mfma_f32_16x16x32_bf16 v[192:195], a[84:87], a[48:51], v[192:195]
    v_accvgpr_mov_b32 a175, a147
    v_mfma_f32_16x16x32_bf16 v[224:227], a[88:91], a[48:51], v[224:227]
    v_accvgpr_mov_b32 a248, a132
    v_mfma_f32_16x16x32_bf16 v[232:235], a[88:91], a[52:55], v[232:235]
    v_accvgpr_mov_b32 a249, a148
    v_mfma_f32_16x16x32_bf16 v[240:243], a[88:91], a[56:59], v[240:243]
    v_accvgpr_mov_b32 a250, a133
    v_mfma_f32_16x16x32_bf16 v[248:251], a[88:91], a[60:63], v[248:251]
    v_accvgpr_mov_b32 a251, a149
    s_waitcnt vmcnt(15) lgkmcnt(0)
    v_mfma_f32_16x16x32_bf16 v[36:39], a[92:95], a[48:51], v[36:39]
    s_barrier
    s_add_u32 m0, s24, 32768
    s_lshr_b32 s23, 0xf0e0a09, s34
    s_and_b32 s23, s23, 0xff
    v_mfma_f32_16x16x32_bf16 v[44:47], a[92:95], a[52:55], v[44:47]
    s_lshl4_add_u32 s23, s23, s35
    s_sub_u32 s22, s23, 896
    s_cselect_b32 s23, s23, s22
    s_lshl_b32 s23, s23, 11
    v_mfma_f32_16x16x32_bf16 v[52:55], a[92:95], a[56:59], v[52:55]
    buffer_load_dwordx4 v1, s[12:15], s23 offen offset:0 lds
    v_mfma_f32_16x16x32_bf16 v[60:63], a[92:95], a[60:63], v[60:63]
    v_mfma_f32_16x16x32_bf16 v[92:95], a[96:99], a[60:63], v[92:95]
    s_add_u32 s23, s23, 7168
    v_mfma_f32_16x16x32_bf16 v[84:87], a[96:99], a[56:59], v[84:87]
    buffer_load_dwordx4 v1, s[12:15], s23 offen offset:1024 lds
    v_mfma_f32_16x16x32_bf16 v[76:79], a[96:99], a[52:55], v[76:79]
    v_mfma_f32_16x16x32_bf16 v[68:71], a[96:99], a[48:51], v[68:71]
    s_add_u32 s23, s23, 7168
    v_mfma_f32_16x16x32_bf16 v[100:103], a[100:103], a[48:51], v[100:103]
    buffer_load_dwordx4 v0, s[12:15], s23 offen offset:2048 lds
    v_mfma_f32_16x16x32_bf16 v[108:111], a[100:103], a[52:55], v[108:111]
    v_mfma_f32_16x16x32_bf16 v[116:119], a[100:103], a[56:59], v[116:119]
    s_add_u32 s23, s23, 7168
    v_mfma_f32_16x16x32_bf16 v[124:127], a[100:103], a[60:63], v[124:127]
    buffer_load_dwordx4 v0, s[12:15], s23 offen offset:3072 lds
    v_mfma_f32_16x16x32_bf16 v[156:159], a[104:107], a[60:63], v[156:159]
    v_mfma_f32_16x16x32_bf16 v[148:151], a[104:107], a[56:59], v[148:151]
    v_mfma_f32_16x16x32_bf16 v[140:143], a[104:107], a[52:55], v[140:143]
    v_mfma_f32_16x16x32_bf16 v[132:135], a[104:107], a[48:51], v[132:135]
    v_mfma_f32_16x16x32_bf16 v[164:167], a[108:111], a[48:51], v[164:167]
    v_mfma_f32_16x16x32_bf16 v[172:175], a[108:111], a[52:55], v[172:175]
    v_mfma_f32_16x16x32_bf16 v[180:183], a[108:111], a[56:59], v[180:183]
    v_mfma_f32_16x16x32_bf16 v[188:191], a[108:111], a[60:63], v[188:191]
    v_mfma_f32_16x16x32_bf16 v[220:223], a[112:115], a[60:63], v[220:223]
    v_mfma_f32_16x16x32_bf16 v[212:215], a[112:115], a[56:59], v[212:215]
    v_mfma_f32_16x16x32_bf16 v[204:207], a[112:115], a[52:55], v[204:207]
    v_mfma_f32_16x16x32_bf16 v[196:199], a[112:115], a[48:51], v[196:199]
    v_mfma_f32_16x16x32_bf16 v[228:231], a[116:119], a[48:51], v[228:231]
    v_mfma_f32_16x16x32_bf16 v[236:239], a[116:119], a[52:55], v[236:239]
    v_mfma_f32_16x16x32_bf16 v[244:247], a[116:119], a[56:59], v[244:247]
    v_mfma_f32_16x16x32_bf16 v[252:255], a[116:119], a[60:63], v[252:255]
    s_mov_b32 s96, 0
L_mk_sp_26:
    v_accvgpr_read_b32 v2, a252
    v_accvgpr_read_b32 v3, a253
    v_cmp_ne_u64_e64 vcc, s[92:93], v[2:3]
    v_cmp_ne_u64 s[48:49], s[92:93], v[14:15]
    s_or_b64 vcc, vcc, s[48:49]
    v_cmp_ne_u64 s[48:49], s[92:93], v[18:19]
    s_or_b64 vcc, vcc, s[48:49]
    v_cmp_ne_u64 s[48:49], s[92:93], v[22:23]
    s_or_b64 vcc, vcc, s[48:49]
    v_cmp_ne_u64 s[48:49], s[92:93], v[26:27]
    s_or_b64 vcc, vcc, s[48:49]
    s_cbranch_vccz L_mk_sok_27
    v_and_b32 v4, 15, v30
    v_lshlrev_b32 v4, 4, v4
    v_lshrrev_b32 v5, 4, v30
    v_lshl_add_u32 v4, v5, 11, v4
    v_and_b32 v5, 7, v30
    v_lshlrev_b32 v5, 9, v5
    s_and_b32 s48, s2, 0xc7
    s_lshl_b32 s48, s48, 6
    s_add_u32 s48, s48, 49152
    v_add_u32 v5, s48, v5
    buffer_load_dwordx2 a[252:253], v5, s[60:63], 0 offen sc1
    buffer_load_dwordx4 v[12:15], v9, s[36:39], 0 offen offset:0 sc1
    buffer_load_dwordx4 v[16:19], v9, s[36:39], 0 offen offset:256 sc1
    buffer_load_dwordx4 v[20:23], v9, s[36:39], 0 offen offset:512 sc1
    buffer_load_dwordx4 v[24:27], v9, s[36:39], 0 offen offset:768 sc1
    s_waitcnt vmcnt(0)
    s_nop 0
    buffer_load_dwordx4 a[120:123], v4, s[40:43], s32 offen offset:0 sc1
    buffer_load_dwordx4 a[124:127], v4, s[40:43], s32 offen offset:256 sc1
    buffer_load_dwordx4 a[128:131], v4, s[40:43], s32 offen offset:512 sc1
    buffer_load_dwordx4 a[132:135], v4, s[40:43], s32 offen offset:768 sc1
    buffer_load_dwordx4 a[136:139], v4, s[40:43], s32 offen offset:1024 sc1
    buffer_load_dwordx4 a[140:143], v4, s[40:43], s32 offen offset:1280 sc1
    buffer_load_dwordx4 a[144:147], v4, s[40:43], s32 offen offset:1536 sc1
    buffer_load_dwordx4 a[148:151], v4, s[40:43], s32 offen offset:1792 sc1
    s_waitcnt vmcnt(0)
    v_accvgpr_mov_b32 a152, a120
    v_accvgpr_mov_b32 a153, a136
    v_accvgpr_mov_b32 a154, a121
    v_accvgpr_mov_b32 a155, a137
    v_accvgpr_mov_b32 a156, a122
    v_accvgpr_mov_b32 a157, a138
    v_accvgpr_mov_b32 a158, a123
    v_accvgpr_mov_b32 a159, a139
    v_accvgpr_mov_b32 a160, a124
    v_accvgpr_mov_b32 a161, a140
    v_accvgpr_mov_b32 a162, a125
    v_accvgpr_mov_b32 a163, a141
    v_accvgpr_mov_b32 a164, a126
    v_accvgpr_mov_b32 a165, a142
    v_accvgpr_mov_b32 a166, a127
    v_accvgpr_mov_b32 a167, a143
    v_accvgpr_mov_b32 a168, a128
    v_accvgpr_mov_b32 a169, a144
    v_accvgpr_mov_b32 a170, a129
    v_accvgpr_mov_b32 a171, a145
    v_accvgpr_mov_b32 a172, a130
    v_accvgpr_mov_b32 a173, a146
    v_accvgpr_mov_b32 a174, a131
    v_accvgpr_mov_b32 a175, a147
    v_accvgpr_mov_b32 a248, a132
    v_accvgpr_mov_b32 a249, a148
    v_accvgpr_mov_b32 a250, a133
    v_accvgpr_mov_b32 a251, a149
    s_add_u32 s96, s96, 1
    s_cmp_lt_u32 s96, 400000
    s_cbranch_scc1 L_mk_sp_26
L_mk_sok_27:
    v_xor_b32 v15, 0x80000000, v12
    v_lshrrev_b32 v14, 16, v15
    v_or_b32_e64 v15, v14, v15
    v_mul_f32 v12, 0xc0135761, v13
    v_mul_f32_e64 v14, v13, v13
    v_accvgpr_write_b32 a192, v15
    v_accvgpr_write_b32 a193, v15
    v_mul_f32 v13, v14, v13
    v_rcp_f32 v14, v14
    v_mul_f32 v13, 0xbdd2d3e8, v13
    v_xor_b32 v19, 0x80000000, v16
    v_lshrrev_b32 v18, 16, v19
    v_or_b32 v19, v18, v19
    v_mul_f32 v16, 0xc0135761, v17
    v_mul_f32_e64 v18, v17, v17
    v_accvgpr_write_b32 a194, v19
    v_accvgpr_write_b32 a195, v19
    v_mul_f32 v17, v18, v17
    v_rcp_f32 v18, v18
    v_mul_f32 v17, 0xbdd2d3e8, v17
    v_xor_b32 v23, 0x80000000, v20
    v_lshrrev_b32 v22, 16, v23
    v_or_b32 v23, v22, v23
    v_mul_f32 v20, 0xc0135761, v21
    v_mul_f32_e64 v22, v21, v21
    v_accvgpr_write_b32 a196, v23
    v_accvgpr_write_b32 a197, v23
    v_mul_f32 v21, v22, v21
    v_rcp_f32 v22, v22
    v_mul_f32 v21, 0xbdd2d3e8, v21
    v_xor_b32 v27, 0x80000000, v24
    v_lshrrev_b32 v26, 16, v27
    v_or_b32 v27, v26, v27
    v_mul_f32 v24, 0xc0135761, v25
    v_mul_f32_e64 v26, v25, v25
    v_accvgpr_write_b32 a198, v27
    v_accvgpr_write_b32 a199, v27
    v_mul_f32 v25, v26, v25
    v_rcp_f32 v26, v26
    v_mul_f32 v25, 0xbdd2d3e8, v25
    v_mfma_f32_16x16x16_bf16 v[32:35], a[152:153], a[192:193], v[32:35]
    v_mfma_f32_16x16x16_bf16 v[36:39], a[166:167], a[192:193], v[36:39]
    v_mfma_f32_16x16x16_bf16 v[40:43], a[152:153], a[194:195], v[40:43]
    v_mfma_f32_16x16x16_bf16 v[44:47], a[166:167], a[194:195], v[44:47]
    v_mfma_f32_16x16x16_bf16 v[48:51], a[152:153], a[196:197], v[48:51]
    v_mfma_f32_16x16x16_bf16 v[52:55], a[166:167], a[196:197], v[52:55]
    v_mfma_f32_16x16x16_bf16 v[56:59], a[152:153], a[198:199], v[56:59]
    v_mfma_f32_16x16x16_bf16 v[60:63], a[166:167], a[198:199], v[60:63]
    s_nop 3
    s_nop 0
    v_pk_mul_f32 v[2:3], v[32:33], v[32:33]
    v_pk_mul_f32 v[4:5], v[34:35], v[34:35]
    v_pk_mul_f32 v[6:7], v[40:41], v[40:41]
    v_pk_mul_f32 v[8:9], v[42:43], v[42:43]
    v_pk_fma_f32 v[2:3], v[2:3], v[12:13], v[12:13] op_sel:[0,1,0] op_sel_hi:[1,1,0]
    v_pk_fma_f32 v[4:5], v[4:5], v[12:13], v[12:13] op_sel:[0,1,0] op_sel_hi:[1,1,0]
    v_pk_fma_f32 v[6:7], v[6:7], v[16:17], v[16:17] op_sel:[0,1,0] op_sel_hi:[1,1,0]
    v_pk_fma_f32 v[8:9], v[8:9], v[16:17], v[16:17] op_sel:[0,1,0] op_sel_hi:[1,1,0]
    v_pk_mul_f32 v[2:3], v[2:3], v[32:33]
    v_pk_mul_f32 v[4:5], v[4:5], v[34:35]
    v_pk_mul_f32 v[6:7], v[6:7], v[40:41]
    v_pk_mul_f32 v[8:9], v[8:9], v[42:43]
    s_add_u32 m0, s24, 131072
    s_lshr_b32 s23, 0x16151110, s34
    s_and_b32 s23, s23, 0xff
    s_lshl4_add_u32 s23, s23, s35
    s_sub_u32 s22, s23, 896
    s_cselect_b32 s23, s23, s22
    s_lshl_b32 s23, s23, 11
    buffer_load_dwordx4 v1, s[12:15], s23 offen offset:0 lds
    v_exp_f32 v2, v2
    v_mfma_f32_16x16x16_bf16 v[64:67], a[154:155], a[192:193], v[64:67]
    v_exp_f32 v3, v3
    v_exp_f32 v4, v4
    v_mfma_f32_16x16x16_bf16 v[68:71], a[168:169], a[192:193], v[68:71]
    v_exp_f32 v5, v5
    v_exp_f32 v6, v6
    v_mfma_f32_16x16x16_bf16 v[72:75], a[154:155], a[194:195], v[72:75]
    v_exp_f32 v7, v7
    v_exp_f32 v8, v8
    v_mfma_f32_16x16x16_bf16 v[76:79], a[168:169], a[194:195], v[76:79]
    v_exp_f32_e64 v9, v9
    v_pk_mul_f32 v[36:37], v[36:37], v[32:33]
    v_pk_mul_f32 v[38:39], v[38:39], v[34:35]
    v_pk_mul_f32 v[44:45], v[44:45], v[40:41]
    v_pk_mul_f32 v[46:47], v[46:47], v[42:43]
    v_pk_fma_f32 v[2:3], v[2:3], v[14:15], v[14:15] op_sel_hi:[1,0,0]
    v_pk_fma_f32 v[4:5], v[4:5], v[14:15], v[14:15] op_sel_hi:[1,0,0]
    v_pk_fma_f32 v[6:7], v[6:7], v[18:19], v[18:19] op_sel_hi:[1,0,0]
    v_pk_fma_f32 v[8:9], v[8:9], v[18:19], v[18:19] op_sel_hi:[1,0,0]
    s_add_u32 s23, s23, 7168
    buffer_load_dwordx4 v1, s[12:15], s23 offen offset:1024 lds
    v_rcp_f32 v2, v2
    v_rcp_f32 v3, v3
    v_rcp_f32 v4, v4
    v_rcp_f32 v5, v5
    v_rcp_f32 v6, v6
    v_rcp_f32 v7, v7
    v_rcp_f32 v8, v8
    v_rcp_f32_e64 v9, v9
    s_mov_b32 s48, 0
    v_pk_mul_f32 v[36:37], v[36:37], v[2:3]
    v_pk_mul_f32 v[38:39], v[38:39], v[4:5]
    v_pk_mul_f32 v[44:45], v[44:45], v[6:7]
    v_pk_mul_f32 v[46:47], v[46:47], v[8:9]
    v_cvt_pk_bf16_f32 v32, v36, v37
    v_cvt_pk_bf16_f32 v34, v44, v45
    v_cvt_pk_bf16_f32 v33, v38, v39
    v_cvt_pk_bf16_f32 v35, v46, v47
    v_accvgpr_write_b32 a0, v32
    v_accvgpr_write_b32 a1, v33
    v_accvgpr_write_b32 a4, v34
    v_accvgpr_write_b32 a5, v35
    v_permlane16_swap_b32 v32, v34
    v_permlane16_swap_b32 v33, v35
    buffer_store_dwordx4 v[32:35], v28, s[8:11], s48 offen offset:0 sc1
    v_pk_mul_f32 v[2:3], v[48:49], v[48:49]
    v_pk_mul_f32 v[4:5], v[50:51], v[50:51]
    v_pk_mul_f32 v[6:7], v[56:57], v[56:57]
    v_pk_mul_f32 v[8:9], v[58:59], v[58:59]
    v_pk_fma_f32 v[2:3], v[2:3], v[20:21], v[20:21] op_sel:[0,1,0] op_sel_hi:[1,1,0]
    v_pk_fma_f32 v[4:5], v[4:5], v[20:21], v[20:21] op_sel:[0,1,0] op_sel_hi:[1,1,0]
    v_pk_fma_f32 v[6:7], v[6:7], v[24:25], v[24:25] op_sel:[0,1,0] op_sel_hi:[1,1,0]
    v_pk_fma_f32 v[8:9], v[8:9], v[24:25], v[24:25] op_sel:[0,1,0] op_sel_hi:[1,1,0]
    v_pk_mul_f32 v[2:3], v[2:3], v[48:49]
    v_pk_mul_f32 v[4:5], v[4:5], v[50:51]
    v_pk_mul_f32 v[6:7], v[6:7], v[56:57]
    v_pk_mul_f32 v[8:9], v[8:9], v[58:59]
    s_add_u32 s23, s23, 7168
    buffer_load_dwordx4 v0, s[12:15], s23 offen offset:2048 lds
    v_exp_f32 v2, v2
    v_mfma_f32_16x16x16_bf16 v[80:83], a[154:155], a[196:197], v[80:83]
    v_exp_f32 v3, v3
    v_exp_f32 v4, v4
    v_mfma_f32_16x16x16_bf16 v[84:87], a[168:169], a[196:197], v[84:87]
    v_exp_f32 v5, v5
    v_exp_f32 v6, v6
    v_mfma_f32_16x16x16_bf16 v[88:91], a[154:155], a[198:199], v[88:91]
    v_exp_f32 v7, v7
    v_exp_f32 v8, v8
    v_mfma_f32_16x16x16_bf16 v[92:95], a[168:169], a[198:199], v[92:95]
    v_exp_f32 v9, v9
    v_pk_mul_f32 v[52:53], v[52:53], v[48:49]
    v_pk_mul_f32 v[54:55], v[54:55], v[50:51]
    v_pk_mul_f32 v[60:61], v[60:61], v[56:57]
    v_pk_mul_f32 v[62:63], v[62:63], v[58:59]
    v_pk_fma_f32 v[2:3], v[2:3], v[22:23], v[22:23] op_sel_hi:[1,0,0]
    v_pk_fma_f32 v[4:5], v[4:5], v[22:23], v[22:23] op_sel_hi:[1,0,0]
    v_pk_fma_f32 v[6:7], v[6:7], v[26:27], v[26:27] op_sel_hi:[1,0,0]
    v_pk_fma_f32 v[8:9], v[8:9], v[26:27], v[26:27] op_sel_hi:[1,0,0]
    s_add_u32 s23, s23, 7168
    buffer_load_dwordx4 v0, s[12:15], s23 offen offset:3072 lds
    v_rcp_f32 v2, v2
    v_rcp_f32 v3, v3
    v_rcp_f32 v4, v4
    v_rcp_f32 v5, v5
    v_rcp_f32 v6, v6
    v_rcp_f32 v7, v7
    v_rcp_f32 v8, v8
    v_rcp_f32_e64 v9, v9
    s_mov_b32 s48, 0
    v_pk_mul_f32 v[52:53], v[52:53], v[2:3]
    v_pk_mul_f32 v[54:55], v[54:55], v[4:5]
    v_pk_mul_f32 v[60:61], v[60:61], v[6:7]
    v_pk_mul_f32 v[62:63], v[62:63], v[8:9]
    v_cvt_pk_bf16_f32 v48, v52, v53
    v_cvt_pk_bf16_f32 v50, v60, v61
    v_cvt_pk_bf16_f32 v49, v54, v55
    v_cvt_pk_bf16_f32 v51, v62, v63
    v_accvgpr_write_b32 a8, v48
    v_accvgpr_write_b32 a9, v49
    v_accvgpr_write_b32 a12, v50
    v_accvgpr_write_b32 a13, v51
    v_permlane16_swap_b32 v48, v50
    v_permlane16_swap_b32 v49, v51
    buffer_store_dwordx4 v[48:51], v28, s[8:11], s48 offen offset:512 sc1
    v_pk_mul_f32 v[2:3], v[64:65], v[64:65]
    v_pk_mul_f32 v[4:5], v[66:67], v[66:67]
    v_pk_mul_f32 v[6:7], v[72:73], v[72:73]
    v_pk_mul_f32 v[8:9], v[74:75], v[74:75]
    v_pk_fma_f32 v[2:3], v[2:3], v[12:13], v[12:13] op_sel:[0,1,0] op_sel_hi:[1,1,0]
    v_pk_fma_f32 v[4:5], v[4:5], v[12:13], v[12:13] op_sel:[0,1,0] op_sel_hi:[1,1,0]
    v_pk_fma_f32 v[6:7], v[6:7], v[16:17], v[16:17] op_sel:[0,1,0] op_sel_hi:[1,1,0]
    v_pk_fma_f32 v[8:9], v[8:9], v[16:17], v[16:17] op_sel:[0,1,0] op_sel_hi:[1,1,0]
    v_pk_mul_f32 v[2:3], v[2:3], v[64:65]
    v_pk_mul_f32 v[4:5], v[4:5], v[66:67]
    v_pk_mul_f32 v[6:7], v[6:7], v[72:73]
    v_pk_mul_f32 v[8:9], v[8:9], v[74:75]
    s_add_u32 m0, s24, 147456
    s_lshr_b32 s23, 0x1d1c1817, s34
    s_and_b32 s23, s23, 0xff
    s_lshl4_add_u32 s23, s23, s35
    s_sub_u32 s22, s23, 896
    s_cselect_b32 s23, s23, s22
    s_lshl_b32 s23, s23, 11
    buffer_load_dwordx4 v1, s[12:15], s23 offen offset:0 lds
    v_exp_f32 v2, v2
    v_mfma_f32_16x16x16_bf16 v[96:99], a[156:157], a[192:193], v[96:99]
    v_exp_f32 v3, v3
    v_exp_f32 v4, v4
    v_mfma_f32_16x16x16_bf16 v[100:103], a[170:171], a[192:193], v[100:103]
    v_exp_f32 v5, v5
    v_exp_f32 v6, v6
    v_mfma_f32_16x16x16_bf16 v[104:107], a[156:157], a[194:195], v[104:107]
    v_exp_f32 v7, v7
    v_exp_f32 v8, v8
    v_mfma_f32_16x16x16_bf16 v[108:111], a[170:171], a[194:195], v[108:111]
    v_exp_f32_e64 v9, v9
    v_pk_mul_f32 v[68:69], v[68:69], v[64:65]
    v_pk_mul_f32 v[70:71], v[70:71], v[66:67]
    v_pk_mul_f32 v[76:77], v[76:77], v[72:73]
    v_pk_mul_f32 v[78:79], v[78:79], v[74:75]
    v_pk_fma_f32 v[2:3], v[2:3], v[14:15], v[14:15] op_sel_hi:[1,0,0]
    v_pk_fma_f32 v[4:5], v[4:5], v[14:15], v[14:15] op_sel_hi:[1,0,0]
    v_pk_fma_f32 v[6:7], v[6:7], v[18:19], v[18:19] op_sel_hi:[1,0,0]
    v_pk_fma_f32 v[8:9], v[8:9], v[18:19], v[18:19] op_sel_hi:[1,0,0]
    s_add_u32 s23, s23, 7168
    buffer_load_dwordx4 v1, s[12:15], s23 offen offset:1024 lds
    v_rcp_f32 v2, v2
    v_rcp_f32 v3, v3
    v_rcp_f32 v4, v4
    v_rcp_f32 v5, v5
    v_rcp_f32 v6, v6
    v_rcp_f32 v7, v7
    v_rcp_f32 v8, v8
    v_rcp_f32 v9, v9
    s_mov_b32 s48, 65536
    v_pk_mul_f32 v[68:69], v[68:69], v[2:3]
    v_pk_mul_f32 v[70:71], v[70:71], v[4:5]
    v_pk_mul_f32 v[76:77], v[76:77], v[6:7]
    v_pk_mul_f32 v[78:79], v[78:79], v[8:9]
    v_cvt_pk_bf16_f32 v64, v68, v69
    v_cvt_pk_bf16_f32 v66, v76, v77
    v_cvt_pk_bf16_f32 v65, v70, v71
    v_cvt_pk_bf16_f32 v67, v78, v79
    v_accvgpr_write_b32 a2, v64
    v_accvgpr_write_b32 a3, v65
    v_accvgpr_write_b32 a6, v66
    v_accvgpr_write_b32 a7, v67
    v_permlane16_swap_b32 v64, v66
    v_permlane16_swap_b32 v65, v67
    buffer_store_dwordx4 v[64:67], v28, s[8:11], s48 offen offset:0 sc1
    v_pk_mul_f32 v[2:3], v[80:81], v[80:81]
    v_pk_mul_f32 v[4:5], v[82:83], v[82:83]
    v_pk_mul_f32 v[6:7], v[88:89], v[88:89]
    v_pk_mul_f32 v[8:9], v[90:91], v[90:91]
    v_pk_fma_f32 v[2:3], v[2:3], v[20:21], v[20:21] op_sel:[0,1,0] op_sel_hi:[1,1,0]
    v_pk_fma_f32 v[4:5], v[4:5], v[20:21], v[20:21] op_sel:[0,1,0] op_sel_hi:[1,1,0]
    v_pk_fma_f32 v[6:7], v[6:7], v[24:25], v[24:25] op_sel:[0,1,0] op_sel_hi:[1,1,0]
    v_pk_fma_f32 v[8:9], v[8:9], v[24:25], v[24:25] op_sel:[0,1,0] op_sel_hi:[1,1,0]
    v_pk_mul_f32 v[2:3], v[2:3], v[80:81]
    v_pk_mul_f32 v[4:5], v[4:5], v[82:83]
    v_pk_mul_f32 v[6:7], v[6:7], v[88:89]
    v_pk_mul_f32 v[8:9], v[8:9], v[90:91]
    s_add_u32 s23, s23, 7168
    buffer_load_dwordx4 v0, s[12:15], s23 offen offset:2048 lds
    v_exp_f32 v2, v2
    v_mfma_f32_16x16x16_bf16 v[112:115], a[156:157], a[196:197], v[112:115]
    v_exp_f32 v3, v3
    v_exp_f32 v4, v4
    v_mfma_f32_16x16x16_bf16 v[116:119], a[170:171], a[196:197], v[116:119]
    v_exp_f32 v5, v5
    v_exp_f32 v6, v6
    v_mfma_f32_16x16x16_bf16 v[120:123], a[156:157], a[198:199], v[120:123]
    v_exp_f32 v7, v7
    v_exp_f32 v8, v8
    v_mfma_f32_16x16x16_bf16 v[124:127], a[170:171], a[198:199], v[124:127]
    v_exp_f32 v9, v9
    v_pk_mul_f32 v[84:85], v[84:85], v[80:81]
    v_pk_mul_f32 v[86:87], v[86:87], v[82:83]
    v_pk_mul_f32 v[92:93], v[92:93], v[88:89]
    v_pk_mul_f32 v[94:95], v[94:95], v[90:91]
    v_pk_fma_f32 v[2:3], v[2:3], v[22:23], v[22:23] op_sel_hi:[1,0,0]
    v_pk_fma_f32 v[4:5], v[4:5], v[22:23], v[22:23] op_sel_hi:[1,0,0]
    v_pk_fma_f32 v[6:7], v[6:7], v[26:27], v[26:27] op_sel_hi:[1,0,0]
    v_pk_fma_f32 v[8:9], v[8:9], v[26:27], v[26:27] op_sel_hi:[1,0,0]
    s_add_u32 s23, s23, 7168
    buffer_load_dwordx4 v0, s[12:15], s23 offen offset:3072 lds
    v_rcp_f32 v2, v2
    v_rcp_f32 v3, v3
    v_rcp_f32 v4, v4
    v_rcp_f32 v5, v5
    v_rcp_f32 v6, v6
    v_rcp_f32 v7, v7
    v_rcp_f32 v8, v8
    v_rcp_f32 v9, v9
    s_mov_b32 s48, 65536
    v_pk_mul_f32 v[84:85], v[84:85], v[2:3]
    v_pk_mul_f32 v[86:87], v[86:87], v[4:5]
    v_pk_mul_f32 v[92:93], v[92:93], v[6:7]
    v_pk_mul_f32 v[94:95], v[94:95], v[8:9]
    v_cvt_pk_bf16_f32 v80, v84, v85
    v_cvt_pk_bf16_f32 v82, v92, v93
    v_cvt_pk_bf16_f32 v81, v86, v87
    v_cvt_pk_bf16_f32 v83, v94, v95
    v_accvgpr_write_b32 a10, v80
    v_accvgpr_write_b32 a11, v81
    v_accvgpr_write_b32 a14, v82
    v_accvgpr_write_b32 a15, v83
    v_permlane16_swap_b32 v80, v82
    v_permlane16_swap_b32 v81, v83
    buffer_store_dwordx4 v[80:83], v28, s[8:11], s48 offen offset:512 sc1
    v_pk_mul_f32 v[2:3], v[96:97], v[96:97]
    v_pk_mul_f32 v[4:5], v[98:99], v[98:99]
    v_pk_mul_f32 v[6:7], v[104:105], v[104:105]
    v_pk_mul_f32 v[8:9], v[106:107], v[106:107]
    v_pk_fma_f32 v[2:3], v[2:3], v[12:13], v[12:13] op_sel:[0,1,0] op_sel_hi:[1,1,0]
    v_pk_fma_f32 v[4:5], v[4:5], v[12:13], v[12:13] op_sel:[0,1,0] op_sel_hi:[1,1,0]
    v_pk_fma_f32 v[6:7], v[6:7], v[16:17], v[16:17] op_sel:[0,1,0] op_sel_hi:[1,1,0]
    v_pk_fma_f32 v[8:9], v[8:9], v[16:17], v[16:17] op_sel:[0,1,0] op_sel_hi:[1,1,0]
    v_pk_mul_f32 v[2:3], v[2:3], v[96:97]
    v_pk_mul_f32 v[4:5], v[4:5], v[98:99]
    v_pk_mul_f32 v[6:7], v[6:7], v[104:105]
    v_pk_mul_f32 v[8:9], v[8:9], v[106:107]
    s_add_u32 m0, s24, 49152
    s_lshr_b32 s23, 0x24231f1e, s34
    s_and_b32 s23, s23, 0xff
    s_lshl4_add_u32 s23, s23, s35
    s_sub_u32 s22, s23, 896
    s_cselect_b32 s23, s23, s22
    s_lshl_b32 s23, s23, 11
    buffer_load_dwordx4 v1, s[12:15], s23 offen offset:0 lds
    v_exp_f32 v2, v2
    v_mfma_f32_16x16x16_bf16 v[128:131], a[158:159], a[192:193], v[128:131]
    v_exp_f32 v3, v3
    v_exp_f32 v4, v4
    v_mfma_f32_16x16x16_bf16 v[132:135], a[172:173], a[192:193], v[132:135]
    v_exp_f32 v5, v5
    v_exp_f32 v6, v6
    v_mfma_f32_16x16x16_bf16 v[136:139], a[158:159], a[194:195], v[136:139]
    v_exp_f32 v7, v7
    v_exp_f32 v8, v8
    v_mfma_f32_16x16x16_bf16 v[140:143], a[172:173], a[194:195], v[140:143]
    v_exp_f32_e64 v9, v9
    v_pk_mul_f32 v[100:101], v[100:101], v[96:97]
    v_pk_mul_f32 v[102:103], v[102:103], v[98:99]
    v_pk_mul_f32 v[108:109], v[108:109], v[104:105]
    v_pk_mul_f32 v[110:111], v[110:111], v[106:107]
    v_pk_fma_f32 v[2:3], v[2:3], v[14:15], v[14:15] op_sel_hi:[1,0,0]
    v_pk_fma_f32 v[4:5], v[4:5], v[14:15], v[14:15] op_sel_hi:[1,0,0]
    v_pk_fma_f32 v[6:7], v[6:7], v[18:19], v[18:19] op_sel_hi:[1,0,0]
    v_pk_fma_f32 v[8:9], v[8:9], v[18:19], v[18:19] op_sel_hi:[1,0,0]
    s_add_u32 s23, s23, 7168
    buffer_load_dwordx4 v1, s[12:15], s23 offen offset:1024 lds
    v_rcp_f32 v2, v2
    v_rcp_f32 v3, v3
    v_rcp_f32 v4, v4
    v_rcp_f32 v5, v5
    v_rcp_f32 v6, v6
    v_rcp_f32 v7, v7
    v_rcp_f32 v8, v8
    v_rcp_f32 v9, v9
    s_mov_b32 s48, 131072
    v_pk_mul_f32 v[100:101], v[100:101], v[2:3]
    v_pk_mul_f32 v[102:103], v[102:103], v[4:5]
    v_pk_mul_f32 v[108:109], v[108:109], v[6:7]
    v_pk_mul_f32 v[110:111], v[110:111], v[8:9]
    v_cvt_pk_bf16_f32 v96, v100, v101
    v_cvt_pk_bf16_f32 v98, v108, v109
    v_cvt_pk_bf16_f32 v97, v102, v103
    v_cvt_pk_bf16_f32 v99, v110, v111
    v_accvgpr_write_b32 a16, v96
    v_accvgpr_write_b32 a17, v97
    v_accvgpr_write_b32 a20, v98
    v_accvgpr_write_b32 a21, v99
    v_permlane16_swap_b32 v96, v98
    v_permlane16_swap_b32 v97, v99
    buffer_store_dwordx4 v[96:99], v28, s[8:11], s48 offen offset:0 sc1
    v_pk_mul_f32 v[2:3], v[112:113], v[112:113]
    v_pk_mul_f32 v[4:5], v[114:115], v[114:115]
    v_pk_mul_f32 v[6:7], v[120:121], v[120:121]
    v_pk_mul_f32 v[8:9], v[122:123], v[122:123]
    v_pk_fma_f32 v[2:3], v[2:3], v[20:21], v[20:21] op_sel:[0,1,0] op_sel_hi:[1,1,0]
    v_pk_fma_f32 v[4:5], v[4:5], v[20:21], v[20:21] op_sel:[0,1,0] op_sel_hi:[1,1,0]
    v_pk_fma_f32 v[6:7], v[6:7], v[24:25], v[24:25] op_sel:[0,1,0] op_sel_hi:[1,1,0]
    v_pk_fma_f32 v[8:9], v[8:9], v[24:25], v[24:25] op_sel:[0,1,0] op_sel_hi:[1,1,0]
    v_pk_mul_f32 v[2:3], v[2:3], v[112:113]
    v_pk_mul_f32 v[4:5], v[4:5], v[114:115]
    v_pk_mul_f32 v[6:7], v[6:7], v[120:121]
    v_pk_mul_f32 v[8:9], v[8:9], v[122:123]
    s_add_u32 s23, s23, 7168
    buffer_load_dwordx4 v0, s[12:15], s23 offen offset:2048 lds
    v_exp_f32 v2, v2
    v_mfma_f32_16x16x16_bf16 v[144:147], a[158:159], a[196:197], v[144:147]
    v_exp_f32 v3, v3
    v_exp_f32 v4, v4
    v_mfma_f32_16x16x16_bf16 v[148:151], a[172:173], a[196:197], v[148:151]
    v_exp_f32 v5, v5
    v_exp_f32 v6, v6
    v_mfma_f32_16x16x16_bf16 v[152:155], a[158:159], a[198:199], v[152:155]
    v_exp_f32 v7, v7
    v_exp_f32 v8, v8
    v_mfma_f32_16x16x16_bf16 v[156:159], a[172:173], a[198:199], v[156:159]
    v_exp_f32 v9, v9
    v_pk_mul_f32 v[116:117], v[116:117], v[112:113]
    v_pk_mul_f32 v[118:119], v[118:119], v[114:115]
    v_pk_mul_f32 v[124:125], v[124:125], v[120:121]
    v_pk_mul_f32 v[126:127], v[126:127], v[122:123]
    v_pk_fma_f32 v[2:3], v[2:3], v[22:23], v[22:23] op_sel_hi:[1,0,0]
    v_pk_fma_f32 v[4:5], v[4:5], v[22:23], v[22:23] op_sel_hi:[1,0,0]
    v_pk_fma_f32 v[6:7], v[6:7], v[26:27], v[26:27] op_sel_hi:[1,0,0]
    v_pk_fma_f32 v[8:9], v[8:9], v[26:27], v[26:27] op_sel_hi:[1,0,0]
    s_add_u32 s23, s23, 7168
    buffer_load_dwordx4 v0, s[12:15], s23 offen offset:3072 lds
    v_rcp_f32 v2, v2
    v_rcp_f32 v3, v3
    v_rcp_f32 v4, v4
    v_rcp_f32 v5, v5
    v_rcp_f32 v6, v6
    v_rcp_f32 v7, v7
    v_rcp_f32 v8, v8
    v_rcp_f32 v9, v9
    s_mov_b32 s48, 131072
    v_pk_mul_f32 v[116:117], v[116:117], v[2:3]
    v_pk_mul_f32 v[118:119], v[118:119], v[4:5]
    v_pk_mul_f32 v[124:125], v[124:125], v[6:7]
    v_pk_mul_f32 v[126:127], v[126:127], v[8:9]
    v_cvt_pk_bf16_f32 v112, v116, v117
    v_cvt_pk_bf16_f32 v114, v124, v125
    v_cvt_pk_bf16_f32 v113, v118, v119
    v_cvt_pk_bf16_f32 v115, v126, v127
    v_accvgpr_write_b32 a24, v112
    v_accvgpr_write_b32 a25, v113
    v_accvgpr_write_b32 a28, v114
    v_accvgpr_write_b32 a29, v115
    v_permlane16_swap_b32 v112, v114
    v_permlane16_swap_b32 v113, v115
    buffer_store_dwordx4 v[112:115], v28, s[8:11], s48 offen offset:512 sc1
    v_pk_mul_f32 v[2:3], v[128:129], v[128:129]
    v_pk_mul_f32 v[4:5], v[130:131], v[130:131]
    v_pk_mul_f32 v[6:7], v[136:137], v[136:137]
    v_pk_mul_f32 v[8:9], v[138:139], v[138:139]
    v_pk_fma_f32 v[2:3], v[2:3], v[12:13], v[12:13] op_sel:[0,1,0] op_sel_hi:[1,1,0]
    v_pk_fma_f32 v[4:5], v[4:5], v[12:13], v[12:13] op_sel:[0,1,0] op_sel_hi:[1,1,0]
    v_pk_fma_f32 v[6:7], v[6:7], v[16:17], v[16:17] op_sel:[0,1,0] op_sel_hi:[1,1,0]
    v_pk_fma_f32 v[8:9], v[8:9], v[16:17], v[16:17] op_sel:[0,1,0] op_sel_hi:[1,1,0]
    v_pk_mul_f32 v[2:3], v[2:3], v[128:129]
    v_pk_mul_f32 v[4:5], v[4:5], v[130:131]
    v_pk_mul_f32 v[6:7], v[6:7], v[136:137]
    v_pk_mul_f32 v[8:9], v[8:9], v[138:139]
    s_add_u32 m0, s24, 65536
    s_lshr_b32 s23, 0x2b2a2625, s34
    s_and_b32 s23, s23, 0xff
    s_lshl4_add_u32 s23, s23, s35
    s_sub_u32 s22, s23, 896
    s_cselect_b32 s23, s23, s22
    s_lshl_b32 s23, s23, 11
    buffer_load_dwordx4 v1, s[12:15], s23 offen offset:0 lds
    v_exp_f32 v2, v2
    v_mfma_f32_16x16x16_bf16 v[160:163], a[160:161], a[192:193], v[160:163]
    v_exp_f32 v3, v3
    v_exp_f32 v4, v4
    v_mfma_f32_16x16x16_bf16 v[164:167], a[174:175], a[192:193], v[164:167]
    v_exp_f32 v5, v5
    v_exp_f32 v6, v6
    v_mfma_f32_16x16x16_bf16 v[168:171], a[160:161], a[194:195], v[168:171]
    v_exp_f32 v7, v7
    v_exp_f32 v8, v8
    v_mfma_f32_16x16x16_bf16 v[172:175], a[174:175], a[194:195], v[172:175]
    v_exp_f32_e64 v9, v9
    v_pk_mul_f32 v[132:133], v[132:133], v[128:129]
    v_pk_mul_f32 v[134:135], v[134:135], v[130:131]
    v_pk_mul_f32 v[140:141], v[140:141], v[136:137]
    v_pk_mul_f32 v[142:143], v[142:143], v[138:139]
    v_pk_fma_f32 v[2:3], v[2:3], v[14:15], v[14:15] op_sel_hi:[1,0,0]
    v_pk_fma_f32 v[4:5], v[4:5], v[14:15], v[14:15] op_sel_hi:[1,0,0]
    v_pk_fma_f32 v[6:7], v[6:7], v[18:19], v[18:19] op_sel_hi:[1,0,0]
    v_pk_fma_f32 v[8:9], v[8:9], v[18:19], v[18:19] op_sel_hi:[1,0,0]
    s_add_u32 s23, s23, 7168
    buffer_load_dwordx4 v1, s[12:15], s23 offen offset:1024 lds
    v_rcp_f32 v2, v2
    v_rcp_f32 v3, v3
    v_rcp_f32 v4, v4
    v_rcp_f32 v5, v5
    v_rcp_f32 v6, v6
    v_rcp_f32 v7, v7
    v_rcp_f32 v8, v8
    v_rcp_f32 v9, v9
    s_mov_b32 s48, 196608
    v_pk_mul_f32 v[132:133], v[132:133], v[2:3]
    v_pk_mul_f32 v[134:135], v[134:135], v[4:5]
    v_pk_mul_f32 v[140:141], v[140:141], v[6:7]
    v_pk_mul_f32 v[142:143], v[142:143], v[8:9]
    v_cvt_pk_bf16_f32 v128, v132, v133
    v_cvt_pk_bf16_f32 v130, v140, v141
    v_cvt_pk_bf16_f32 v129, v134, v135
    v_cvt_pk_bf16_f32 v131, v142, v143
    v_accvgpr_write_b32 a18, v128
    v_accvgpr_write_b32 a19, v129
    v_accvgpr_write_b32 a22, v130
    v_accvgpr_write_b32 a23, v131
    v_permlane16_swap_b32 v128, v130
    v_permlane16_swap_b32 v129, v131
    buffer_store_dwordx4 v[128:131], v28, s[8:11], s48 offen offset:0 sc1
    v_pk_mul_f32 v[2:3], v[144:145], v[144:145]
    v_pk_mul_f32 v[4:5], v[146:147], v[146:147]
    v_pk_mul_f32 v[6:7], v[152:153], v[152:153]
    v_pk_mul_f32 v[8:9], v[154:155], v[154:155]
    v_pk_fma_f32 v[2:3], v[2:3], v[20:21], v[20:21] op_sel:[0,1,0] op_sel_hi:[1,1,0]
    v_pk_fma_f32 v[4:5], v[4:5], v[20:21], v[20:21] op_sel:[0,1,0] op_sel_hi:[1,1,0]
    v_pk_fma_f32 v[6:7], v[6:7], v[24:25], v[24:25] op_sel:[0,1,0] op_sel_hi:[1,1,0]
    v_pk_fma_f32 v[8:9], v[8:9], v[24:25], v[24:25] op_sel:[0,1,0] op_sel_hi:[1,1,0]
    v_pk_mul_f32 v[2:3], v[2:3], v[144:145]
    v_pk_mul_f32 v[4:5], v[4:5], v[146:147]
    v_pk_mul_f32 v[6:7], v[6:7], v[152:153]
    v_pk_mul_f32 v[8:9], v[8:9], v[154:155]
    s_add_u32 s23, s23, 7168
    buffer_load_dwordx4 v0, s[12:15], s23 offen offset:2048 lds
    v_exp_f32 v2, v2
    v_mfma_f32_16x16x16_bf16 v[176:179], a[160:161], a[196:197], v[176:179]
    v_exp_f32 v3, v3
    v_exp_f32 v4, v4
    v_mfma_f32_16x16x16_bf16 v[180:183], a[174:175], a[196:197], v[180:183]
    v_exp_f32 v5, v5
    v_exp_f32 v6, v6
    v_mfma_f32_16x16x16_bf16 v[184:187], a[160:161], a[198:199], v[184:187]
    v_exp_f32 v7, v7
    v_exp_f32 v8, v8
    v_mfma_f32_16x16x16_bf16 v[188:191], a[174:175], a[198:199], v[188:191]
    v_exp_f32 v9, v9
    v_pk_mul_f32 v[148:149], v[148:149], v[144:145]
    v_pk_mul_f32 v[150:151], v[150:151], v[146:147]
    v_pk_mul_f32 v[156:157], v[156:157], v[152:153]
    v_pk_mul_f32 v[158:159], v[158:159], v[154:155]
    v_pk_fma_f32 v[2:3], v[2:3], v[22:23], v[22:23] op_sel_hi:[1,0,0]
    v_pk_fma_f32 v[4:5], v[4:5], v[22:23], v[22:23] op_sel_hi:[1,0,0]
    v_pk_fma_f32 v[6:7], v[6:7], v[26:27], v[26:27] op_sel_hi:[1,0,0]
    v_pk_fma_f32 v[8:9], v[8:9], v[26:27], v[26:27] op_sel_hi:[1,0,0]
    s_add_u32 s23, s23, 7168
    buffer_load_dwordx4 v0, s[12:15], s23 offen offset:3072 lds
    v_rcp_f32 v2, v2
    v_rcp_f32 v3, v3
    v_rcp_f32 v4, v4
    v_rcp_f32 v5, v5
    v_rcp_f32 v6, v6
    v_rcp_f32 v7, v7
    v_rcp_f32 v8, v8
    v_rcp_f32 v9, v9
    s_mov_b32 s48, 196608
    v_pk_mul_f32 v[148:149], v[148:149], v[2:3]
    v_pk_mul_f32 v[150:151], v[150:151], v[4:5]
    v_pk_mul_f32 v[156:157], v[156:157], v[6:7]
    v_pk_mul_f32 v[158:159], v[158:159], v[8:9]
    v_cvt_pk_bf16_f32 v144, v148, v149
    v_cvt_pk_bf16_f32 v146, v156, v157
    v_cvt_pk_bf16_f32 v145, v150, v151
    v_cvt_pk_bf16_f32 v147, v158, v159
    v_accvgpr_write_b32 a26, v144
    v_accvgpr_write_b32 a27, v145
    v_accvgpr_write_b32 a30, v146
    v_accvgpr_write_b32 a31, v147
    v_permlane16_swap_b32 v144, v146
    v_permlane16_swap_b32 v145, v147
    buffer_store_dwordx4 v[144:147], v28, s[8:11], s48 offen offset:512 sc1
    v_pk_mul_f32 v[2:3], v[160:161], v[160:161]
    v_pk_mul_f32 v[4:5], v[162:163], v[162:163]
    v_pk_mul_f32 v[6:7], v[168:169], v[168:169]
    v_pk_mul_f32 v[8:9], v[170:171], v[170:171]
    v_pk_fma_f32 v[2:3], v[2:3], v[12:13], v[12:13] op_sel:[0,1,0] op_sel_hi:[1,1,0]
    v_pk_fma_f32 v[4:5], v[4:5], v[12:13], v[12:13] op_sel:[0,1,0] op_sel_hi:[1,1,0]
    v_pk_fma_f32 v[6:7], v[6:7], v[16:17], v[16:17] op_sel:[0,1,0] op_sel_hi:[1,1,0]
    v_pk_fma_f32 v[8:9], v[8:9], v[16:17], v[16:17] op_sel:[0,1,0] op_sel_hi:[1,1,0]
    v_pk_mul_f32 v[2:3], v[2:3], v[160:161]
    v_pk_mul_f32 v[4:5], v[4:5], v[162:163]
    v_pk_mul_f32 v[6:7], v[6:7], v[168:169]
    v_pk_mul_f32 v[8:9], v[8:9], v[170:171]
    s_add_u32 m0, s24, 81920
    s_lshr_b32 s23, 0x32312d2c, s34
    s_and_b32 s23, s23, 0xff
    s_lshl4_add_u32 s23, s23, s35
    s_sub_u32 s22, s23, 896
    s_cselect_b32 s23, s23, s22
    s_lshl_b32 s23, s23, 11
    buffer_load_dwordx4 v1, s[12:15], s23 offen offset:0 lds
    v_exp_f32 v2, v2
    v_mfma_f32_16x16x16_bf16 v[192:195], a[162:163], a[192:193], v[192:195]
    v_exp_f32 v3, v3
    v_exp_f32 v4, v4
    v_mfma_f32_16x16x16_bf16 v[196:199], a[248:249], a[192:193], v[196:199]
    v_exp_f32 v5, v5
    v_exp_f32 v6, v6
    v_mfma_f32_16x16x16_bf16 v[200:203], a[162:163], a[194:195], v[200:203]
    v_exp_f32 v7, v7
    v_exp_f32 v8, v8
    v_mfma_f32_16x16x16_bf16 v[204:207], a[248:249], a[194:195], v[204:207]
    v_exp_f32_e64 v9, v9
    v_pk_mul_f32 v[164:165], v[164:165], v[160:161]
    v_pk_mul_f32 v[166:167], v[166:167], v[162:163]
    v_pk_mul_f32 v[172:173], v[172:173], v[168:169]
    v_pk_mul_f32 v[174:175], v[174:175], v[170:171]
    v_pk_fma_f32 v[2:3], v[2:3], v[14:15], v[14:15] op_sel_hi:[1,0,0]
    v_pk_fma_f32 v[4:5], v[4:5], v[14:15], v[14:15] op_sel_hi:[1,0,0]
    v_pk_fma_f32 v[6:7], v[6:7], v[18:19], v[18:19] op_sel_hi:[1,0,0]
    v_pk_fma_f32 v[8:9], v[8:9], v[18:19], v[18:19] op_sel_hi:[1,0,0]
    s_add_u32 s23, s23, 7168
    buffer_load_dwordx4 v1, s[12:15], s23 offen offset:1024 lds
    v_rcp_f32 v2, v2
    v_rcp_f32 v3, v3
    v_rcp_f32 v4, v4
    v_rcp_f32 v5, v5
    v_rcp_f32 v6, v6
    v_rcp_f32 v7, v7
    v_rcp_f32 v8, v8
    v_rcp_f32 v9, v9
    s_mov_b32 s48, 262144
    v_pk_mul_f32 v[164:165], v[164:165], v[2:3]
    v_pk_mul_f32 v[166:167], v[166:167], v[4:5]
    v_pk_mul_f32 v[172:173], v[172:173], v[6:7]
    v_pk_mul_f32 v[174:175], v[174:175], v[8:9]
    v_cvt_pk_bf16_f32 v160, v164, v165
    v_cvt_pk_bf16_f32 v162, v172, v173
    v_cvt_pk_bf16_f32 v161, v166, v167
    v_cvt_pk_bf16_f32 v163, v174, v175
    v_accvgpr_write_b32 a32, v160
    v_accvgpr_write_b32 a33, v161
    v_accvgpr_write_b32 a36, v162
    v_accvgpr_write_b32 a37, v163
    v_permlane16_swap_b32 v160, v162
    v_permlane16_swap_b32 v161, v163
    buffer_store_dwordx4 v[160:163], v28, s[8:11], s48 offen offset:0 sc1
    v_pk_mul_f32 v[2:3], v[176:177], v[176:177]
    v_pk_mul_f32 v[4:5], v[178:179], v[178:179]
    v_pk_mul_f32 v[6:7], v[184:185], v[184:185]
    v_pk_mul_f32 v[8:9], v[186:187], v[186:187]
    v_pk_fma_f32 v[2:3], v[2:3], v[20:21], v[20:21] op_sel:[0,1,0] op_sel_hi:[1,1,0]
    v_pk_fma_f32 v[4:5], v[4:5], v[20:21], v[20:21] op_sel:[0,1,0] op_sel_hi:[1,1,0]
    v_pk_fma_f32 v[6:7], v[6:7], v[24:25], v[24:25] op_sel:[0,1,0] op_sel_hi:[1,1,0]
    v_pk_fma_f32 v[8:9], v[8:9], v[24:25], v[24:25] op_sel:[0,1,0] op_sel_hi:[1,1,0]
    v_pk_mul_f32 v[2:3], v[2:3], v[176:177]
    v_pk_mul_f32 v[4:5], v[4:5], v[178:179]
    v_pk_mul_f32 v[6:7], v[6:7], v[184:185]
    v_pk_mul_f32 v[8:9], v[8:9], v[186:187]
    s_add_u32 s23, s23, 7168
    buffer_load_dwordx4 v0, s[12:15], s23 offen offset:2048 lds
    v_exp_f32 v2, v2
    v_mfma_f32_16x16x16_bf16 v[208:211], a[162:163], a[196:197], v[208:211]
    v_exp_f32 v3, v3
    v_exp_f32 v4, v4
    v_mfma_f32_16x16x16_bf16 v[212:215], a[248:249], a[196:197], v[212:215]
    v_exp_f32 v5, v5
    v_exp_f32 v6, v6
    v_mfma_f32_16x16x16_bf16 v[216:219], a[162:163], a[198:199], v[216:219]
    v_exp_f32 v7, v7
    v_exp_f32 v8, v8
    v_mfma_f32_16x16x16_bf16 v[220:223], a[248:249], a[198:199], v[220:223]
    v_exp_f32 v9, v9
    v_pk_mul_f32 v[180:181], v[180:181], v[176:177]
    v_pk_mul_f32 v[182:183], v[182:183], v[178:179]
    v_pk_mul_f32 v[188:189], v[188:189], v[184:185]
    v_pk_mul_f32 v[190:191], v[190:191], v[186:187]
    v_pk_fma_f32 v[2:3], v[2:3], v[22:23], v[22:23] op_sel_hi:[1,0,0]
    v_pk_fma_f32 v[4:5], v[4:5], v[22:23], v[22:23] op_sel_hi:[1,0,0]
    v_pk_fma_f32 v[6:7], v[6:7], v[26:27], v[26:27] op_sel_hi:[1,0,0]
    v_pk_fma_f32 v[8:9], v[8:9], v[26:27], v[26:27] op_sel_hi:[1,0,0]
    s_add_u32 s23, s23, 7168
    buffer_load_dwordx4 v0, s[12:15], s23 offen offset:3072 lds
    v_rcp_f32 v2, v2
    v_rcp_f32 v3, v3
    v_rcp_f32 v4, v4
    v_rcp_f32 v5, v5
    v_rcp_f32 v6, v6
    v_rcp_f32 v7, v7
    v_rcp_f32 v8, v8
    v_rcp_f32 v9, v9
    s_mov_b32 s48, 262144
    v_pk_mul_f32 v[180:181], v[180:181], v[2:3]
    v_pk_mul_f32 v[182:183], v[182:183], v[4:5]
    v_pk_mul_f32 v[188:189], v[188:189], v[6:7]
    v_pk_mul_f32 v[190:191], v[190:191], v[8:9]
    v_cvt_pk_bf16_f32 v176, v180, v181
    v_cvt_pk_bf16_f32 v178, v188, v189
    v_cvt_pk_bf16_f32 v177, v182, v183
    v_cvt_pk_bf16_f32 v179, v190, v191
    v_accvgpr_write_b32 a40, v176
    v_accvgpr_write_b32 a41, v177
    v_accvgpr_write_b32 a44, v178
    v_accvgpr_write_b32 a45, v179
    v_permlane16_swap_b32 v176, v178
    v_permlane16_swap_b32 v177, v179
    buffer_store_dwordx4 v[176:179], v28, s[8:11], s48 offen offset:512 sc1
    s_lshl_b32 s26, s52, 8
    s_lshl_b32 s49, s94, 6
    s_add_u32 s26, s26, s49
    v_and_b32 v36, 15, v30
    v_add_u32 v36, s26, v36
    v_lshrrev_b32 v37, 4, v30
    v_lshl_add_u32 v10, v37, 11, v36
    v_lshlrev_b32_e64 v10, 4, v10
    s_mul_i32 s20, s54, 3670016
    s_add_u32 s19, s20, 3670016
    s_lshl_b32 s18, s35, 12
    s_add_u32 s18, s18, s20
    v_and_b32_e64 v39, 3, v30
    v_bfe_u32 v40, v30, 2, 1
    v_lshl_add_u32 v40, v39, 6, v40
    s_and_b32 s49, s2, 0x3e
    v_add_u32 v40, s49, v40
    v_lshlrev_b32_e64 v29, 6, v40
    s_mov_b32 s33, 32768
    s_waitcnt vmcnt(6)
    s_barrier
    s_cmp_lg_u32 s94, 0
    s_cbranch_scc1 L_mk_fl_28
    s_lshl_b32 s48, s2, 6
    s_add_u32 s48, s48, 32768
    v_mov_b32 v36, s92
    v_mov_b32 v37, s93
    v_mov_b32_e64 v38, 0
    s_mov_b64 exec, 1
    buffer_store_dwordx2 v[36:37], v38, s[60:63], s48 offen sc1
    s_mov_b64 exec, -1
L_mk_fl_28:
    s_nop 0
    v_pk_mul_f32 v[2:3], v[192:193], v[192:193]
    v_pk_mul_f32 v[4:5], v[194:195], v[194:195]
    v_pk_mul_f32 v[6:7], v[200:201], v[200:201]
    v_pk_mul_f32 v[8:9], v[202:203], v[202:203]
    v_pk_fma_f32 v[2:3], v[2:3], v[12:13], v[12:13] op_sel:[0,1,0] op_sel_hi:[1,1,0]
    v_pk_fma_f32 v[4:5], v[4:5], v[12:13], v[12:13] op_sel:[0,1,0] op_sel_hi:[1,1,0]
    v_pk_fma_f32 v[6:7], v[6:7], v[16:17], v[16:17] op_sel:[0,1,0] op_sel_hi:[1,1,0]
    v_pk_fma_f32 v[8:9], v[8:9], v[16:17], v[16:17] op_sel:[0,1,0] op_sel_hi:[1,1,0]
    v_pk_mul_f32 v[2:3], v[2:3], v[192:193]
    v_pk_mul_f32 v[4:5], v[4:5], v[194:195]
    v_pk_mul_f32 v[6:7], v[6:7], v[200:201]
    v_pk_mul_f32 v[8:9], v[8:9], v[202:203]
    s_add_u32 m0, s24, 98304
    s_lshr_b32 s23, 0xc0b3433, s34
    s_and_b32 s23, s23, 0xff
    s_lshl4_add_u32 s23, s23, s35
    s_sub_u32 s22, s23, 896
    s_cselect_b32 s23, s23, s22
    s_lshl_b32 s23, s23, 11
    buffer_load_dwordx4 v1, s[12:15], s23 offen offset:0 lds
    v_exp_f32 v2, v2
    v_mfma_f32_16x16x16_bf16 v[224:227], a[164:165], a[192:193], v[224:227]
    v_exp_f32 v3, v3
    v_exp_f32 v4, v4
    v_mfma_f32_16x16x16_bf16 v[228:231], a[250:251], a[192:193], v[228:231]
    v_exp_f32 v5, v5
    v_exp_f32 v6, v6
    v_mfma_f32_16x16x16_bf16 v[232:235], a[164:165], a[194:195], v[232:235]
    v_exp_f32 v7, v7
    v_exp_f32 v8, v8
    v_mfma_f32_16x16x16_bf16 v[236:239], a[250:251], a[194:195], v[236:239]
    v_exp_f32_e64 v9, v9
    v_pk_mul_f32 v[196:197], v[196:197], v[192:193]
    v_pk_mul_f32 v[198:199], v[198:199], v[194:195]
    v_pk_mul_f32 v[204:205], v[204:205], v[200:201]
    v_pk_mul_f32 v[206:207], v[206:207], v[202:203]
    v_pk_fma_f32 v[2:3], v[2:3], v[14:15], v[14:15] op_sel_hi:[1,0,0]
    v_pk_fma_f32 v[4:5], v[4:5], v[14:15], v[14:15] op_sel_hi:[1,0,0]
    v_pk_fma_f32 v[6:7], v[6:7], v[18:19], v[18:19] op_sel_hi:[1,0,0]
    v_pk_fma_f32 v[8:9], v[8:9], v[18:19], v[18:19] op_sel_hi:[1,0,0]
    s_add_u32 s23, s23, 7168
    buffer_load_dwordx4 v1, s[12:15], s23 offen offset:1024 lds
    v_rcp_f32 v2, v2
    v_rcp_f32 v3, v3
    v_rcp_f32 v4, v4
    v_rcp_f32 v5, v5
    v_rcp_f32 v6, v6
    v_rcp_f32 v7, v7
    v_rcp_f32 v8, v8
    v_rcp_f32 v9, v9
    s_mov_b32 s48, 327680
    v_pk_mul_f32 v[196:197], v[196:197], v[2:3]
    v_pk_mul_f32 v[198:199], v[198:199], v[4:5]
    v_pk_mul_f32 v[204:205], v[204:205], v[6:7]
    v_pk_mul_f32 v[206:207], v[206:207], v[8:9]
    v_cvt_pk_bf16_f32 v192, v196, v197
    v_cvt_pk_bf16_f32 v194, v204, v205
    v_cvt_pk_bf16_f32 v193, v198, v199
    v_cvt_pk_bf16_f32 v195, v206, v207
    v_accvgpr_write_b32 a34, v192
    v_accvgpr_write_b32 a35, v193
    v_accvgpr_write_b32 a38, v194
    v_accvgpr_write_b32 a39, v195
    v_permlane16_swap_b32 v192, v194
    v_permlane16_swap_b32 v193, v195
    buffer_store_dwordx4 v[192:195], v28, s[8:11], s48 offen offset:0 sc1
    v_pk_mul_f32 v[2:3], v[208:209], v[208:209]
    v_pk_mul_f32 v[4:5], v[210:211], v[210:211]
    v_pk_mul_f32 v[6:7], v[216:217], v[216:217]
    v_pk_mul_f32 v[8:9], v[218:219], v[218:219]
    v_pk_fma_f32 v[2:3], v[2:3], v[20:21], v[20:21] op_sel:[0,1,0] op_sel_hi:[1,1,0]
    v_pk_fma_f32 v[4:5], v[4:5], v[20:21], v[20:21] op_sel:[0,1,0] op_sel_hi:[1,1,0]
    v_pk_fma_f32 v[6:7], v[6:7], v[24:25], v[24:25] op_sel:[0,1,0] op_sel_hi:[1,1,0]
    v_pk_fma_f32 v[8:9], v[8:9], v[24:25], v[24:25] op_sel:[0,1,0] op_sel_hi:[1,1,0]
    v_pk_mul_f32 v[2:3], v[2:3], v[208:209]
    v_pk_mul_f32 v[4:5], v[4:5], v[210:211]
    v_pk_mul_f32 v[6:7], v[6:7], v[216:217]
    v_pk_mul_f32 v[8:9], v[8:9], v[218:219]
    s_add_u32 s23, s23, 7168
    buffer_load_dwordx4 v0, s[12:15], s23 offen offset:2048 lds
    v_exp_f32 v2, v2
    v_mfma_f32_16x16x16_bf16 v[240:243], a[164:165], a[196:197], v[240:243]
    v_exp_f32 v3, v3
    v_exp_f32 v4, v4
    v_mfma_f32_16x16x16_bf16 v[244:247], a[250:251], a[196:197], v[244:247]
    v_exp_f32 v5, v5
    v_exp_f32 v6, v6
    v_mfma_f32_16x16x16_bf16 v[248:251], a[164:165], a[198:199], v[248:251]
    v_exp_f32 v7, v7
    v_exp_f32 v8, v8
    v_mfma_f32_16x16x16_bf16 v[252:255], a[250:251], a[198:199], v[252:255]
    v_exp_f32 v9, v9
    v_pk_mul_f32 v[212:213], v[212:213], v[208:209]
    v_pk_mul_f32 v[214:215], v[214:215], v[210:211]
    v_pk_mul_f32 v[220:221], v[220:221], v[216:217]
    v_pk_mul_f32 v[222:223], v[222:223], v[218:219]
    v_pk_fma_f32 v[2:3], v[2:3], v[22:23], v[22:23] op_sel_hi:[1,0,0]
    v_pk_fma_f32 v[4:5], v[4:5], v[22:23], v[22:23] op_sel_hi:[1,0,0]
    v_pk_fma_f32 v[6:7], v[6:7], v[26:27], v[26:27] op_sel_hi:[1,0,0]
    v_pk_fma_f32 v[8:9], v[8:9], v[26:27], v[26:27] op_sel_hi:[1,0,0]
    s_add_u32 s23, s23, 7168
    buffer_load_dwordx4 v0, s[12:15], s23 offen offset:3072 lds
    v_rcp_f32 v2, v2
    v_rcp_f32 v3, v3
    v_rcp_f32 v4, v4
    v_rcp_f32 v5, v5
    v_rcp_f32 v6, v6
    v_rcp_f32 v7, v7
    v_rcp_f32 v8, v8
    v_rcp_f32 v9, v9
    s_mov_b32 s48, 327680
    v_pk_mul_f32 v[212:213], v[212:213], v[2:3]
    v_pk_mul_f32 v[214:215], v[214:215], v[4:5]
    v_pk_mul_f32 v[220:221], v[220:221], v[6:7]
    v_pk_mul_f32 v[222:223], v[222:223], v[8:9]
    v_cvt_pk_bf16_f32 v208, v212, v213
    v_cvt_pk_bf16_f32 v210, v220, v221
    v_cvt_pk_bf16_f32 v209, v214, v215
    v_cvt_pk_bf16_f32 v211, v222, v223
    v_accvgpr_write_b32 a42, v208
    v_accvgpr_write_b32 a43, v209
    v_accvgpr_write_b32 a46, v210
    v_accvgpr_write_b32 a47, v211
    v_permlane16_swap_b32 v208, v210
    v_permlane16_swap_b32 v209, v211
    buffer_store_dwordx4 v[208:211], v28, s[8:11], s48 offen offset:512 sc1
    v_pk_mul_f32 v[2:3], v[224:225], v[224:225]
    v_pk_mul_f32 v[4:5], v[226:227], v[226:227]
    v_pk_mul_f32 v[6:7], v[232:233], v[232:233]
    v_pk_mul_f32 v[8:9], v[234:235], v[234:235]
    v_pk_fma_f32 v[2:3], v[2:3], v[12:13], v[12:13] op_sel:[0,1,0] op_sel_hi:[1,1,0]
    v_pk_fma_f32 v[4:5], v[4:5], v[12:13], v[12:13] op_sel:[0,1,0] op_sel_hi:[1,1,0]
    v_pk_fma_f32 v[6:7], v[6:7], v[16:17], v[16:17] op_sel:[0,1,0] op_sel_hi:[1,1,0]
    v_pk_fma_f32 v[8:9], v[8:9], v[16:17], v[16:17] op_sel:[0,1,0] op_sel_hi:[1,1,0]
    v_pk_mul_f32 v[2:3], v[2:3], v[224:225]
    v_pk_mul_f32 v[4:5], v[4:5], v[226:227]
    v_pk_mul_f32 v[6:7], v[6:7], v[232:233]
    v_pk_mul_f32 v[8:9], v[8:9], v[234:235]
    s_add_u32 m0, s24, 114688
    s_lshr_b32 s23, 0x1a191312, s34
    s_and_b32 s23, s23, 0xff
    s_lshl4_add_u32 s23, s23, s35
    s_sub_u32 s22, s23, 896
    s_cselect_b32 s23, s23, s22
    s_lshl_b32 s23, s23, 11
    buffer_load_dwordx4 v1, s[12:15], s23 offen offset:0 lds
    v_exp_f32 v2, v2
    v_exp_f32 v3, v3
    v_exp_f32 v4, v4
    v_exp_f32 v5, v5
    v_exp_f32 v6, v6
    v_exp_f32 v7, v7
    v_exp_f32 v8, v8
    v_exp_f32_e64 v9, v9
    v_pk_mul_f32 v[228:229], v[228:229], v[224:225]
    v_pk_mul_f32 v[230:231], v[230:231], v[226:227]
    v_pk_mul_f32 v[236:237], v[236:237], v[232:233]
    v_pk_mul_f32 v[238:239], v[238:239], v[234:235]
    v_pk_fma_f32 v[2:3], v[2:3], v[14:15], v[14:15] op_sel_hi:[1,0,0]
    v_pk_fma_f32 v[4:5], v[4:5], v[14:15], v[14:15] op_sel_hi:[1,0,0]
    v_pk_fma_f32 v[6:7], v[6:7], v[18:19], v[18:19] op_sel_hi:[1,0,0]
    v_pk_fma_f32 v[8:9], v[8:9], v[18:19], v[18:19] op_sel_hi:[1,0,0]
    s_add_u32 s23, s23, 7168
    buffer_load_dwordx4 v1, s[12:15], s23 offen offset:1024 lds
    v_rcp_f32 v2, v2
    v_rcp_f32 v3, v3
    v_rcp_f32 v4, v4
    v_rcp_f32 v5, v5
    v_rcp_f32 v6, v6
    v_rcp_f32 v7, v7
    v_rcp_f32 v8, v8
    v_rcp_f32 v9, v9
    s_mov_b32 s48, 393216
    v_pk_mul_f32 v[228:229], v[228:229], v[2:3]
    v_pk_mul_f32 v[230:231], v[230:231], v[4:5]
    v_pk_mul_f32 v[236:237], v[236:237], v[6:7]
    v_pk_mul_f32 v[238:239], v[238:239], v[8:9]
    v_cvt_pk_bf16_f32 v224, v228, v229
    v_cvt_pk_bf16_f32 v226, v236, v237
    v_cvt_pk_bf16_f32 v225, v230, v231
    v_cvt_pk_bf16_f32 v227, v238, v239
    v_permlane16_swap_b32 v224, v226
    s_nop 0
    v_permlane16_swap_b32 v225, v227
    buffer_store_dwordx4 v[224:227], v28, s[8:11], s48 offen offset:0 sc1
    buffer_load_dwordx2 v[192:193], v29, s[60:63], s33 offen sc1
    v_lshrrev_b32 v44, 2, v30
    v_lshlrev_b32 v184, 8, v44
    v_lshrrev_b32 v41, 5, v30
    v_and_b32_e64 v43, 3, v44
    v_lshl_add_u32 v43, v41, 2, v43
    s_lshl_b32 s50, s54, 1
    v_xor_b32 v43, s50, v43
    v_lshl_add_u32 v184, v43, 5, v184
    v_and_b32_e64 v43, 3, v30
    v_lshl_add_u32 v184, v43, 3, v184
    v_xor_b32 v185, 32, v184
    v_xor_b32 v186, 64, v184
    v_xor_b32 v187, 96, v184
    v_xor_b32 v188, 128, v184
    v_xor_b32 v189, 160, v184
    v_xor_b32 v190, 192, v184
    v_xor_b32 v191, 224, v184
    v_pk_mul_f32 v[2:3], v[240:241], v[240:241]
    v_pk_mul_f32 v[4:5], v[242:243], v[242:243]
    v_pk_mul_f32 v[6:7], v[248:249], v[248:249]
    v_pk_mul_f32 v[8:9], v[250:251], v[250:251]
    v_pk_fma_f32 v[2:3], v[2:3], v[20:21], v[20:21] op_sel:[0,1,0] op_sel_hi:[1,1,0]
    v_pk_fma_f32 v[4:5], v[4:5], v[20:21], v[20:21] op_sel:[0,1,0] op_sel_hi:[1,1,0]
    v_pk_fma_f32 v[6:7], v[6:7], v[24:25], v[24:25] op_sel:[0,1,0] op_sel_hi:[1,1,0]
    v_pk_fma_f32 v[8:9], v[8:9], v[24:25], v[24:25] op_sel:[0,1,0] op_sel_hi:[1,1,0]
    v_pk_mul_f32 v[2:3], v[2:3], v[240:241]
    v_pk_mul_f32 v[4:5], v[4:5], v[242:243]
    v_pk_mul_f32 v[6:7], v[6:7], v[248:249]
    v_pk_mul_f32 v[8:9], v[8:9], v[250:251]
    s_add_u32 s23, s23, 7168
    buffer_load_dwordx4 v0, s[12:15], s23 offen offset:2048 lds
    v_exp_f32 v2, v2
    v_exp_f32 v3, v3
    v_exp_f32 v4, v4
    v_exp_f32 v5, v5
    v_exp_f32 v6, v6
    v_exp_f32 v7, v7
    v_exp_f32 v8, v8
    v_exp_f32 v9, v9
    v_pk_mul_f32 v[244:245], v[244:245], v[240:241]
    v_pk_mul_f32 v[246:247], v[246:247], v[242:243]
    v_pk_mul_f32 v[252:253], v[252:253], v[248:249]
    v_pk_mul_f32 v[254:255], v[254:255], v[250:251]
    v_pk_fma_f32 v[2:3], v[2:3], v[22:23], v[22:23] op_sel_hi:[1,0,0]
    v_pk_fma_f32 v[4:5], v[4:5], v[22:23], v[22:23] op_sel_hi:[1,0,0]
    v_pk_fma_f32 v[6:7], v[6:7], v[26:27], v[26:27] op_sel_hi:[1,0,0]
    v_pk_fma_f32 v[8:9], v[8:9], v[26:27], v[26:27] op_sel_hi:[1,0,0]
    s_add_u32 s23, s23, 7168
    buffer_load_dwordx4 v0, s[12:15], s23 offen offset:3072 lds
    v_rcp_f32 v2, v2
    v_rcp_f32 v3, v3
    v_rcp_f32 v4, v4
    v_rcp_f32 v5, v5
    v_rcp_f32 v6, v6
    v_rcp_f32 v7, v7
    v_rcp_f32 v8, v8
    v_rcp_f32 v9, v9
    s_mov_b32 s48, 393216
    v_pk_mul_f32 v[244:245], v[244:245], v[2:3]
    v_pk_mul_f32 v[246:247], v[246:247], v[4:5]
    v_pk_mul_f32 v[252:253], v[252:253], v[6:7]
    v_pk_mul_f32 v[254:255], v[254:255], v[8:9]
    v_cvt_pk_bf16_f32 v240, v244, v245
    v_cvt_pk_bf16_f32 v242, v252, v253
    v_cvt_pk_bf16_f32 v241, v246, v247
    v_cvt_pk_bf16_f32 v243, v254, v255
    v_permlane16_swap_b32 v240, v242
    s_nop 0
    v_permlane16_swap_b32 v241, v243
    s_nop 0
    buffer_store_dwordx4 v[240:243], v28, s[8:11], s48 offen offset:512 sc1
    ds_read_b64_tr_b16 a[224:225], v184 offset:0
    ds_read_b64_tr_b16 a[226:227], v184 offset:4096
    ds_read_b64_tr_b16 a[228:229], v185 offset:0
    ds_read_b64_tr_b16 a[230:231], v185 offset:4096
    ds_read_b64_tr_b16 a[232:233], v186 offset:0
    ds_read_b64_tr_b16 a[234:235], v186 offset:4096
    ds_read_b64_tr_b16 a[236:237], v187 offset:0
    ds_read_b64_tr_b16 a[238:239], v187 offset:4096
    s_waitcnt vmcnt(63) lgkmcnt(0)
    v_mfma_f32_16x16x32_bf16 v[32:35], a[224:227], a[0:3], 0
    ds_read_b64_tr_b16 a[240:241], v188 offset:0
    v_lshrrev_b32 v5, 4, v30
    v_mfma_f32_16x16x32_bf16 v[40:43], a[224:227], a[4:7], 0
    ds_read_b64_tr_b16 a[242:243], v188 offset:4096
    v_bfe_u32 v7, v30, 2, 2
    v_mfma_f32_16x16x32_bf16 v[48:51], a[224:227], a[8:11], 0
    ds_read_b64_tr_b16 a[244:245], v189 offset:0
    v_lshl_add_u32 v8, v5, 3, v7
    v_mfma_f32_16x16x32_bf16 v[56:59], a[224:227], a[12:15], 0
    v_lshlrev_b32 v160, 8, v8
    v_mfma_f32_16x16x32_bf16 v[60:63], a[228:231], a[12:15], 0
    ds_read_b64_tr_b16 a[246:247], v189 offset:4096
    v_bfe_u32 v7, v30, 2, 3
    v_mfma_f32_16x16x32_bf16 v[52:55], a[228:231], a[8:11], 0
    ds_read_b64_tr_b16 a[248:249], v190 offset:0
    s_lshl_b32 s50, s54, 1
    v_mfma_f32_16x16x32_bf16 v[44:47], a[228:231], a[4:7], 0
    ds_read_b64_tr_b16 a[250:251], v190 offset:4096
    v_xor_b32 v7, s50, v7
    v_mfma_f32_16x16x32_bf16 v[36:39], a[228:231], a[0:3], 0
    v_lshl_add_u32 v160, v7, 5, v160
    v_mfma_f32_16x16x32_bf16 v[64:67], a[232:235], a[0:3], 0
    ds_read_b64_tr_b16 a[252:253], v191 offset:0
    v_and_b32 v7, 3, v30
    v_mfma_f32_16x16x32_bf16 v[72:75], a[232:235], a[4:7], 0
    ds_read_b64_tr_b16 a[254:255], v191 offset:4096
    v_lshl_add_u32 v160, v7, 3, v160
    v_mfma_f32_16x16x32_bf16 v[80:83], a[232:235], a[8:11], 0
    v_xor_b32 v161, 32, v160
    v_mfma_f32_16x16x32_bf16 v[88:91], a[232:235], a[12:15], 0
    v_xor_b32 v162, 64, v160
    v_mfma_f32_16x16x32_bf16 v[92:95], a[236:239], a[12:15], 0
    v_xor_b32 v163, 96, v160
    v_mfma_f32_16x16x32_bf16 v[84:87], a[236:239], a[8:11], 0
    v_xor_b32 v164, 128, v160
    v_mfma_f32_16x16x32_bf16 v[76:79], a[236:239], a[4:7], 0
    v_xor_b32 v165, 160, v160
    v_mfma_f32_16x16x32_bf16 v[68:71], a[236:239], a[0:3], 0
    v_xor_b32 v166, 192, v160
    s_waitcnt vmcnt(3) lgkmcnt(0)
    v_cmp_ne_u64_e64 vcc, s[92:93], v[192:193]
    s_cbranch_vccz L_mk_faok_29
    s_mov_b32 s49, 32768
    s_mov_b32 s96, 0
L_mk_poll_30:
    buffer_load_dwordx2 v[192:193], v29, s[60:63], s49 offen sc1
    s_waitcnt vmcnt(0)
    v_cmp_ne_u64 vcc, s[92:93], v[192:193]
    s_cbranch_vccz L_mk_pdone_31
    s_mov_b64 exec, vcc
    s_add_u32 s96, s96, 1
    s_cmp_lt_u32 s96, 400000
    s_cbranch_scc1 L_mk_poll_30
L_mk_pdone_31:
    s_mov_b64 exec, -1
L_mk_faok_29:
    v_mfma_f32_16x16x32_bf16 v[96:99], a[240:243], a[0:3], 0
    ds_read_b64_tr_b16 a[224:225], v184 offset:8192
    s_add_u32 s21, s18, 458752
    v_mfma_f32_16x16x32_bf16 v[104:107], a[240:243], a[4:7], 0
    ds_read_b64_tr_b16 a[226:227], v184 offset:12288
    s_cmp_ge_u32 s21, s19
    s_cselect_b32 s25, 3670016, 0
    v_mfma_f32_16x16x32_bf16 v[112:115], a[240:243], a[8:11], 0
    ds_read_b64_tr_b16 a[228:229], v185 offset:8192
    s_sub_u32 s21, s21, s25
    v_mfma_f32_16x16x32_bf16 v[120:123], a[240:243], a[12:15], 0
    buffer_load_dwordx4 a[48:51], v10, s[8:11], s21 offen offset:0 sc1
    v_mfma_f32_16x16x32_bf16 v[124:127], a[244:247], a[12:15], 0
    ds_read_b64_tr_b16 a[230:231], v185 offset:12288
    v_xor_b32 v167, 224, v160
    v_mfma_f32_16x16x32_bf16 v[116:119], a[244:247], a[8:11], 0
    ds_read_b64_tr_b16 a[232:233], v186 offset:8192
    s_mov_b32 s33, 32784
    v_mfma_f32_16x16x32_bf16 v[108:111], a[244:247], a[4:7], 0
    ds_read_b64_tr_b16 a[234:235], v186 offset:12288
    v_lshrrev_b32 v6, 5, v30
    v_mfma_f32_16x16x32_bf16 v[100:103], a[244:247], a[0:3], 0
    buffer_load_dwordx4 a[52:55], v10, s[8:11], s21 offen offset:256 sc1
    v_mfma_f32_16x16x32_bf16 v[128:131], a[248:251], a[0:3], 0
    ds_read_b64_tr_b16 a[236:237], v187 offset:8192
    v_mul_u32_u24 v6, 393216, v6
    v_mfma_f32_16x16x32_bf16 v[136:139], a[248:251], a[4:7], 0
    ds_read_b64_tr_b16 a[238:239], v187 offset:12288
    v_add_u32 v11, v6, v10
    v_mfma_f32_16x16x32_bf16 v[144:147], a[248:251], a[8:11], 0
    v_xor_b32 v176, 131072, v160
    v_mfma_f32_16x16x32_bf16 v[152:155], a[248:251], a[12:15], 0
    buffer_load_dwordx4 a[56:59], v10, s[8:11], s21 offen offset:512 sc1
    v_mfma_f32_16x16x32_bf16 v[156:159], a[252:255], a[12:15], 0
    v_xor_b32 v177, 131104, v160
    v_mfma_f32_16x16x32_bf16 v[148:151], a[252:255], a[8:11], 0
    buffer_load_dwordx4 a[60:63], v10, s[8:11], s21 offen offset:768 sc1
    v_mfma_f32_16x16x32_bf16 v[140:143], a[252:255], a[4:7], 0
    v_xor_b32 v178, 131136, v160
    v_mfma_f32_16x16x32_bf16 v[132:135], a[252:255], a[0:3], 0
    v_xor_b32 v179, 131168, v160
    s_waitcnt vmcnt(63) lgkmcnt(0)
    v_mfma_f32_16x16x32_bf16 v[32:35], a[224:227], a[16:19], v[32:35]
    ds_read_b64_tr_b16 a[240:241], v188 offset:8192
    s_add_u32 s21, s18, 589824
    v_mfma_f32_16x16x32_bf16 v[40:43], a[224:227], a[20:23], v[40:43]
    ds_read_b64_tr_b16 a[242:243], v188 offset:12288
    s_cmp_ge_u32 s21, s19
    s_cselect_b32 s25, 3670016, 0
    v_mfma_f32_16x16x32_bf16 v[48:51], a[224:227], a[24:27], v[48:51]
    ds_read_b64_tr_b16 a[244:245], v189 offset:8192
    s_sub_u32 s21, s21, s25
    v_mfma_f32_16x16x32_bf16 v[56:59], a[224:227], a[28:31], v[56:59]
    buffer_load_dwordx4 a[64:67], v10, s[8:11], s21 offen offset:0 sc1
    v_mfma_f32_16x16x32_bf16 v[60:63], a[228:231], a[28:31], v[60:63]
    ds_read_b64_tr_b16 a[246:247], v189 offset:12288
    v_xor_b32 v180, 131200, v160
    v_mfma_f32_16x16x32_bf16 v[52:55], a[228:231], a[24:27], v[52:55]
    ds_read_b64_tr_b16 a[248:249], v190 offset:8192
    v_xor_b32 v181, 131232, v160
    v_mfma_f32_16x16x32_bf16 v[44:47], a[228:231], a[20:23], v[44:47]
    ds_read_b64_tr_b16 a[250:251], v190 offset:12288
    v_xor_b32 v182, 131264, v160
    v_mfma_f32_16x16x32_bf16 v[36:39], a[228:231], a[16:19], v[36:39]
    buffer_load_dwordx4 a[68:71], v10, s[8:11], s21 offen offset:256 sc1
    v_mfma_f32_16x16x32_bf16 v[64:67], a[232:235], a[16:19], v[64:67]
    ds_read_b64_tr_b16 a[252:253], v191 offset:8192
    v_xor_b32 v183, 131296, v160
    v_mfma_f32_16x16x32_bf16 v[72:75], a[232:235], a[20:23], v[72:75]
    ds_read_b64_tr_b16 a[254:255], v191 offset:12288
    s_lshl_b32 s27, s53, 7
    v_mfma_f32_16x16x32_bf16 v[80:83], a[232:235], a[24:27], v[80:83]
    s_lshl_b32 s50, s54, 5
    v_mfma_f32_16x16x32_bf16 v[88:91], a[232:235], a[28:31], v[88:91]
    s_add_u32 s27, s27, s50
    v_mfma_f32_16x16x32_bf16 v[92:95], a[236:239], a[28:31], v[92:95]
    v_lshrrev_b32 v18, 1, v10
    v_mfma_f32_16x16x32_bf16 v[84:87], a[236:239], a[24:27], v[84:87]
    s_lshl_b32 s50, s27, 12
    v_mfma_f32_16x16x32_bf16 v[76:79], a[236:239], a[20:23], v[76:79]
    v_add_u32 v18, s50, v18
    v_mfma_f32_16x16x32_bf16 v[68:71], a[236:239], a[16:19], v[68:71]
    s_mov_b32 s33, 32784
    s_waitcnt vmcnt(6) lgkmcnt(0)
    s_barrier
    s_cmp_lg_u32 s94, 0
    s_cbranch_scc1 L_mk_fl_33
    s_lshl_b32 s48, s2, 6
    s_add_u32 s48, s48, 32784
    v_mov_b32 v22, s92
    v_mov_b32 v23, s93
    v_mov_b32 v24, 0
    s_mov_b64 exec, 1
    buffer_store_dwordx2 v[22:23], v24, s[60:63], s48 offen sc1
    s_mov_b64 exec, -1
L_mk_fl_33:
    v_mfma_f32_16x16x32_bf16 v[96:99], a[240:243], a[16:19], v[96:99]
    ds_read_b64_tr_b16 a[224:225], v184 offset:16384
    v_xor_b32 v168, 65536, v160
    v_mfma_f32_16x16x32_bf16 v[104:107], a[240:243], a[20:23], v[104:107]
    ds_read_b64_tr_b16 a[226:227], v184 offset:20480
    v_xor_b32 v169, 65568, v160
    v_mfma_f32_16x16x32_bf16 v[112:115], a[240:243], a[24:27], v[112:115]
    ds_read_b64_tr_b16 a[228:229], v185 offset:16384
    v_xor_b32 v170, 65600, v160
    v_mfma_f32_16x16x32_bf16 v[120:123], a[240:243], a[28:31], v[120:123]
    buffer_load_dwordx4 a[72:75], v10, s[8:11], s21 offen offset:512 sc1
    v_mfma_f32_16x16x32_bf16 v[124:127], a[244:247], a[28:31], v[124:127]
    ds_read_b64_tr_b16 a[230:231], v185 offset:20480
    v_xor_b32 v171, 65632, v160
    v_mfma_f32_16x16x32_bf16 v[116:119], a[244:247], a[24:27], v[116:119]
    ds_read_b64_tr_b16 a[232:233], v186 offset:16384
    v_xor_b32 v172, 65664, v160
    v_mfma_f32_16x16x32_bf16 v[108:111], a[244:247], a[20:23], v[108:111]
    ds_read_b64_tr_b16 a[234:235], v186 offset:20480
    v_xor_b32 v173, 65696, v160
    v_mfma_f32_16x16x32_bf16 v[100:103], a[244:247], a[16:19], v[100:103]
    buffer_load_dwordx4 a[76:79], v10, s[8:11], s21 offen offset:768 sc1
    v_mfma_f32_16x16x32_bf16 v[128:131], a[248:251], a[16:19], v[128:131]
    ds_read_b64_tr_b16 a[236:237], v187 offset:16384
    s_add_u32 s21, s18, 917504
    v_mfma_f32_16x16x32_bf16 v[136:139], a[248:251], a[20:23], v[136:139]
    ds_read_b64_tr_b16 a[238:239], v187 offset:20480
    s_cmp_ge_u32 s21, s19
    s_cselect_b32 s25, 3670016, 0
    v_mfma_f32_16x16x32_bf16 v[144:147], a[248:251], a[24:27], v[144:147]
    s_sub_u32 s21, s21, s25
    v_xor_b32 v174, 65728, v160
    v_mfma_f32_16x16x32_bf16 v[152:155], a[248:251], a[28:31], v[152:155]
    buffer_load_dwordx4 a[80:83], v10, s[8:11], s21 offen offset:0 sc1
    v_mfma_f32_16x16x32_bf16 v[156:159], a[252:255], a[28:31], v[156:159]
    v_xor_b32 v175, 65760, v160
    v_mfma_f32_16x16x32_bf16 v[148:151], a[252:255], a[24:27], v[148:151]
    buffer_load_dwordx4 a[84:87], v10, s[8:11], s21 offen offset:256 sc1
    v_mfma_f32_16x16x32_bf16 v[140:143], a[252:255], a[20:23], v[140:143]
    v_and_b32 v4, 15, v30
    v_mfma_f32_16x16x32_bf16 v[132:135], a[252:255], a[16:19], v[132:135]
    s_lshr_b32 s50, s26, 1
    s_waitcnt vmcnt(63) lgkmcnt(0)
    v_mfma_f32_16x16x32_bf16 v[32:35], a[224:227], a[32:35], v[32:35]
    ds_read_b64_tr_b16 a[240:241], v188 offset:16384
    v_add_u32 v4, s50, v4
    v_mfma_f32_16x16x32_bf16 v[40:43], a[224:227], a[36:39], v[40:43]
    ds_read_b64_tr_b16 a[242:243], v188 offset:20480
    v_lshrrev_b32 v5, 5, v30
    v_mfma_f32_16x16x32_bf16 v[48:51], a[224:227], a[40:43], v[48:51]
    ds_read_b64_tr_b16 a[244:245], v189 offset:16384
    v_lshlrev_b32 v16, 11, v4
    v_mfma_f32_16x16x32_bf16 v[56:59], a[224:227], a[44:47], v[56:59]
    buffer_load_dwordx4 a[88:91], v10, s[8:11], s21 offen offset:512 sc1
    v_mfma_f32_16x16x32_bf16 v[60:63], a[228:231], a[44:47], v[60:63]
    ds_read_b64_tr_b16 a[246:247], v189 offset:20480
    v_lshl_add_u32 v16, v5, 4, v16
    v_mfma_f32_16x16x32_bf16 v[52:55], a[228:231], a[40:43], v[52:55]
    ds_read_b64_tr_b16 a[248:249], v190 offset:16384
    v_bfe_u32 v5, v30, 4, 1
    v_mfma_f32_16x16x32_bf16 v[44:47], a[228:231], a[36:39], v[44:47]
    ds_read_b64_tr_b16 a[250:251], v190 offset:20480
    v_lshl_add_u32 v16, v5, 5, v16
    v_mfma_f32_16x16x32_bf16 v[36:39], a[228:231], a[32:35], v[36:39]
    buffer_load_dwordx4 a[92:95], v10, s[8:11], s21 offen offset:768 sc1
    s_add_u32 m0, s24, 0
    s_lshr_b32 s23, 0x28272120, s34
    s_and_b32 s23, s23, 0xff
    v_mfma_f32_16x16x32_bf16 v[64:67], a[232:235], a[32:35], v[64:67]
    ds_read_b64_tr_b16 a[252:253], v191 offset:16384
    s_lshl4_add_u32 s23, s23, s35
    v_mfma_f32_16x16x32_bf16 v[72:75], a[232:235], a[36:39], v[72:75]
    ds_read_b64_tr_b16 a[254:255], v191 offset:20480
    s_sub_u32 s22, s23, 896
    s_cselect_b32 s23, s23, s22
    v_mfma_f32_16x16x32_bf16 v[80:83], a[232:235], a[40:43], v[80:83]
    s_lshl_b32 s23, s23, 11
    s_lshl_b32 s50, s27, 1
    v_mfma_f32_16x16x32_bf16 v[88:91], a[232:235], a[44:47], v[88:91]
    buffer_load_dwordx4 v1, s[12:15], s23 offen offset:0 lds
    v_mfma_f32_16x16x32_bf16 v[92:95], a[236:239], a[44:47], v[92:95]
    v_add_u32 v16, s50, v16
    v_mfma_f32_16x16x32_bf16 v[84:87], a[236:239], a[40:43], v[84:87]
    v_lshlrev_b32 v17, 4, v30
    v_mfma_f32_16x16x32_bf16 v[76:79], a[236:239], a[36:39], v[76:79]
    s_lshl_b32 s50, s94, 12
    v_mfma_f32_16x16x32_bf16 v[68:71], a[236:239], a[32:35], v[68:71]
    v_add_u32 v17, s50, v17
    s_waitcnt vmcnt(63) lgkmcnt(0)
    v_mfma_f32_16x16x32_bf16 v[96:99], a[240:243], a[32:35], v[96:99]
    ds_read_b64_tr_b16 a[224:225], v160 offset:24576
    s_add_u32 s21, s18, 1048576
    v_mfma_f32_16x16x32_bf16 v[104:107], a[240:243], a[36:39], v[104:107]
    ds_read_b64_tr_b16 a[226:227], v160 offset:25600
    s_cmp_ge_u32 s21, s19
    s_cselect_b32 s25, 3670016, 0
    v_mfma_f32_16x16x32_bf16 v[112:115], a[240:243], a[40:43], v[112:115]
    ds_read_b64_tr_b16 a[228:229], v161 offset:24576
    s_sub_u32 s21, s21, s25
    v_mfma_f32_16x16x32_bf16 v[120:123], a[240:243], a[44:47], v[120:123]
    buffer_load_dwordx4 a[96:99], v10, s[8:11], s21 offen offset:0 sc1
    v_mfma_f32_16x16x32_bf16 v[124:127], a[244:247], a[44:47], v[124:127]
    ds_read_b64_tr_b16 a[230:231], v161 offset:25600
    v_mov_b32 v20, -2
    v_mfma_f32_16x16x32_bf16 v[116:119], a[244:247], a[40:43], v[116:119]
    ds_read_b64_tr_b16 a[232:233], v162 offset:24576
    s_mov_b32 s4, s86
    v_mfma_f32_16x16x32_bf16 v[108:111], a[244:247], a[36:39], v[108:111]
    ds_read_b64_tr_b16 a[234:235], v162 offset:25600
    s_mov_b32 s5, s87
    v_mfma_f32_16x16x32_bf16 v[100:103], a[244:247], a[32:35], v[100:103]
    buffer_load_dwordx4 a[100:103], v10, s[8:11], s21 offen offset:256 sc1
    v_mfma_f32_16x16x32_bf16 v[128:131], a[248:251], a[32:35], v[128:131]
    ds_read_b64_tr_b16 a[236:237], v163 offset:24576
    s_mov_b32 s6, 4194304
    v_mfma_f32_16x16x32_bf16 v[136:139], a[248:251], a[36:39], v[136:139]
    ds_read_b64_tr_b16 a[238:239], v163 offset:25600
    s_mov_b32 s7, 0x20000
    v_mfma_f32_16x16x32_bf16 v[144:147], a[248:251], a[40:43], v[144:147]
    s_add_u32 s36, s90, 19922944
    s_addc_u32 s37, s91, 0
    v_mfma_f32_16x16x32_bf16 v[152:155], a[248:251], a[44:47], v[152:155]
    buffer_load_dwordx4 a[104:107], v10, s[8:11], s21 offen offset:512 sc1
    v_mfma_f32_16x16x32_bf16 v[156:159], a[252:255], a[44:47], v[156:159]
    s_mov_b32 s38, 12582912
    v_mfma_f32_16x16x32_bf16 v[148:151], a[252:255], a[40:43], v[148:151]
    buffer_load_dwordx4 a[108:111], v10, s[8:11], s21 offen offset:768 sc1
    v_mfma_f32_16x16x32_bf16 v[140:143], a[252:255], a[36:39], v[140:143]
    s_mov_b32 s39, 0x20000
    v_mfma_f32_16x16x32_bf16 v[132:135], a[252:255], a[32:35], v[132:135]
    s_lshl_b32 s31, s2, 15
    s_waitcnt vmcnt(13) lgkmcnt(0)
    v_mfma_f32_16x16x32_bf16 v[32:35], a[224:227], a[48:51], v[32:35]
    ds_read_b64_tr_b16 a[240:241], v164 offset:24576
    s_add_u32 s21, s18, 1376256
    v_mfma_f32_16x16x32_bf16 v[40:43], a[224:227], a[52:55], v[40:43]
    ds_read_b64_tr_b16 a[242:243], v164 offset:25600
    s_cmp_ge_u32 s21, s19
    s_cselect_b32 s25, 3670016, 0
    v_mfma_f32_16x16x32_bf16 v[48:51], a[224:227], a[56:59], v[48:51]
    ds_read_b64_tr_b16 a[244:245], v165 offset:24576
    s_sub_u32 s21, s21, s25
    v_mfma_f32_16x16x32_bf16 v[56:59], a[224:227], a[60:63], v[56:59]
    buffer_load_dwordx4 a[112:115], v10, s[8:11], s21 offen offset:0 sc1
    v_mfma_f32_16x16x32_bf16 v[60:63], a[228:231], a[60:63], v[60:63]
    ds_read_b64_tr_b16 a[246:247], v165 offset:25600
    s_add_u32 s31, s31, 4194304
    v_mfma_f32_16x16x32_bf16 v[52:55], a[228:231], a[56:59], v[52:55]
    ds_read_b64_tr_b16 a[248:249], v166 offset:24576
    s_xor_b32 s28, s31, 65536
    v_mfma_f32_16x16x32_bf16 v[44:47], a[228:231], a[52:55], v[44:47]
    ds_read_b64_tr_b16 a[250:251], v166 offset:25600
    s_xor_b32 s29, s31, 147456
    v_mfma_f32_16x16x32_bf16 v[36:39], a[228:231], a[48:51], v[36:39]
    buffer_load_dwordx4 a[116:119], v10, s[8:11], s21 offen offset:256 sc1
    v_mfma_f32_16x16x32_bf16 v[64:67], a[232:235], a[48:51], v[64:67]
    ds_read_b64_tr_b16 a[252:253], v167 offset:24576
    s_lshl_b32 s32, s95, 14
    v_mfma_f32_16x16x32_bf16 v[72:75], a[232:235], a[52:55], v[72:75]
    ds_read_b64_tr_b16 a[254:255], v167 offset:25600
    s_xor_b32 s30, s32, 3145728
    v_mfma_f32_16x16x32_bf16 v[80:83], a[232:235], a[56:59], v[80:83]
    s_add_u32 s23, s23, 7168
    s_lshl_b32 s16, s2, 8
    v_mfma_f32_16x16x32_bf16 v[88:91], a[232:235], a[60:63], v[88:91]
    buffer_load_dwordx4 v1, s[12:15], s23 offen offset:1024 lds
    v_mfma_f32_16x16x32_bf16 v[92:95], a[236:239], a[60:63], v[92:95]
    s_lshl_b32 s50, s94, 6
    v_mfma_f32_16x16x32_bf16 v[84:87], a[236:239], a[56:59], v[84:87]
    s_add_u32 s16, s16, s50
    v_mfma_f32_16x16x32_bf16 v[76:79], a[236:239], a[52:55], v[76:79]
    s_add_u32 s16, s16, 327680
    v_mfma_f32_16x16x32_bf16 v[68:71], a[236:239], a[48:51], v[68:71]
    v_lshlrev_b32 v19, 24, v30
    s_waitcnt vmcnt(16) lgkmcnt(0)
    v_mfma_f32_16x16x32_bf16 v[96:99], a[240:243], a[48:51], v[96:99]
    ds_read_b64_tr_b16 a[224:225], v160 offset:32768
    v_mov_b32 v14, s92
    v_mfma_f32_16x16x32_bf16 v[104:107], a[240:243], a[52:55], v[104:107]
    ds_read_b64_tr_b16 a[226:227], v160 offset:33792
    v_mov_b32 v15, s93
    v_mfma_f32_16x16x32_bf16 v[112:115], a[240:243], a[56:59], v[112:115]
    ds_read_b64_tr_b16 a[228:229], v161 offset:32768
    v_mfma_f32_16x16x32_bf16 v[120:123], a[240:243], a[60:63], v[120:123]
    buffer_load_dwordx4 a[120:123], v10, s[8:11], s21 offen offset:512 sc1
    v_mfma_f32_16x16x32_bf16 v[124:127], a[244:247], a[60:63], v[124:127]
    ds_read_b64_tr_b16 a[230:231], v161 offset:33792
    v_mfma_f32_16x16x32_bf16 v[116:119], a[244:247], a[56:59], v[116:119]
    ds_read_b64_tr_b16 a[232:233], v162 offset:32768
    v_mfma_f32_16x16x32_bf16 v[108:111], a[244:247], a[52:55], v[108:111]
    ds_read_b64_tr_b16 a[234:235], v162 offset:33792
    v_mfma_f32_16x16x32_bf16 v[100:103], a[244:247], a[48:51], v[100:103]
    buffer_load_dwordx4 a[124:127], v10, s[8:11], s21 offen offset:768 sc1
    v_mfma_f32_16x16x32_bf16 v[128:131], a[248:251], a[48:51], v[128:131]
    ds_read_b64_tr_b16 a[236:237], v163 offset:32768
    s_add_u32 s21, s18, 1507328
    v_mfma_f32_16x16x32_bf16 v[136:139], a[248:251], a[52:55], v[136:139]
    ds_read_b64_tr_b16 a[238:239], v163 offset:33792
    s_cmp_ge_u32 s21, s19
    s_cselect_b32 s25, 3670016, 0
    v_mfma_f32_16x16x32_bf16 v[144:147], a[248:251], a[56:59], v[144:147]
    s_sub_u32 s21, s21, s25
    v_mfma_f32_16x16x32_bf16 v[152:155], a[248:251], a[60:63], v[152:155]
    buffer_load_dwordx4 a[128:131], v10, s[8:11], s21 offen offset:0 sc1
    v_mfma_f32_16x16x32_bf16 v[156:159], a[252:255], a[60:63], v[156:159]
    v_mfma_f32_16x16x32_bf16 v[148:151], a[252:255], a[56:59], v[148:151]
    buffer_load_dwordx4 a[132:135], v10, s[8:11], s21 offen offset:256 sc1
    v_mfma_f32_16x16x32_bf16 v[140:143], a[252:255], a[52:55], v[140:143]
    v_mfma_f32_16x16x32_bf16 v[132:135], a[252:255], a[48:51], v[132:135]
    s_waitcnt vmcnt(16) lgkmcnt(0)
    v_mfma_f32_16x16x32_bf16 v[32:35], a[224:227], a[64:67], v[32:35]
    ds_read_b64_tr_b16 a[240:241], v164 offset:32768
    v_mfma_f32_16x16x32_bf16 v[40:43], a[224:227], a[68:71], v[40:43]
    ds_read_b64_tr_b16 a[242:243], v164 offset:33792
    v_mfma_f32_16x16x32_bf16 v[48:51], a[224:227], a[72:75], v[48:51]
    ds_read_b64_tr_b16 a[244:245], v165 offset:32768
    v_mfma_f32_16x16x32_bf16 v[56:59], a[224:227], a[76:79], v[56:59]
    buffer_load_dwordx4 a[136:139], v10, s[8:11], s21 offen offset:512 sc1
    v_mfma_f32_16x16x32_bf16 v[60:63], a[228:231], a[76:79], v[60:63]
    ds_read_b64_tr_b16 a[246:247], v165 offset:33792
    v_mfma_f32_16x16x32_bf16 v[52:55], a[228:231], a[72:75], v[52:55]
    ds_read_b64_tr_b16 a[248:249], v166 offset:32768
    v_mfma_f32_16x16x32_bf16 v[44:47], a[228:231], a[68:71], v[44:47]
    ds_read_b64_tr_b16 a[250:251], v166 offset:33792
    v_mfma_f32_16x16x32_bf16 v[36:39], a[228:231], a[64:67], v[36:39]
    buffer_load_dwordx4 a[140:143], v10, s[8:11], s21 offen offset:768 sc1
    v_mfma_f32_16x16x32_bf16 v[64:67], a[232:235], a[64:67], v[64:67]
    ds_read_b64_tr_b16 a[252:253], v167 offset:32768
    v_mfma_f32_16x16x32_bf16 v[72:75], a[232:235], a[68:71], v[72:75]
    ds_read_b64_tr_b16 a[254:255], v167 offset:33792
    v_mfma_f32_16x16x32_bf16 v[80:83], a[232:235], a[72:75], v[80:83]
    s_add_u32 s23, s23, 7168
    v_mfma_f32_16x16x32_bf16 v[88:91], a[232:235], a[76:79], v[88:91]
    buffer_load_dwordx4 v0, s[12:15], s23 offen offset:2048 lds
    v_mfma_f32_16x16x32_bf16 v[92:95], a[236:239], a[76:79], v[92:95]
    v_mfma_f32_16x16x32_bf16 v[84:87], a[236:239], a[72:75], v[84:87]
    v_mfma_f32_16x16x32_bf16 v[76:79], a[236:239], a[68:71], v[76:79]
    v_mfma_f32_16x16x32_bf16 v[68:71], a[236:239], a[64:67], v[68:71]
    s_waitcnt vmcnt(19) lgkmcnt(0)
    v_mfma_f32_16x16x32_bf16 v[96:99], a[240:243], a[64:67], v[96:99]
    ds_read_b64_tr_b16 a[224:225], v160 offset:40960
    s_add_u32 s21, s18, 1835008
    v_mfma_f32_16x16x32_bf16 v[104:107], a[240:243], a[68:71], v[104:107]
    ds_read_b64_tr_b16 a[226:227], v160 offset:41984
    s_cmp_ge_u32 s21, s19
    s_cselect_b32 s25, 3670016, 0
    v_mfma_f32_16x16x32_bf16 v[112:115], a[240:243], a[72:75], v[112:115]
    ds_read_b64_tr_b16 a[228:229], v161 offset:40960
    s_sub_u32 s21, s21, s25
    v_mfma_f32_16x16x32_bf16 v[120:123], a[240:243], a[76:79], v[120:123]
    buffer_load_dwordx4 a[144:147], v10, s[8:11], s21 offen offset:0 sc1
    v_mfma_f32_16x16x32_bf16 v[124:127], a[244:247], a[76:79], v[124:127]
    ds_read_b64_tr_b16 a[230:231], v161 offset:41984
    v_mfma_f32_16x16x32_bf16 v[116:119], a[244:247], a[72:75], v[116:119]
    ds_read_b64_tr_b16 a[232:233], v162 offset:40960
    v_mfma_f32_16x16x32_bf16 v[108:111], a[244:247], a[68:71], v[108:111]
    ds_read_b64_tr_b16 a[234:235], v162 offset:41984
    v_mfma_f32_16x16x32_bf16 v[100:103], a[244:247], a[64:67], v[100:103]
    buffer_load_dwordx4 a[148:151], v10, s[8:11], s21 offen offset:256 sc1
    v_mfma_f32_16x16x32_bf16 v[128:131], a[248:251], a[64:67], v[128:131]
    ds_read_b64_tr_b16 a[236:237], v163 offset:40960
    v_mfma_f32_16x16x32_bf16 v[136:139], a[248:251], a[68:71], v[136:139]
    ds_read_b64_tr_b16 a[238:239], v163 offset:41984
    v_mfma_f32_16x16x32_bf16 v[144:147], a[248:251], a[72:75], v[144:147]
    v_mfma_f32_16x16x32_bf16 v[152:155], a[248:251], a[76:79], v[152:155]
    buffer_load_dwordx4 a[152:155], v10, s[8:11], s21 offen offset:512 sc1
    v_mfma_f32_16x16x32_bf16 v[156:159], a[252:255], a[76:79], v[156:159]
    v_mfma_f32_16x16x32_bf16 v[148:151], a[252:255], a[72:75], v[148:151]
    buffer_load_dwordx4 a[156:159], v10, s[8:11], s21 offen offset:768 sc1
    v_mfma_f32_16x16x32_bf16 v[140:143], a[252:255], a[68:71], v[140:143]
    v_mfma_f32_16x16x32_bf16 v[132:135], a[252:255], a[64:67], v[132:135]
    s_waitcnt vmcnt(19) lgkmcnt(0)
    v_mfma_f32_16x16x32_bf16 v[32:35], a[224:227], a[80:83], v[32:35]
    ds_read_b64_tr_b16 a[240:241], v164 offset:40960
    s_add_u32 s21, s18, 1966080
    v_mfma_f32_16x16x32_bf16 v[40:43], a[224:227], a[84:87], v[40:43]
    ds_read_b64_tr_b16 a[242:243], v164 offset:41984
    s_cmp_ge_u32 s21, s19
    s_cselect_b32 s25, 3670016, 0
    v_mfma_f32_16x16x32_bf16 v[48:51], a[224:227], a[88:91], v[48:51]
    ds_read_b64_tr_b16 a[244:245], v165 offset:40960
    s_sub_u32 s21, s21, s25
    v_mfma_f32_16x16x32_bf16 v[56:59], a[224:227], a[92:95], v[56:59]
    buffer_load_dwordx4 a[160:163], v10, s[8:11], s21 offen offset:0 sc1
    v_mfma_f32_16x16x32_bf16 v[60:63], a[228:231], a[92:95], v[60:63]
    ds_read_b64_tr_b16 a[246:247], v165 offset:41984
    v_mfma_f32_16x16x32_bf16 v[52:55], a[228:231], a[88:91], v[52:55]
    ds_read_b64_tr_b16 a[248:249], v166 offset:40960
    v_mfma_f32_16x16x32_bf16 v[44:47], a[228:231], a[84:87], v[44:47]
    ds_read_b64_tr_b16 a[250:251], v166 offset:41984
    v_mfma_f32_16x16x32_bf16 v[36:39], a[228:231], a[80:83], v[36:39]
    buffer_load_dwordx4 a[164:167], v10, s[8:11], s21 offen offset:256 sc1
    v_mfma_f32_16x16x32_bf16 v[64:67], a[232:235], a[80:83], v[64:67]
    ds_read_b64_tr_b16 a[252:253], v167 offset:40960
    v_mfma_f32_16x16x32_bf16 v[72:75], a[232:235], a[84:87], v[72:75]
    ds_read_b64_tr_b16 a[254:255], v167 offset:41984
    v_mfma_f32_16x16x32_bf16 v[80:83], a[232:235], a[88:91], v[80:83]
    s_add_u32 s23, s23, 7168
    v_mfma_f32_16x16x32_bf16 v[88:91], a[232:235], a[92:95], v[88:91]
    buffer_load_dwordx4 v0, s[12:15], s23 offen offset:3072 lds
    v_mfma_f32_16x16x32_bf16 v[92:95], a[236:239], a[92:95], v[92:95]
    v_mfma_f32_16x16x32_bf16 v[84:87], a[236:239], a[88:91], v[84:87]
    v_mfma_f32_16x16x32_bf16 v[76:79], a[236:239], a[84:87], v[76:79]
    v_mfma_f32_16x16x32_bf16 v[68:71], a[236:239], a[80:83], v[68:71]
    s_waitcnt vmcnt(22) lgkmcnt(0)
    s_barrier
    v_mfma_f32_16x16x32_bf16 v[96:99], a[240:243], a[80:83], v[96:99]
    ds_read_b64_tr_b16 a[224:225], v176 offset:0
    v_mfma_f32_16x16x32_bf16 v[104:107], a[240:243], a[84:87], v[104:107]
    ds_read_b64_tr_b16 a[226:227], v176 offset:1024
    v_mfma_f32_16x16x32_bf16 v[112:115], a[240:243], a[88:91], v[112:115]
    ds_read_b64_tr_b16 a[228:229], v177 offset:0
    v_mfma_f32_16x16x32_bf16 v[120:123], a[240:243], a[92:95], v[120:123]
    buffer_load_dwordx4 a[168:171], v10, s[8:11], s21 offen offset:512 sc1
    v_mfma_f32_16x16x32_bf16 v[124:127], a[244:247], a[92:95], v[124:127]
    ds_read_b64_tr_b16 a[230:231], v177 offset:1024
    v_mfma_f32_16x16x32_bf16 v[116:119], a[244:247], a[88:91], v[116:119]
    ds_read_b64_tr_b16 a[232:233], v178 offset:0
    v_mfma_f32_16x16x32_bf16 v[108:111], a[244:247], a[84:87], v[108:111]
    ds_read_b64_tr_b16 a[234:235], v178 offset:1024
    v_mfma_f32_16x16x32_bf16 v[100:103], a[244:247], a[80:83], v[100:103]
    buffer_load_dwordx4 a[172:175], v10, s[8:11], s21 offen offset:768 sc1
    v_mfma_f32_16x16x32_bf16 v[128:131], a[248:251], a[80:83], v[128:131]
    ds_read_b64_tr_b16 a[236:237], v179 offset:0
    s_add_u32 s21, s18, 2293760
    v_mfma_f32_16x16x32_bf16 v[136:139], a[248:251], a[84:87], v[136:139]
    ds_read_b64_tr_b16 a[238:239], v179 offset:1024
    s_cmp_ge_u32 s21, s19
    s_cselect_b32 s25, 3670016, 0
    v_mfma_f32_16x16x32_bf16 v[144:147], a[248:251], a[88:91], v[144:147]
    s_sub_u32 s21, s21, s25
    v_mfma_f32_16x16x32_bf16 v[152:155], a[248:251], a[92:95], v[152:155]
    buffer_load_dwordx4 a[176:179], v10, s[8:11], s21 offen offset:0 sc1
    v_mfma_f32_16x16x32_bf16 v[156:159], a[252:255], a[92:95], v[156:159]
    v_mfma_f32_16x16x32_bf16 v[148:151], a[252:255], a[88:91], v[148:151]
    buffer_load_dwordx4 a[180:183], v10, s[8:11], s21 offen offset:256 sc1
    v_mfma_f32_16x16x32_bf16 v[140:143], a[252:255], a[84:87], v[140:143]
    v_mfma_f32_16x16x32_bf16 v[132:135], a[252:255], a[80:83], v[132:135]
    s_waitcnt vmcnt(21) lgkmcnt(0)
    v_mfma_f32_16x16x32_bf16 v[32:35], a[224:227], a[96:99], v[32:35]
    ds_read_b64_tr_b16 a[240:241], v180 offset:0
    v_mfma_f32_16x16x32_bf16 v[40:43], a[224:227], a[100:103], v[40:43]
    ds_read_b64_tr_b16 a[242:243], v180 offset:1024
    v_mfma_f32_16x16x32_bf16 v[48:51], a[224:227], a[104:107], v[48:51]
    ds_read_b64_tr_b16 a[244:245], v181 offset:0
    v_mfma_f32_16x16x32_bf16 v[56:59], a[224:227], a[108:111], v[56:59]
    buffer_load_dwordx4 a[184:187], v10, s[8:11], s21 offen offset:512 sc1
    v_mfma_f32_16x16x32_bf16 v[60:63], a[228:231], a[108:111], v[60:63]
    ds_read_b64_tr_b16 a[246:247], v181 offset:1024
    v_mfma_f32_16x16x32_bf16 v[52:55], a[228:231], a[104:107], v[52:55]
    ds_read_b64_tr_b16 a[248:249], v182 offset:0
    v_mfma_f32_16x16x32_bf16 v[44:47], a[228:231], a[100:103], v[44:47]
    ds_read_b64_tr_b16 a[250:251], v182 offset:1024
    v_mfma_f32_16x16x32_bf16 v[36:39], a[228:231], a[96:99], v[36:39]
    buffer_load_dwordx4 a[188:191], v10, s[8:11], s21 offen offset:768 sc1
    s_add_u32 m0, s24, 16384
    s_lshr_b32 s23, 0x36352f2e, s34
    s_and_b32 s23, s23, 0xff
    v_mfma_f32_16x16x32_bf16 v[64:67], a[232:235], a[96:99], v[64:67]
    ds_read_b64_tr_b16 a[252:253], v183 offset:0
    s_lshl4_add_u32 s23, s23, s35
    v_mfma_f32_16x16x32_bf16 v[72:75], a[232:235], a[100:103], v[72:75]
    ds_read_b64_tr_b16 a[254:255], v183 offset:1024
    s_sub_u32 s22, s23, 896
    s_cselect_b32 s23, s23, s22
    v_mfma_f32_16x16x32_bf16 v[80:83], a[232:235], a[104:107], v[80:83]
    s_lshl_b32 s23, s23, 11
    v_mfma_f32_16x16x32_bf16 v[88:91], a[232:235], a[108:111], v[88:91]
    buffer_load_dwordx4 v1, s[12:15], s23 offen offset:0 lds
    v_mfma_f32_16x16x32_bf16 v[92:95], a[236:239], a[108:111], v[92:95]
    v_mfma_f32_16x16x32_bf16 v[84:87], a[236:239], a[104:107], v[84:87]
    v_mfma_f32_16x16x32_bf16 v[76:79], a[236:239], a[100:103], v[76:79]
    v_mfma_f32_16x16x32_bf16 v[68:71], a[236:239], a[96:99], v[68:71]
    s_waitcnt vmcnt(24) lgkmcnt(0)
    v_mfma_f32_16x16x32_bf16 v[96:99], a[240:243], a[96:99], v[96:99]
    ds_read_b64_tr_b16 a[224:225], v176 offset:8192
    s_add_u32 s21, s18, 2424832
    v_mfma_f32_16x16x32_bf16 v[104:107], a[240:243], a[100:103], v[104:107]
    ds_read_b64_tr_b16 a[226:227], v176 offset:9216
    s_cmp_ge_u32 s21, s19
    s_cselect_b32 s25, 3670016, 0
    v_mfma_f32_16x16x32_bf16 v[112:115], a[240:243], a[104:107], v[112:115]
    ds_read_b64_tr_b16 a[228:229], v177 offset:8192
    s_sub_u32 s21, s21, s25
    v_mfma_f32_16x16x32_bf16 v[120:123], a[240:243], a[108:111], v[120:123]
    buffer_load_dwordx4 a[192:195], v10, s[8:11], s21 offen offset:0 sc1
    v_mfma_f32_16x16x32_bf16 v[124:127], a[244:247], a[108:111], v[124:127]
    ds_read_b64_tr_b16 a[230:231], v177 offset:9216
    v_mfma_f32_16x16x32_bf16 v[116:119], a[244:247], a[104:107], v[116:119]
    ds_read_b64_tr_b16 a[232:233], v178 offset:8192
    v_mfma_f32_16x16x32_bf16 v[108:111], a[244:247], a[100:103], v[108:111]
    ds_read_b64_tr_b16 a[234:235], v178 offset:9216
    v_mfma_f32_16x16x32_bf16 v[100:103], a[244:247], a[96:99], v[100:103]
    buffer_load_dwordx4 a[196:199], v10, s[8:11], s21 offen offset:256 sc1
    v_mfma_f32_16x16x32_bf16 v[128:131], a[248:251], a[96:99], v[128:131]
    ds_read_b64_tr_b16 a[236:237], v179 offset:8192
    v_mfma_f32_16x16x32_bf16 v[136:139], a[248:251], a[100:103], v[136:139]
    ds_read_b64_tr_b16 a[238:239], v179 offset:9216
    v_mfma_f32_16x16x32_bf16 v[144:147], a[248:251], a[104:107], v[144:147]
    v_mfma_f32_16x16x32_bf16 v[152:155], a[248:251], a[108:111], v[152:155]
    buffer_load_dwordx4 a[200:203], v10, s[8:11], s21 offen offset:512 sc1
    v_mfma_f32_16x16x32_bf16 v[156:159], a[252:255], a[108:111], v[156:159]
    v_mfma_f32_16x16x32_bf16 v[148:151], a[252:255], a[104:107], v[148:151]
    buffer_load_dwordx4 a[204:207], v10, s[8:11], s21 offen offset:768 sc1
    v_mfma_f32_16x16x32_bf16 v[140:143], a[252:255], a[100:103], v[140:143]
    v_mfma_f32_16x16x32_bf16 v[132:135], a[252:255], a[96:99], v[132:135]
    buffer_load_dwordx2 v[12:13], v29, s[60:63], s33 offen sc1
    s_waitcnt vmcnt(24) lgkmcnt(0)
    v_mfma_f32_16x16x32_bf16 v[32:35], a[224:227], a[112:115], v[32:35]
    ds_read_b64_tr_b16 a[240:241], v180 offset:8192
    s_add_u32 s21, s18, 2752512
    v_mfma_f32_16x16x32_bf16 v[40:43], a[224:227], a[116:119], v[40:43]
    ds_read_b64_tr_b16 a[242:243], v180 offset:9216
    s_cmp_ge_u32 s21, s19
    s_cselect_b32 s25, 3670016, 0
    v_mfma_f32_16x16x32_bf16 v[48:51], a[224:227], a[120:123], v[48:51]
    ds_read_b64_tr_b16 a[244:245], v181 offset:8192
    s_sub_u32 s21, s21, s25
    v_mfma_f32_16x16x32_bf16 v[56:59], a[224:227], a[124:127], v[56:59]
    buffer_load_dwordx4 a[208:211], v10, s[8:11], s21 offen offset:0 sc1
    v_mfma_f32_16x16x32_bf16 v[60:63], a[228:231], a[124:127], v[60:63]
    ds_read_b64_tr_b16 a[246:247], v181 offset:9216
    v_mfma_f32_16x16x32_bf16 v[52:55], a[228:231], a[120:123], v[52:55]
    ds_read_b64_tr_b16 a[248:249], v182 offset:8192
    v_mfma_f32_16x16x32_bf16 v[44:47], a[228:231], a[116:119], v[44:47]
    ds_read_b64_tr_b16 a[250:251], v182 offset:9216
    v_mfma_f32_16x16x32_bf16 v[36:39], a[228:231], a[112:115], v[36:39]
    buffer_load_dwordx4 a[212:215], v10, s[8:11], s21 offen offset:256 sc1
    v_mfma_f32_16x16x32_bf16 v[64:67], a[232:235], a[112:115], v[64:67]
    ds_read_b64_tr_b16 a[252:253], v183 offset:8192
    v_mfma_f32_16x16x32_bf16 v[72:75], a[232:235], a[116:119], v[72:75]
    ds_read_b64_tr_b16 a[254:255], v183 offset:9216
    v_mfma_f32_16x16x32_bf16 v[80:83], a[232:235], a[120:123], v[80:83]
    s_add_u32 s23, s23, 7168
    v_mfma_f32_16x16x32_bf16 v[88:91], a[232:235], a[124:127], v[88:91]
    buffer_load_dwordx4 v1, s[12:15], s23 offen offset:1024 lds
    v_mfma_f32_16x16x32_bf16 v[92:95], a[236:239], a[124:127], v[92:95]
    v_mfma_f32_16x16x32_bf16 v[84:87], a[236:239], a[120:123], v[84:87]
    v_mfma_f32_16x16x32_bf16 v[76:79], a[236:239], a[116:119], v[76:79]
    v_mfma_f32_16x16x32_bf16 v[68:71], a[236:239], a[112:115], v[68:71]
    s_waitcnt vmcnt(27) lgkmcnt(0)
    v_mfma_f32_16x16x32_bf16 v[96:99], a[240:243], a[112:115], v[96:99]
    ds_read_b64_tr_b16 a[224:225], v176 offset:16384
    v_mfma_f32_16x16x32_bf16 v[104:107], a[240:243], a[116:119], v[104:107]
    ds_read_b64_tr_b16 a[226:227], v176 offset:17408
    v_mfma_f32_16x16x32_bf16 v[112:115], a[240:243], a[120:123], v[112:115]
    ds_read_b64_tr_b16 a[228:229], v177 offset:16384
    v_mfma_f32_16x16x32_bf16 v[120:123], a[240:243], a[124:127], v[120:123]
    buffer_load_dwordx4 a[216:219], v10, s[8:11], s21 offen offset:512 sc1
    v_mfma_f32_16x16x32_bf16 v[124:127], a[244:247], a[124:127], v[124:127]
    ds_read_b64_tr_b16 a[230:231], v177 offset:17408
    v_mfma_f32_16x16x32_bf16 v[116:119], a[244:247], a[120:123], v[116:119]
    ds_read_b64_tr_b16 a[232:233], v178 offset:16384
    v_mfma_f32_16x16x32_bf16 v[108:111], a[244:247], a[116:119], v[108:111]
    ds_read_b64_tr_b16 a[234:235], v178 offset:17408
    v_mfma_f32_16x16x32_bf16 v[100:103], a[244:247], a[112:115], v[100:103]
    buffer_load_dwordx4 a[220:223], v10, s[8:11], s21 offen offset:768 sc1
    v_mfma_f32_16x16x32_bf16 v[128:131], a[248:251], a[112:115], v[128:131]
    ds_read_b64_tr_b16 a[236:237], v179 offset:16384
    s_add_u32 s21, s18, 2883584
    v_mfma_f32_16x16x32_bf16 v[136:139], a[248:251], a[116:119], v[136:139]
    ds_read_b64_tr_b16 a[238:239], v179 offset:17408
    s_cmp_ge_u32 s21, s19
    s_cselect_b32 s25, 3670016, 0
    v_mfma_f32_16x16x32_bf16 v[144:147], a[248:251], a[120:123], v[144:147]
    s_sub_u32 s21, s21, s25
    v_mfma_f32_16x16x32_bf16 v[152:155], a[248:251], a[124:127], v[152:155]
    buffer_load_dwordx4 a[0:3], v10, s[8:11], s21 offen offset:0 sc1
    v_mfma_f32_16x16x32_bf16 v[156:159], a[252:255], a[124:127], v[156:159]
    v_mfma_f32_16x16x32_bf16 v[148:151], a[252:255], a[120:123], v[148:151]
    buffer_load_dwordx4 a[4:7], v10, s[8:11], s21 offen offset:256 sc1
    v_mfma_f32_16x16x32_bf16 v[140:143], a[252:255], a[116:119], v[140:143]
    v_mfma_f32_16x16x32_bf16 v[132:135], a[252:255], a[112:115], v[132:135]
    s_waitcnt vmcnt(27) lgkmcnt(0)
    v_mfma_f32_16x16x32_bf16 v[32:35], a[224:227], a[128:131], v[32:35]
    ds_read_b64_tr_b16 a[240:241], v180 offset:16384
    v_mfma_f32_16x16x32_bf16 v[40:43], a[224:227], a[132:135], v[40:43]
    ds_read_b64_tr_b16 a[242:243], v180 offset:17408
    v_mfma_f32_16x16x32_bf16 v[48:51], a[224:227], a[136:139], v[48:51]
    ds_read_b64_tr_b16 a[244:245], v181 offset:16384
    v_mfma_f32_16x16x32_bf16 v[56:59], a[224:227], a[140:143], v[56:59]
    buffer_load_dwordx4 a[8:11], v10, s[8:11], s21 offen offset:512 sc1
    v_mfma_f32_16x16x32_bf16 v[60:63], a[228:231], a[140:143], v[60:63]
    ds_read_b64_tr_b16 a[246:247], v181 offset:17408
    v_mfma_f32_16x16x32_bf16 v[52:55], a[228:231], a[136:139], v[52:55]
    ds_read_b64_tr_b16 a[248:249], v182 offset:16384
    v_mfma_f32_16x16x32_bf16 v[44:47], a[228:231], a[132:135], v[44:47]
    ds_read_b64_tr_b16 a[250:251], v182 offset:17408
    v_mfma_f32_16x16x32_bf16 v[36:39], a[228:231], a[128:131], v[36:39]
    buffer_load_dwordx4 a[12:15], v10, s[8:11], s21 offen offset:768 sc1
    v_mfma_f32_16x16x32_bf16 v[64:67], a[232:235], a[128:131], v[64:67]
    ds_read_b64_tr_b16 a[252:253], v183 offset:16384
    v_mfma_f32_16x16x32_bf16 v[72:75], a[232:235], a[132:135], v[72:75]
    ds_read_b64_tr_b16 a[254:255], v183 offset:17408
    v_mfma_f32_16x16x32_bf16 v[80:83], a[232:235], a[136:139], v[80:83]
    s_add_u32 s23, s23, 7168
    v_mfma_f32_16x16x32_bf16 v[88:91], a[232:235], a[140:143], v[88:91]
    buffer_load_dwordx4 v0, s[12:15], s23 offen offset:2048 lds
    v_mfma_f32_16x16x32_bf16 v[92:95], a[236:239], a[140:143], v[92:95]
    v_mfma_f32_16x16x32_bf16 v[84:87], a[236:239], a[136:139], v[84:87]
    v_mfma_f32_16x16x32_bf16 v[76:79], a[236:239], a[132:135], v[76:79]
    v_mfma_f32_16x16x32_bf16 v[68:71], a[236:239], a[128:131], v[68:71]
    s_waitcnt vmcnt(10) lgkmcnt(0)
    v_cmp_ne_u64 vcc, s[92:93], v[12:13]
    s_cbranch_vccz L_mk_fbok_34
    s_mov_b32 s96, 0
L_mk_poll_35:
    buffer_load_dwordx2 v[12:13], v29, s[60:63], s33 offen sc1
    s_waitcnt vmcnt(0)
    v_cmp_ne_u64_e64 vcc, s[92:93], v[12:13]
    s_cbranch_vccz L_mk_pdone_36
    s_mov_b64 exec, vcc
    s_add_u32 s96, s96, 1
    s_cmp_lt_u32 s96, 400000
    s_cbranch_scc1 L_mk_poll_35
L_mk_pdone_36:
    s_mov_b64 exec, -1
L_mk_fbok_34:
    v_mfma_f32_16x16x32_bf16 v[96:99], a[240:243], a[128:131], v[96:99]
    ds_read_b64_tr_b16 a[224:225], v176 offset:24576
    s_add_u32 s21, s18, 3211264
    v_mfma_f32_16x16x32_bf16 v[104:107], a[240:243], a[132:135], v[104:107]
    ds_read_b64_tr_b16 a[226:227], v176 offset:25600
    s_cmp_ge_u32 s21, s19
    s_cselect_b32 s25, 3670016, 0
    v_mfma_f32_16x16x32_bf16 v[112:115], a[240:243], a[136:139], v[112:115]
    ds_read_b64_tr_b16 a[228:229], v177 offset:24576
    s_sub_u32 s21, s21, s25
    v_mfma_f32_16x16x32_bf16 v[120:123], a[240:243], a[140:143], v[120:123]
    buffer_load_dwordx4 a[16:19], v10, s[8:11], s21 offen offset:0 sc1
    v_mfma_f32_16x16x32_bf16 v[124:127], a[244:247], a[140:143], v[124:127]
    ds_read_b64_tr_b16 a[230:231], v177 offset:25600
    v_mfma_f32_16x16x32_bf16 v[116:119], a[244:247], a[136:139], v[116:119]
    ds_read_b64_tr_b16 a[232:233], v178 offset:24576
    v_mfma_f32_16x16x32_bf16 v[108:111], a[244:247], a[132:135], v[108:111]
    ds_read_b64_tr_b16 a[234:235], v178 offset:25600
    v_mfma_f32_16x16x32_bf16 v[100:103], a[244:247], a[128:131], v[100:103]
    buffer_load_dwordx4 a[20:23], v10, s[8:11], s21 offen offset:256 sc1
    v_mfma_f32_16x16x32_bf16 v[128:131], a[248:251], a[128:131], v[128:131]
    ds_read_b64_tr_b16 a[236:237], v179 offset:24576
    v_mfma_f32_16x16x32_bf16 v[136:139], a[248:251], a[132:135], v[136:139]
    ds_read_b64_tr_b16 a[238:239], v179 offset:25600
    v_mfma_f32_16x16x32_bf16 v[144:147], a[248:251], a[136:139], v[144:147]
    v_mfma_f32_16x16x32_bf16 v[152:155], a[248:251], a[140:143], v[152:155]
    buffer_load_dwordx4 a[24:27], v10, s[8:11], s21 offen offset:512 sc1
    v_mfma_f32_16x16x32_bf16 v[156:159], a[252:255], a[140:143], v[156:159]
    v_mfma_f32_16x16x32_bf16 v[148:151], a[252:255], a[136:139], v[148:151]
    buffer_load_dwordx4 a[28:31], v10, s[8:11], s21 offen offset:768 sc1
    v_mfma_f32_16x16x32_bf16 v[140:143], a[252:255], a[132:135], v[140:143]
    v_mfma_f32_16x16x32_bf16 v[132:135], a[252:255], a[128:131], v[132:135]
    s_waitcnt vmcnt(29) lgkmcnt(0)
    v_mfma_f32_16x16x32_bf16 v[32:35], a[224:227], a[144:147], v[32:35]
    ds_read_b64_tr_b16 a[240:241], v180 offset:24576
    s_add_u32 s21, s18, 3342336
    v_mfma_f32_16x16x32_bf16 v[40:43], a[224:227], a[148:151], v[40:43]
    ds_read_b64_tr_b16 a[242:243], v180 offset:25600
    s_cmp_ge_u32 s21, s19
    s_cselect_b32 s25, 3670016, 0
    v_mfma_f32_16x16x32_bf16 v[48:51], a[224:227], a[152:155], v[48:51]
    ds_read_b64_tr_b16 a[244:245], v181 offset:24576
    s_sub_u32 s21, s21, s25
    v_mfma_f32_16x16x32_bf16 v[56:59], a[224:227], a[156:159], v[56:59]
    buffer_load_dwordx4 a[32:35], v10, s[8:11], s21 offen offset:0 sc1
    v_mfma_f32_16x16x32_bf16 v[60:63], a[228:231], a[156:159], v[60:63]
    ds_read_b64_tr_b16 a[246:247], v181 offset:25600
    v_mfma_f32_16x16x32_bf16 v[52:55], a[228:231], a[152:155], v[52:55]
    ds_read_b64_tr_b16 a[248:249], v182 offset:24576
    v_mfma_f32_16x16x32_bf16 v[44:47], a[228:231], a[148:151], v[44:47]
    ds_read_b64_tr_b16 a[250:251], v182 offset:25600
    v_mfma_f32_16x16x32_bf16 v[36:39], a[228:231], a[144:147], v[36:39]
    buffer_load_dwordx4 a[36:39], v10, s[8:11], s21 offen offset:256 sc1
    v_mfma_f32_16x16x32_bf16 v[64:67], a[232:235], a[144:147], v[64:67]
    ds_read_b64_tr_b16 a[252:253], v183 offset:24576
    v_mfma_f32_16x16x32_bf16 v[72:75], a[232:235], a[148:151], v[72:75]
    ds_read_b64_tr_b16 a[254:255], v183 offset:25600
    v_mfma_f32_16x16x32_bf16 v[80:83], a[232:235], a[152:155], v[80:83]
    s_add_u32 s23, s23, 7168
    v_mfma_f32_16x16x32_bf16 v[88:91], a[232:235], a[156:159], v[88:91]
    buffer_load_dwordx4 v0, s[12:15], s23 offen offset:3072 lds
    v_mfma_f32_16x16x32_bf16 v[92:95], a[236:239], a[156:159], v[92:95]
    v_mfma_f32_16x16x32_bf16 v[84:87], a[236:239], a[152:155], v[84:87]
    v_mfma_f32_16x16x32_bf16 v[76:79], a[236:239], a[148:151], v[76:79]
    v_mfma_f32_16x16x32_bf16 v[68:71], a[236:239], a[144:147], v[68:71]
    s_waitcnt vmcnt(32) lgkmcnt(0)
    s_barrier
    v_mfma_f32_16x16x32_bf16 v[96:99], a[240:243], a[144:147], v[96:99]
    ds_read_b64_tr_b16 a[224:225], v160 offset:49152
    v_mfma_f32_16x16x32_bf16 v[104:107], a[240:243], a[148:151], v[104:107]
    ds_read_b64_tr_b16 a[226:227], v160 offset:50176
    v_mfma_f32_16x16x32_bf16 v[112:115], a[240:243], a[152:155], v[112:115]
    ds_read_b64_tr_b16 a[228:229], v161 offset:49152
    v_mfma_f32_16x16x32_bf16 v[120:123], a[240:243], a[156:159], v[120:123]
    buffer_load_dwordx4 a[40:43], v10, s[8:11], s21 offen offset:512 sc1
    v_mfma_f32_16x16x32_bf16 v[124:127], a[244:247], a[156:159], v[124:127]
    ds_read_b64_tr_b16 a[230:231], v161 offset:50176
    v_mfma_f32_16x16x32_bf16 v[116:119], a[244:247], a[152:155], v[116:119]
    ds_read_b64_tr_b16 a[232:233], v162 offset:49152
    v_mfma_f32_16x16x32_bf16 v[108:111], a[244:247], a[148:151], v[108:111]
    ds_read_b64_tr_b16 a[234:235], v162 offset:50176
    v_mfma_f32_16x16x32_bf16 v[100:103], a[244:247], a[144:147], v[100:103]
    buffer_load_dwordx4 a[44:47], v10, s[8:11], s21 offen offset:768 sc1
    v_mfma_f32_16x16x32_bf16 v[128:131], a[248:251], a[144:147], v[128:131]
    ds_read_b64_tr_b16 a[236:237], v163 offset:49152
    s_add_u32 s21, s18, 720896
    v_mfma_f32_16x16x32_bf16 v[136:139], a[248:251], a[148:151], v[136:139]
    ds_read_b64_tr_b16 a[238:239], v163 offset:50176
    s_cmp_ge_u32 s21, s19
    s_cselect_b32 s25, 3670016, 0
    v_mfma_f32_16x16x32_bf16 v[144:147], a[248:251], a[152:155], v[144:147]
    s_sub_u32 s21, s21, s25
    v_mfma_f32_16x16x32_bf16 v[152:155], a[248:251], a[156:159], v[152:155]
    buffer_load_dwordx4 a[48:51], v10, s[8:11], s21 offen offset:0 sc1
    v_mfma_f32_16x16x32_bf16 v[156:159], a[252:255], a[156:159], v[156:159]
    v_mfma_f32_16x16x32_bf16 v[148:151], a[252:255], a[152:155], v[148:151]
    buffer_load_dwordx4 a[52:55], v10, s[8:11], s21 offen offset:256 sc1
    v_mfma_f32_16x16x32_bf16 v[140:143], a[252:255], a[148:151], v[140:143]
    v_mfma_f32_16x16x32_bf16 v[132:135], a[252:255], a[144:147], v[132:135]
    s_waitcnt vmcnt(31) lgkmcnt(0)
    v_mfma_f32_16x16x32_bf16 v[32:35], a[224:227], a[160:163], v[32:35]
    ds_read_b64_tr_b16 a[240:241], v164 offset:49152
    v_mfma_f32_16x16x32_bf16 v[40:43], a[224:227], a[164:167], v[40:43]
    ds_read_b64_tr_b16 a[242:243], v164 offset:50176
    v_mfma_f32_16x16x32_bf16 v[48:51], a[224:227], a[168:171], v[48:51]
    ds_read_b64_tr_b16 a[244:245], v165 offset:49152
    v_mfma_f32_16x16x32_bf16 v[56:59], a[224:227], a[172:175], v[56:59]
    buffer_load_dwordx4 a[56:59], v10, s[8:11], s21 offen offset:512 sc1
    v_mfma_f32_16x16x32_bf16 v[60:63], a[228:231], a[172:175], v[60:63]
    ds_read_b64_tr_b16 a[246:247], v165 offset:50176
    v_mfma_f32_16x16x32_bf16 v[52:55], a[228:231], a[168:171], v[52:55]
    ds_read_b64_tr_b16 a[248:249], v166 offset:49152
    v_mfma_f32_16x16x32_bf16 v[44:47], a[228:231], a[164:167], v[44:47]
    ds_read_b64_tr_b16 a[250:251], v166 offset:50176
    v_mfma_f32_16x16x32_bf16 v[36:39], a[228:231], a[160:163], v[36:39]
    buffer_load_dwordx4 a[60:63], v10, s[8:11], s21 offen offset:768 sc1
    v_mfma_f32_16x16x32_bf16 v[64:67], a[232:235], a[160:163], v[64:67]
    ds_read_b64_tr_b16 a[252:253], v167 offset:49152
    s_add_u32 m0, s24, 32768
    v_mfma_f32_16x16x32_bf16 v[72:75], a[232:235], a[164:167], v[72:75]
    ds_read_b64_tr_b16 a[254:255], v167 offset:50176
    s_mul_i32 s23, s94, 229376
    v_mfma_f32_16x16x32_bf16 v[80:83], a[232:235], a[168:171], v[80:83]
    s_add_u32 s23, s23, 196608
    v_mfma_f32_16x16x32_bf16 v[88:91], a[232:235], a[172:175], v[88:91]
    buffer_load_dwordx4 v1, s[12:15], s23 offen offset:0 lds
    v_mfma_f32_16x16x32_bf16 v[92:95], a[236:239], a[172:175], v[92:95]
    v_mfma_f32_16x16x32_bf16 v[84:87], a[236:239], a[168:171], v[84:87]
    v_mfma_f32_16x16x32_bf16 v[76:79], a[236:239], a[164:167], v[76:79]
    v_mfma_f32_16x16x32_bf16 v[68:71], a[236:239], a[160:163], v[68:71]
    s_waitcnt vmcnt(34) lgkmcnt(0)
    v_mfma_f32_16x16x32_bf16 v[96:99], a[240:243], a[160:163], v[96:99]
    ds_read_b64_tr_b16 a[224:225], v160 offset:57344
    s_add_u32 s21, s18, 1179648
    v_mfma_f32_16x16x32_bf16 v[104:107], a[240:243], a[164:167], v[104:107]
    ds_read_b64_tr_b16 a[226:227], v160 offset:58368
    s_cmp_ge_u32 s21, s19
    s_cselect_b32 s25, 3670016, 0
    v_mfma_f32_16x16x32_bf16 v[112:115], a[240:243], a[168:171], v[112:115]
    ds_read_b64_tr_b16 a[228:229], v161 offset:57344
    s_sub_u32 s21, s21, s25
    v_mfma_f32_16x16x32_bf16 v[120:123], a[240:243], a[172:175], v[120:123]
    buffer_load_dwordx4 a[64:67], v10, s[8:11], s21 offen offset:0 sc1
    v_mfma_f32_16x16x32_bf16 v[124:127], a[244:247], a[172:175], v[124:127]
    ds_read_b64_tr_b16 a[230:231], v161 offset:58368
    v_mfma_f32_16x16x32_bf16 v[116:119], a[244:247], a[168:171], v[116:119]
    ds_read_b64_tr_b16 a[232:233], v162 offset:57344
    v_mfma_f32_16x16x32_bf16 v[108:111], a[244:247], a[164:167], v[108:111]
    ds_read_b64_tr_b16 a[234:235], v162 offset:58368
    v_mfma_f32_16x16x32_bf16 v[100:103], a[244:247], a[160:163], v[100:103]
    buffer_load_dwordx4 a[68:71], v10, s[8:11], s21 offen offset:256 sc1
    v_mfma_f32_16x16x32_bf16 v[128:131], a[248:251], a[160:163], v[128:131]
    ds_read_b64_tr_b16 a[236:237], v163 offset:57344
    v_mfma_f32_16x16x32_bf16 v[136:139], a[248:251], a[164:167], v[136:139]
    ds_read_b64_tr_b16 a[238:239], v163 offset:58368
    v_mfma_f32_16x16x32_bf16 v[144:147], a[248:251], a[168:171], v[144:147]
    v_mfma_f32_16x16x32_bf16 v[152:155], a[248:251], a[172:175], v[152:155]
    buffer_load_dwordx4 a[72:75], v10, s[8:11], s21 offen offset:512 sc1
    v_mfma_f32_16x16x32_bf16 v[156:159], a[252:255], a[172:175], v[156:159]
    v_mfma_f32_16x16x32_bf16 v[148:151], a[252:255], a[168:171], v[148:151]
    buffer_load_dwordx4 a[76:79], v10, s[8:11], s21 offen offset:768 sc1
    v_mfma_f32_16x16x32_bf16 v[140:143], a[252:255], a[164:167], v[140:143]
    v_mfma_f32_16x16x32_bf16 v[132:135], a[252:255], a[160:163], v[132:135]
    s_waitcnt vmcnt(34) lgkmcnt(0)
    v_mfma_f32_16x16x32_bf16 v[32:35], a[224:227], a[176:179], v[32:35]
    ds_read_b64_tr_b16 a[240:241], v164 offset:57344
    s_add_u32 s21, s18, 1638400
    v_mfma_f32_16x16x32_bf16 v[40:43], a[224:227], a[180:183], v[40:43]
    ds_read_b64_tr_b16 a[242:243], v164 offset:58368
    s_cmp_ge_u32 s21, s19
    s_cselect_b32 s25, 3670016, 0
    v_mfma_f32_16x16x32_bf16 v[48:51], a[224:227], a[184:187], v[48:51]
    ds_read_b64_tr_b16 a[244:245], v165 offset:57344
    s_sub_u32 s21, s21, s25
    v_mfma_f32_16x16x32_bf16 v[56:59], a[224:227], a[188:191], v[56:59]
    buffer_load_dwordx4 a[80:83], v10, s[8:11], s21 offen offset:0 sc1
    v_mfma_f32_16x16x32_bf16 v[60:63], a[228:231], a[188:191], v[60:63]
    ds_read_b64_tr_b16 a[246:247], v165 offset:58368
    v_mfma_f32_16x16x32_bf16 v[52:55], a[228:231], a[184:187], v[52:55]
    ds_read_b64_tr_b16 a[248:249], v166 offset:57344
    v_mfma_f32_16x16x32_bf16 v[44:47], a[228:231], a[180:183], v[44:47]
    ds_read_b64_tr_b16 a[250:251], v166 offset:58368
    v_mfma_f32_16x16x32_bf16 v[36:39], a[228:231], a[176:179], v[36:39]
    buffer_load_dwordx4 a[84:87], v10, s[8:11], s21 offen offset:256 sc1
    v_mfma_f32_16x16x32_bf16 v[64:67], a[232:235], a[176:179], v[64:67]
    ds_read_b64_tr_b16 a[252:253], v167 offset:57344
    v_mfma_f32_16x16x32_bf16 v[72:75], a[232:235], a[180:183], v[72:75]
    ds_read_b64_tr_b16 a[254:255], v167 offset:58368
    v_mfma_f32_16x16x32_bf16 v[80:83], a[232:235], a[184:187], v[80:83]
    s_add_u32 s23, s23, 7168
    v_mfma_f32_16x16x32_bf16 v[88:91], a[232:235], a[188:191], v[88:91]
    buffer_load_dwordx4 v1, s[12:15], s23 offen offset:1024 lds
    v_mfma_f32_16x16x32_bf16 v[92:95], a[236:239], a[188:191], v[92:95]
    v_mfma_f32_16x16x32_bf16 v[84:87], a[236:239], a[184:187], v[84:87]
    v_mfma_f32_16x16x32_bf16 v[76:79], a[236:239], a[180:183], v[76:79]
    v_mfma_f32_16x16x32_bf16 v[68:71], a[236:239], a[176:179], v[68:71]
    s_waitcnt vmcnt(37) lgkmcnt(0)
    v_mfma_f32_16x16x32_bf16 v[96:99], a[240:243], a[176:179], v[96:99]
    ds_read_b64_tr_b16 a[224:225], v168 offset:0
    v_mfma_f32_16x16x32_bf16 v[104:107], a[240:243], a[180:183], v[104:107]
    ds_read_b64_tr_b16 a[226:227], v168 offset:1024
    v_mfma_f32_16x16x32_bf16 v[112:115], a[240:243], a[184:187], v[112:115]
    ds_read_b64_tr_b16 a[228:229], v169 offset:0
    v_mfma_f32_16x16x32_bf16 v[120:123], a[240:243], a[188:191], v[120:123]
    buffer_load_dwordx4 a[88:91], v10, s[8:11], s21 offen offset:512 sc1
    v_mfma_f32_16x16x32_bf16 v[124:127], a[244:247], a[188:191], v[124:127]
    ds_read_b64_tr_b16 a[230:231], v169 offset:1024
    v_mfma_f32_16x16x32_bf16 v[116:119], a[244:247], a[184:187], v[116:119]
    ds_read_b64_tr_b16 a[232:233], v170 offset:0
    v_mfma_f32_16x16x32_bf16 v[108:111], a[244:247], a[180:183], v[108:111]
    ds_read_b64_tr_b16 a[234:235], v170 offset:1024
    v_mfma_f32_16x16x32_bf16 v[100:103], a[244:247], a[176:179], v[100:103]
    buffer_load_dwordx4 a[92:95], v10, s[8:11], s21 offen offset:768 sc1
    v_mfma_f32_16x16x32_bf16 v[128:131], a[248:251], a[176:179], v[128:131]
    ds_read_b64_tr_b16 a[236:237], v171 offset:0
    s_add_u32 s21, s18, 2097152
    v_mfma_f32_16x16x32_bf16 v[136:139], a[248:251], a[180:183], v[136:139]
    ds_read_b64_tr_b16 a[238:239], v171 offset:1024
    s_cmp_ge_u32 s21, s19
    s_cselect_b32 s25, 3670016, 0
    v_mfma_f32_16x16x32_bf16 v[144:147], a[248:251], a[184:187], v[144:147]
    s_sub_u32 s21, s21, s25
    v_mfma_f32_16x16x32_bf16 v[152:155], a[248:251], a[188:191], v[152:155]
    buffer_load_dwordx4 a[96:99], v10, s[8:11], s21 offen offset:0 sc1
    v_mfma_f32_16x16x32_bf16 v[156:159], a[252:255], a[188:191], v[156:159]
    v_mfma_f32_16x16x32_bf16 v[148:151], a[252:255], a[184:187], v[148:151]
    buffer_load_dwordx4 a[100:103], v10, s[8:11], s21 offen offset:256 sc1
    v_mfma_f32_16x16x32_bf16 v[140:143], a[252:255], a[180:183], v[140:143]
    v_mfma_f32_16x16x32_bf16 v[132:135], a[252:255], a[176:179], v[132:135]
    s_waitcnt vmcnt(36) lgkmcnt(0)
    v_mfma_f32_16x16x32_bf16 v[32:35], a[224:227], a[192:195], v[32:35]
    ds_read_b64_tr_b16 a[240:241], v172 offset:0
    v_mfma_f32_16x16x32_bf16 v[40:43], a[224:227], a[196:199], v[40:43]
    ds_read_b64_tr_b16 a[242:243], v172 offset:1024
    v_mfma_f32_16x16x32_bf16 v[48:51], a[224:227], a[200:203], v[48:51]
    ds_read_b64_tr_b16 a[244:245], v173 offset:0
    v_mfma_f32_16x16x32_bf16 v[56:59], a[224:227], a[204:207], v[56:59]
    buffer_load_dwordx4 a[104:107], v10, s[8:11], s21 offen offset:512 sc1
    v_mfma_f32_16x16x32_bf16 v[60:63], a[228:231], a[204:207], v[60:63]
    ds_read_b64_tr_b16 a[246:247], v173 offset:1024
    v_mfma_f32_16x16x32_bf16 v[52:55], a[228:231], a[200:203], v[52:55]
    ds_read_b64_tr_b16 a[248:249], v174 offset:0
    v_mfma_f32_16x16x32_bf16 v[44:47], a[228:231], a[196:199], v[44:47]
    ds_read_b64_tr_b16 a[250:251], v174 offset:1024
    v_mfma_f32_16x16x32_bf16 v[36:39], a[228:231], a[192:195], v[36:39]
    buffer_load_dwordx4 a[108:111], v10, s[8:11], s21 offen offset:768 sc1
    v_mfma_f32_16x16x32_bf16 v[64:67], a[232:235], a[192:195], v[64:67]
    ds_read_b64_tr_b16 a[252:253], v175 offset:0
    v_mfma_f32_16x16x32_bf16 v[72:75], a[232:235], a[196:199], v[72:75]
    ds_read_b64_tr_b16 a[254:255], v175 offset:1024
    v_mfma_f32_16x16x32_bf16 v[80:83], a[232:235], a[200:203], v[80:83]
    s_add_u32 s23, s23, 7168
    v_mfma_f32_16x16x32_bf16 v[88:91], a[232:235], a[204:207], v[88:91]
    buffer_load_dwordx4 v0, s[12:15], s23 offen offset:2048 lds
    v_mfma_f32_16x16x32_bf16 v[92:95], a[236:239], a[204:207], v[92:95]
    v_mfma_f32_16x16x32_bf16 v[84:87], a[236:239], a[200:203], v[84:87]
    v_mfma_f32_16x16x32_bf16 v[76:79], a[236:239], a[196:199], v[76:79]
    v_mfma_f32_16x16x32_bf16 v[68:71], a[236:239], a[192:195], v[68:71]
    s_waitcnt vmcnt(39) lgkmcnt(0)
    v_mfma_f32_16x16x32_bf16 v[96:99], a[240:243], a[192:195], v[96:99]
    ds_read_b64_tr_b16 a[224:225], v168 offset:8192
    s_add_u32 s21, s18, 2555904
    v_mfma_f32_16x16x32_bf16 v[104:107], a[240:243], a[196:199], v[104:107]
    ds_read_b64_tr_b16 a[226:227], v168 offset:9216
    s_cmp_ge_u32 s21, s19
    s_cselect_b32 s25, 3670016, 0
    v_mfma_f32_16x16x32_bf16 v[112:115], a[240:243], a[200:203], v[112:115]
    ds_read_b64_tr_b16 a[228:229], v169 offset:8192
    s_sub_u32 s21, s21, s25
    v_mfma_f32_16x16x32_bf16 v[120:123], a[240:243], a[204:207], v[120:123]
    buffer_load_dwordx4 a[112:115], v10, s[8:11], s21 offen offset:0 sc1
    v_mfma_f32_16x16x32_bf16 v[124:127], a[244:247], a[204:207], v[124:127]
    ds_read_b64_tr_b16 a[230:231], v169 offset:9216
    v_mfma_f32_16x16x32_bf16 v[116:119], a[244:247], a[200:203], v[116:119]
    ds_read_b64_tr_b16 a[232:233], v170 offset:8192
    v_mfma_f32_16x16x32_bf16 v[108:111], a[244:247], a[196:199], v[108:111]
    ds_read_b64_tr_b16 a[234:235], v170 offset:9216
    v_mfma_f32_16x16x32_bf16 v[100:103], a[244:247], a[192:195], v[100:103]
    buffer_load_dwordx4 a[116:119], v10, s[8:11], s21 offen offset:256 sc1
    v_mfma_f32_16x16x32_bf16 v[128:131], a[248:251], a[192:195], v[128:131]
    ds_read_b64_tr_b16 a[236:237], v171 offset:8192
    v_mfma_f32_16x16x32_bf16 v[136:139], a[248:251], a[196:199], v[136:139]
    ds_read_b64_tr_b16 a[238:239], v171 offset:9216
    v_mfma_f32_16x16x32_bf16 v[144:147], a[248:251], a[200:203], v[144:147]
    v_mfma_f32_16x16x32_bf16 v[152:155], a[248:251], a[204:207], v[152:155]
    buffer_load_dwordx4 a[120:123], v10, s[8:11], s21 offen offset:512 sc1
    v_mfma_f32_16x16x32_bf16 v[156:159], a[252:255], a[204:207], v[156:159]
    v_mfma_f32_16x16x32_bf16 v[148:151], a[252:255], a[200:203], v[148:151]
    buffer_load_dwordx4 a[124:127], v10, s[8:11], s21 offen offset:768 sc1
    v_mfma_f32_16x16x32_bf16 v[140:143], a[252:255], a[196:199], v[140:143]
    v_mfma_f32_16x16x32_bf16 v[132:135], a[252:255], a[192:195], v[132:135]
    s_waitcnt vmcnt(37) lgkmcnt(0)
    v_mfma_f32_16x16x32_bf16 v[32:35], a[224:227], a[208:211], v[32:35]
    ds_read_b64_tr_b16 a[240:241], v172 offset:8192
    s_add_u32 s21, s18, 3014656
    v_mfma_f32_16x16x32_bf16 v[40:43], a[224:227], a[212:215], v[40:43]
    ds_read_b64_tr_b16 a[242:243], v172 offset:9216
    s_cmp_ge_u32 s21, s19
    s_cselect_b32 s25, 3670016, 0
    v_mfma_f32_16x16x32_bf16 v[48:51], a[224:227], a[216:219], v[48:51]
    ds_read_b64_tr_b16 a[244:245], v173 offset:8192
    s_sub_u32 s21, s21, s25
    v_mfma_f32_16x16x32_bf16 v[56:59], a[224:227], a[220:223], v[56:59]
    buffer_load_dwordx4 a[128:131], v10, s[8:11], s21 offen offset:0 sc1
    v_mfma_f32_16x16x32_bf16 v[60:63], a[228:231], a[220:223], v[60:63]
    ds_read_b64_tr_b16 a[246:247], v173 offset:9216
    v_mfma_f32_16x16x32_bf16 v[52:55], a[228:231], a[216:219], v[52:55]
    ds_read_b64_tr_b16 a[248:249], v174 offset:8192
    v_mfma_f32_16x16x32_bf16 v[44:47], a[228:231], a[212:215], v[44:47]
    ds_read_b64_tr_b16 a[250:251], v174 offset:9216
    v_mfma_f32_16x16x32_bf16 v[36:39], a[228:231], a[208:211], v[36:39]
    buffer_load_dwordx4 a[132:135], v10, s[8:11], s21 offen offset:256 sc1
    v_mfma_f32_16x16x32_bf16 v[64:67], a[232:235], a[208:211], v[64:67]
    ds_read_b64_tr_b16 a[252:253], v175 offset:8192
    v_mfma_f32_16x16x32_bf16 v[72:75], a[232:235], a[212:215], v[72:75]
    ds_read_b64_tr_b16 a[254:255], v175 offset:9216
    v_mfma_f32_16x16x32_bf16 v[80:83], a[232:235], a[216:219], v[80:83]
    s_add_u32 s23, s23, 7168
    v_mfma_f32_16x16x32_bf16 v[88:91], a[232:235], a[220:223], v[88:91]
    buffer_load_dwordx4 v0, s[12:15], s23 offen offset:3072 lds
    v_mfma_f32_16x16x32_bf16 v[92:95], a[236:239], a[220:223], v[92:95]
    v_mfma_f32_16x16x32_bf16 v[84:87], a[236:239], a[216:219], v[84:87]
    v_mfma_f32_16x16x32_bf16 v[76:79], a[236:239], a[212:215], v[76:79]
    v_mfma_f32_16x16x32_bf16 v[68:71], a[236:239], a[208:211], v[68:71]
    s_waitcnt vmcnt(40) lgkmcnt(0)
    v_mfma_f32_16x16x32_bf16 v[96:99], a[240:243], a[208:211], v[96:99]
    ds_read_b64_tr_b16 a[224:225], v168 offset:16384
    v_mfma_f32_16x16x32_bf16 v[104:107], a[240:243], a[212:215], v[104:107]
    ds_read_b64_tr_b16 a[226:227], v168 offset:17408
    v_mfma_f32_16x16x32_bf16 v[112:115], a[240:243], a[216:219], v[112:115]
    ds_read_b64_tr_b16 a[228:229], v169 offset:16384
    v_mfma_f32_16x16x32_bf16 v[120:123], a[240:243], a[220:223], v[120:123]
    buffer_load_dwordx4 a[136:139], v10, s[8:11], s21 offen offset:512 sc1
    v_mfma_f32_16x16x32_bf16 v[124:127], a[244:247], a[220:223], v[124:127]
    ds_read_b64_tr_b16 a[230:231], v169 offset:17408
    v_mfma_f32_16x16x32_bf16 v[116:119], a[244:247], a[216:219], v[116:119]
    ds_read_b64_tr_b16 a[232:233], v170 offset:16384
    v_mfma_f32_16x16x32_bf16 v[108:111], a[244:247], a[212:215], v[108:111]
    ds_read_b64_tr_b16 a[234:235], v170 offset:17408
    v_mfma_f32_16x16x32_bf16 v[100:103], a[244:247], a[208:211], v[100:103]
    buffer_load_dwordx4 a[140:143], v10, s[8:11], s21 offen offset:768 sc1
    v_mfma_f32_16x16x32_bf16 v[128:131], a[248:251], a[208:211], v[128:131]
    ds_read_b64_tr_b16 a[236:237], v171 offset:16384
    s_add_u32 s21, s18, 3473408
    v_mfma_f32_16x16x32_bf16 v[136:139], a[248:251], a[212:215], v[136:139]
    ds_read_b64_tr_b16 a[238:239], v171 offset:17408
    s_cmp_ge_u32 s21, s19
    s_cselect_b32 s25, 3670016, 0
    v_mfma_f32_16x16x32_bf16 v[144:147], a[248:251], a[216:219], v[144:147]
    s_sub_u32 s21, s21, s25
    v_mfma_f32_16x16x32_bf16 v[152:155], a[248:251], a[220:223], v[152:155]
    buffer_load_dwordx4 a[144:147], v10, s[8:11], s21 offen offset:0 sc1
    v_mfma_f32_16x16x32_bf16 v[156:159], a[252:255], a[220:223], v[156:159]
    v_mfma_f32_16x16x32_bf16 v[148:151], a[252:255], a[216:219], v[148:151]
    buffer_load_dwordx4 a[148:151], v10, s[8:11], s21 offen offset:256 sc1
    v_mfma_f32_16x16x32_bf16 v[140:143], a[252:255], a[212:215], v[140:143]
    v_mfma_f32_16x16x32_bf16 v[132:135], a[252:255], a[208:211], v[132:135]
    s_waitcnt vmcnt(40) lgkmcnt(0)
    v_mfma_f32_16x16x32_bf16 v[32:35], a[224:227], a[0:3], v[32:35]
    ds_read_b64_tr_b16 a[240:241], v172 offset:16384
    v_mfma_f32_16x16x32_bf16 v[40:43], a[224:227], a[4:7], v[40:43]
    ds_read_b64_tr_b16 a[242:243], v172 offset:17408
    v_mfma_f32_16x16x32_bf16 v[48:51], a[224:227], a[8:11], v[48:51]
    ds_read_b64_tr_b16 a[244:245], v173 offset:16384
    v_mfma_f32_16x16x32_bf16 v[56:59], a[224:227], a[12:15], v[56:59]
    buffer_load_dwordx4 a[152:155], v10, s[8:11], s21 offen offset:512 sc1
    v_mfma_f32_16x16x32_bf16 v[60:63], a[228:231], a[12:15], v[60:63]
    ds_read_b64_tr_b16 a[246:247], v173 offset:17408
    v_mfma_f32_16x16x32_bf16 v[52:55], a[228:231], a[8:11], v[52:55]
    ds_read_b64_tr_b16 a[248:249], v174 offset:16384
    v_mfma_f32_16x16x32_bf16 v[44:47], a[228:231], a[4:7], v[44:47]
    ds_read_b64_tr_b16 a[250:251], v174 offset:17408
    v_mfma_f32_16x16x32_bf16 v[36:39], a[228:231], a[0:3], v[36:39]
    buffer_load_dwordx4 a[156:159], v10, s[8:11], s21 offen offset:768 sc1
    v_mfma_f32_16x16x32_bf16 v[64:67], a[232:235], a[0:3], v[64:67]
    ds_read_b64_tr_b16 a[252:253], v175 offset:16384
    s_add_u32 m0, s24, 131072
    v_mfma_f32_16x16x32_bf16 v[72:75], a[232:235], a[4:7], v[72:75]
    ds_read_b64_tr_b16 a[254:255], v175 offset:17408
    s_mul_i32 s23, s94, 229376
    v_mfma_f32_16x16x32_bf16 v[80:83], a[232:235], a[8:11], v[80:83]
    s_add_u32 s23, s23, 1114112
    v_mfma_f32_16x16x32_bf16 v[88:91], a[232:235], a[12:15], v[88:91]
    buffer_load_dwordx4 v1, s[12:15], s23 offen offset:0 lds
    v_mfma_f32_16x16x32_bf16 v[92:95], a[236:239], a[12:15], v[92:95]
    v_mfma_f32_16x16x32_bf16 v[84:87], a[236:239], a[8:11], v[84:87]
    v_mfma_f32_16x16x32_bf16 v[76:79], a[236:239], a[4:7], v[76:79]
    v_mfma_f32_16x16x32_bf16 v[68:71], a[236:239], a[0:3], v[68:71]
    s_waitcnt vmcnt(43) lgkmcnt(0)
    v_mfma_f32_16x16x32_bf16 v[96:99], a[240:243], a[0:3], v[96:99]
    ds_read_b64_tr_b16 a[224:225], v168 offset:24576
    v_mfma_f32_16x16x32_bf16 v[104:107], a[240:243], a[4:7], v[104:107]
    ds_read_b64_tr_b16 a[226:227], v168 offset:25600
    v_mfma_f32_16x16x32_bf16 v[112:115], a[240:243], a[8:11], v[112:115]
    ds_read_b64_tr_b16 a[228:229], v169 offset:24576
    s_add_u32 s21, s20, 393216
    v_mfma_f32_16x16x32_bf16 v[120:123], a[240:243], a[12:15], v[120:123]
    buffer_load_dwordx4 a[160:163], v11, s[8:11], s21 offen offset:0 sc1
    v_mfma_f32_16x16x32_bf16 v[124:127], a[244:247], a[12:15], v[124:127]
    ds_read_b64_tr_b16 a[230:231], v169 offset:25600
    v_mfma_f32_16x16x32_bf16 v[116:119], a[244:247], a[8:11], v[116:119]
    ds_read_b64_tr_b16 a[232:233], v170 offset:24576
    v_mfma_f32_16x16x32_bf16 v[108:111], a[244:247], a[4:7], v[108:111]
    ds_read_b64_tr_b16 a[234:235], v170 offset:25600
    v_mfma_f32_16x16x32_bf16 v[100:103], a[244:247], a[0:3], v[100:103]
    buffer_load_dwordx4 a[164:167], v11, s[8:11], s21 offen offset:256 sc1
    v_mfma_f32_16x16x32_bf16 v[128:131], a[248:251], a[0:3], v[128:131]
    ds_read_b64_tr_b16 a[236:237], v171 offset:24576
    v_mfma_f32_16x16x32_bf16 v[136:139], a[248:251], a[4:7], v[136:139]
    ds_read_b64_tr_b16 a[238:239], v171 offset:25600
    v_mfma_f32_16x16x32_bf16 v[144:147], a[248:251], a[8:11], v[144:147]
    v_mfma_f32_16x16x32_bf16 v[152:155], a[248:251], a[12:15], v[152:155]
    buffer_load_dwordx4 a[168:171], v11, s[8:11], s21 offen offset:512 sc1
    v_mfma_f32_16x16x32_bf16 v[156:159], a[252:255], a[12:15], v[156:159]
    v_mfma_f32_16x16x32_bf16 v[148:151], a[252:255], a[8:11], v[148:151]
    buffer_load_dwordx4 a[172:175], v11, s[8:11], s21 offen offset:768 sc1
    v_mfma_f32_16x16x32_bf16 v[140:143], a[252:255], a[4:7], v[140:143]
    v_mfma_f32_16x16x32_bf16 v[132:135], a[252:255], a[0:3], v[132:135]
    s_waitcnt vmcnt(42) lgkmcnt(0)
    v_mfma_f32_16x16x32_bf16 v[32:35], a[224:227], a[16:19], v[32:35]
    ds_read_b64_tr_b16 a[240:241], v172 offset:24576
    v_mfma_f32_16x16x32_bf16 v[40:43], a[224:227], a[20:23], v[40:43]
    ds_read_b64_tr_b16 a[242:243], v172 offset:25600
    v_mfma_f32_16x16x32_bf16 v[48:51], a[224:227], a[24:27], v[48:51]
    ds_read_b64_tr_b16 a[244:245], v173 offset:24576
    s_add_u32 s21, s20, 1310720
    v_mfma_f32_16x16x32_bf16 v[56:59], a[224:227], a[28:31], v[56:59]
    buffer_load_dwordx4 a[176:179], v11, s[8:11], s21 offen offset:0 sc1
    v_mfma_f32_16x16x32_bf16 v[60:63], a[228:231], a[28:31], v[60:63]
    ds_read_b64_tr_b16 a[246:247], v173 offset:25600
    v_mfma_f32_16x16x32_bf16 v[52:55], a[228:231], a[24:27], v[52:55]
    ds_read_b64_tr_b16 a[248:249], v174 offset:24576
    v_mfma_f32_16x16x32_bf16 v[44:47], a[228:231], a[20:23], v[44:47]
    ds_read_b64_tr_b16 a[250:251], v174 offset:25600
    v_mfma_f32_16x16x32_bf16 v[36:39], a[228:231], a[16:19], v[36:39]
    buffer_load_dwordx4 a[180:183], v11, s[8:11], s21 offen offset:256 sc1
    v_mfma_f32_16x16x32_bf16 v[64:67], a[232:235], a[16:19], v[64:67]
    ds_read_b64_tr_b16 a[252:253], v175 offset:24576
    v_mfma_f32_16x16x32_bf16 v[72:75], a[232:235], a[20:23], v[72:75]
    ds_read_b64_tr_b16 a[254:255], v175 offset:25600
    v_mfma_f32_16x16x32_bf16 v[80:83], a[232:235], a[24:27], v[80:83]
    s_add_u32 s23, s23, 7168
    v_mfma_f32_16x16x32_bf16 v[88:91], a[232:235], a[28:31], v[88:91]
    buffer_load_dwordx4 v1, s[12:15], s23 offen offset:1024 lds
    v_mfma_f32_16x16x32_bf16 v[92:95], a[236:239], a[28:31], v[92:95]
    s_mov_b32 s48, 0
    v_mfma_f32_16x16x32_bf16 v[84:87], a[236:239], a[24:27], v[84:87]
    buffer_load_dwordx2 v[184:185], v18, s[44:47], s48 offen offset:0 sc1
    v_mfma_f32_16x16x32_bf16 v[76:79], a[236:239], a[20:23], v[76:79]
    v_mfma_f32_16x16x32_bf16 v[68:71], a[236:239], a[16:19], v[68:71]
    s_waitcnt vmcnt(46) lgkmcnt(0)
    v_mfma_f32_16x16x32_bf16 v[96:99], a[240:243], a[16:19], v[96:99]
    ds_read_b64_tr_b16 a[224:225], v170 offset:32768
    v_mfma_f32_16x16x32_bf16 v[104:107], a[240:243], a[20:23], v[104:107]
    ds_read_b64_tr_b16 a[226:227], v170 offset:33792
    v_mfma_f32_16x16x32_bf16 v[112:115], a[240:243], a[24:27], v[112:115]
    ds_read_b64_tr_b16 a[228:229], v171 offset:32768
    v_mfma_f32_16x16x32_bf16 v[120:123], a[240:243], a[28:31], v[120:123]
    buffer_load_dwordx4 a[184:187], v11, s[8:11], s21 offen offset:512 sc1
    v_mfma_f32_16x16x32_bf16 v[124:127], a[244:247], a[28:31], v[124:127]
    ds_read_b64_tr_b16 a[230:231], v171 offset:33792
    v_mfma_f32_16x16x32_bf16 v[116:119], a[244:247], a[24:27], v[116:119]
    ds_read_b64_tr_b16 a[232:233], v170 offset:40960
    v_mfma_f32_16x16x32_bf16 v[108:111], a[244:247], a[20:23], v[108:111]
    ds_read_b64_tr_b16 a[234:235], v170 offset:41984
    v_mfma_f32_16x16x32_bf16 v[100:103], a[244:247], a[16:19], v[100:103]
    buffer_load_dwordx4 a[188:191], v11, s[8:11], s21 offen offset:768 sc1
    v_mfma_f32_16x16x32_bf16 v[128:131], a[248:251], a[16:19], v[128:131]
    ds_read_b64_tr_b16 a[236:237], v171 offset:40960
    v_mfma_f32_16x16x32_bf16 v[136:139], a[248:251], a[20:23], v[136:139]
    ds_read_b64_tr_b16 a[238:239], v171 offset:41984
    v_mfma_f32_16x16x32_bf16 v[144:147], a[248:251], a[24:27], v[144:147]
    s_add_u32 s21, s20, 2228224
    v_mfma_f32_16x16x32_bf16 v[152:155], a[248:251], a[28:31], v[152:155]
    buffer_load_dwordx4 a[192:195], v11, s[8:11], s21 offen offset:0 sc1
    v_mfma_f32_16x16x32_bf16 v[156:159], a[252:255], a[28:31], v[156:159]
    v_mfma_f32_16x16x32_bf16 v[148:151], a[252:255], a[24:27], v[148:151]
    buffer_load_dwordx4 a[196:199], v11, s[8:11], s21 offen offset:256 sc1
    v_mfma_f32_16x16x32_bf16 v[140:143], a[252:255], a[20:23], v[140:143]
    s_mov_b32 s48, 65536
    v_mfma_f32_16x16x32_bf16 v[132:135], a[252:255], a[16:19], v[132:135]
    buffer_load_dwordx2 v[186:187], v18, s[44:47], s48 offen offset:0 sc1
    s_waitcnt vmcnt(42) lgkmcnt(0)
    v_mfma_f32_16x16x32_bf16 v[64:67], a[224:227], a[32:35], v[64:67]
    ds_read_b64_tr_b16 a[240:241], v170 offset:49152
    v_mfma_f32_16x16x32_bf16 v[72:75], a[224:227], a[36:39], v[72:75]
    ds_read_b64_tr_b16 a[242:243], v170 offset:50176
    v_mfma_f32_16x16x32_bf16 v[80:83], a[224:227], a[40:43], v[80:83]
    ds_read_b64_tr_b16 a[244:245], v171 offset:49152
    v_mfma_f32_16x16x32_bf16 v[88:91], a[224:227], a[44:47], v[88:91]
    buffer_load_dwordx4 a[200:203], v11, s[8:11], s21 offen offset:512 sc1
    v_mfma_f32_16x16x32_bf16 v[92:95], a[228:231], a[44:47], v[92:95]
    ds_read_b64_tr_b16 a[246:247], v171 offset:50176
    v_mfma_f32_16x16x32_bf16 v[84:87], a[228:231], a[40:43], v[84:87]
    ds_read_b64_tr_b16 a[248:249], v170 offset:57344
    v_mfma_f32_16x16x32_bf16 v[76:79], a[228:231], a[36:39], v[76:79]
    ds_read_b64_tr_b16 a[250:251], v170 offset:58368
    v_mfma_f32_16x16x32_bf16 v[68:71], a[228:231], a[32:35], v[68:71]
    buffer_load_dwordx4 a[204:207], v11, s[8:11], s21 offen offset:768 sc1
    v_mfma_f32_16x16x32_bf16 v[64:67], a[232:235], a[48:51], v[64:67]
    ds_read_b64_tr_b16 a[252:253], v171 offset:57344
    v_mfma_f32_16x16x32_bf16 v[72:75], a[232:235], a[52:55], v[72:75]
    ds_read_b64_tr_b16 a[254:255], v171 offset:58368
    v_mfma_f32_16x16x32_bf16 v[80:83], a[232:235], a[56:59], v[80:83]
    s_add_u32 s23, s23, 7168
    v_mfma_f32_16x16x32_bf16 v[88:91], a[232:235], a[60:63], v[88:91]
    buffer_load_dwordx4 v0, s[12:15], s23 offen offset:2048 lds
    v_mfma_f32_16x16x32_bf16 v[92:95], a[236:239], a[60:63], v[92:95]
    s_mov_b32 s48, 0
    v_mfma_f32_16x16x32_bf16 v[84:87], a[236:239], a[56:59], v[84:87]
    buffer_load_dwordx2 v[188:189], v18, s[44:47], s48 offen offset:128 sc1
    v_mfma_f32_16x16x32_bf16 v[76:79], a[236:239], a[52:55], v[76:79]
    v_mfma_f32_16x16x32_bf16 v[68:71], a[236:239], a[48:51], v[68:71]
    s_waitcnt vmcnt(36) lgkmcnt(0)
    s_barrier
    v_mfma_f32_16x16x32_bf16 v[64:67], a[240:243], a[64:67], v[64:67]
    ds_read_b64_tr_b16 a[224:225], v162 offset:0
    v_mfma_f32_16x16x32_bf16 v[72:75], a[240:243], a[68:71], v[72:75]
    ds_read_b64_tr_b16 a[226:227], v162 offset:1024
    v_mfma_f32_16x16x32_bf16 v[80:83], a[240:243], a[72:75], v[80:83]
    ds_read_b64_tr_b16 a[228:229], v163 offset:0
    s_add_u32 s21, s20, 3145728
    v_mfma_f32_16x16x32_bf16 v[88:91], a[240:243], a[76:79], v[88:91]
    buffer_load_dwordx4 a[208:211], v11, s[8:11], s21 offen offset:0 sc1
    v_mfma_f32_16x16x32_bf16 v[92:95], a[244:247], a[76:79], v[92:95]
    ds_read_b64_tr_b16 a[230:231], v163 offset:1024
    v_mfma_f32_16x16x32_bf16 v[84:87], a[244:247], a[72:75], v[84:87]
    ds_read_b64_tr_b16 a[232:233], v162 offset:8192
    v_mfma_f32_16x16x32_bf16 v[76:79], a[244:247], a[68:71], v[76:79]
    ds_read_b64_tr_b16 a[234:235], v162 offset:9216
    v_mfma_f32_16x16x32_bf16 v[68:71], a[244:247], a[64:67], v[68:71]
    buffer_load_dwordx4 a[212:215], v11, s[8:11], s21 offen offset:256 sc1
    v_mfma_f32_16x16x32_bf16 v[64:67], a[248:251], a[80:83], v[64:67]
    ds_read_b64_tr_b16 a[236:237], v163 offset:8192
    v_mfma_f32_16x16x32_bf16 v[72:75], a[248:251], a[84:87], v[72:75]
    ds_read_b64_tr_b16 a[238:239], v163 offset:9216
    v_mfma_f32_16x16x32_bf16 v[80:83], a[248:251], a[88:91], v[80:83]
    v_mfma_f32_16x16x32_bf16 v[88:91], a[248:251], a[92:95], v[88:91]
    buffer_load_dwordx4 a[216:219], v11, s[8:11], s21 offen offset:512 sc1
    v_mfma_f32_16x16x32_bf16 v[92:95], a[252:255], a[92:95], v[92:95]
    v_mfma_f32_16x16x32_bf16 v[84:87], a[252:255], a[88:91], v[84:87]
    buffer_load_dwordx4 a[220:223], v11, s[8:11], s21 offen offset:768 sc1
    v_mfma_f32_16x16x32_bf16 v[76:79], a[252:255], a[84:87], v[76:79]
    s_mov_b32 s48, 65536
    v_mfma_f32_16x16x32_bf16 v[68:71], a[252:255], a[80:83], v[68:71]
    buffer_load_dwordx2 v[190:191], v18, s[44:47], s48 offen offset:128 sc1
    s_waitcnt vmcnt(32) lgkmcnt(0)
    v_mfma_f32_16x16x32_bf16 v[64:67], a[224:227], a[96:99], v[64:67]
    ds_read_b64_tr_b16 a[240:241], v162 offset:16384
    v_mfma_f32_16x16x32_bf16 v[72:75], a[224:227], a[100:103], v[72:75]
    ds_read_b64_tr_b16 a[242:243], v162 offset:17408
    v_mfma_f32_16x16x32_bf16 v[80:83], a[224:227], a[104:107], v[80:83]
    ds_read_b64_tr_b16 a[244:245], v163 offset:16384
    s_add_u32 s23, s23, 7168
    v_mfma_f32_16x16x32_bf16 v[88:91], a[224:227], a[108:111], v[88:91]
    buffer_load_dwordx4 v0, s[12:15], s23 offen offset:3072 lds
    v_mfma_f32_16x16x32_bf16 v[92:95], a[228:231], a[108:111], v[92:95]
    ds_read_b64_tr_b16 a[246:247], v163 offset:17408
    v_mfma_f32_16x16x32_bf16 v[84:87], a[228:231], a[104:107], v[84:87]
    ds_read_b64_tr_b16 a[248:249], v162 offset:24576
    v_mfma_f32_16x16x32_bf16 v[76:79], a[228:231], a[100:103], v[76:79]
    ds_read_b64_tr_b16 a[250:251], v162 offset:25600
    s_mov_b32 s48, 0
    v_mfma_f32_16x16x32_bf16 v[68:71], a[228:231], a[96:99], v[68:71]
    buffer_load_dwordx2 v[192:193], v18, s[44:47], s48 offen offset:256 sc1
    v_mfma_f32_16x16x32_bf16 v[64:67], a[232:235], a[112:115], v[64:67]
    ds_read_b64_tr_b16 a[252:253], v163 offset:24576
    v_mfma_f32_16x16x32_bf16 v[72:75], a[232:235], a[116:119], v[72:75]
    ds_read_b64_tr_b16 a[254:255], v163 offset:25600
    v_mfma_f32_16x16x32_bf16 v[80:83], a[232:235], a[120:123], v[80:83]
    v_mfma_f32_16x16x32_bf16 v[88:91], a[232:235], a[124:127], v[88:91]
    v_mfma_f32_16x16x32_bf16 v[92:95], a[236:239], a[124:127], v[92:95]
    v_mfma_f32_16x16x32_bf16 v[84:87], a[236:239], a[120:123], v[84:87]
    v_mfma_f32_16x16x32_bf16 v[76:79], a[236:239], a[116:119], v[76:79]
    v_mfma_f32_16x16x32_bf16 v[68:71], a[236:239], a[112:115], v[68:71]
    s_waitcnt vmcnt(25) lgkmcnt(0)
    s_barrier
    v_mfma_f32_16x16x32_bf16 v[64:67], a[240:243], a[128:131], v[64:67]
    ds_read_b64_tr_b16 a[224:225], v162 offset:32768
    v_mfma_f32_16x16x32_bf16 v[72:75], a[240:243], a[132:135], v[72:75]
    ds_read_b64_tr_b16 a[226:227], v162 offset:33792
    v_mfma_f32_16x16x32_bf16 v[80:83], a[240:243], a[136:139], v[80:83]
    ds_read_b64_tr_b16 a[228:229], v163 offset:32768
    s_mov_b32 s48, 65536
    v_mfma_f32_16x16x32_bf16 v[88:91], a[240:243], a[140:143], v[88:91]
    buffer_load_dwordx2 v[194:195], v18, s[44:47], s48 offen offset:256 sc1
    v_mfma_f32_16x16x32_bf16 v[92:95], a[244:247], a[140:143], v[92:95]
    ds_read_b64_tr_b16 a[230:231], v163 offset:33792
    v_mfma_f32_16x16x32_bf16 v[84:87], a[244:247], a[136:139], v[84:87]
    ds_read_b64_tr_b16 a[232:233], v162 offset:40960
    v_mfma_f32_16x16x32_bf16 v[76:79], a[244:247], a[132:135], v[76:79]
    ds_read_b64_tr_b16 a[234:235], v162 offset:41984
    v_mfma_f32_16x16x32_bf16 v[68:71], a[244:247], a[128:131], v[68:71]
    v_mfma_f32_16x16x32_bf16 v[64:67], a[248:251], a[144:147], v[64:67]
    ds_read_b64_tr_b16 a[236:237], v163 offset:40960
    v_mfma_f32_16x16x32_bf16 v[72:75], a[248:251], a[148:151], v[72:75]
    ds_read_b64_tr_b16 a[238:239], v163 offset:41984
    v_mfma_f32_16x16x32_bf16 v[80:83], a[248:251], a[152:155], v[80:83]
    v_mfma_f32_16x16x32_bf16 v[88:91], a[248:251], a[156:159], v[88:91]
    v_mfma_f32_16x16x32_bf16 v[92:95], a[252:255], a[156:159], v[92:95]
    v_mfma_f32_16x16x32_bf16 v[84:87], a[252:255], a[152:155], v[84:87]
    v_mfma_f32_16x16x32_bf16 v[76:79], a[252:255], a[148:151], v[76:79]
    v_mfma_f32_16x16x32_bf16 v[68:71], a[252:255], a[144:147], v[68:71]
    s_waitcnt vmcnt(2) lgkmcnt(0)
    s_barrier
    v_mfma_f32_16x16x32_bf16 v[64:67], a[224:227], a[160:163], v[64:67]
    ds_read_b64_tr_b16 a[240:241], v178 offset:0
    v_mfma_f32_16x16x32_bf16 v[72:75], a[224:227], a[164:167], v[72:75]
    ds_read_b64_tr_b16 a[242:243], v178 offset:1024
    v_mfma_f32_16x16x32_bf16 v[80:83], a[224:227], a[168:171], v[80:83]
    ds_read_b64_tr_b16 a[244:245], v179 offset:0
    s_mov_b32 s48, 0
    v_mfma_f32_16x16x32_bf16 v[88:91], a[224:227], a[172:175], v[88:91]
    buffer_load_dwordx2 v[196:197], v18, s[44:47], s48 offen offset:384 sc1
    v_mfma_f32_16x16x32_bf16 v[92:95], a[228:231], a[172:175], v[92:95]
    ds_read_b64_tr_b16 a[246:247], v179 offset:1024
    v_mfma_f32_16x16x32_bf16 v[84:87], a[228:231], a[168:171], v[84:87]
    ds_read_b64_tr_b16 a[248:249], v178 offset:8192
    v_mfma_f32_16x16x32_bf16 v[76:79], a[228:231], a[164:167], v[76:79]
    ds_read_b64_tr_b16 a[250:251], v178 offset:9216
    v_mfma_f32_16x16x32_bf16 v[68:71], a[228:231], a[160:163], v[68:71]
    v_mfma_f32_16x16x32_bf16 v[64:67], a[232:235], a[176:179], v[64:67]
    ds_read_b64_tr_b16 a[252:253], v179 offset:8192
    v_mfma_f32_16x16x32_bf16 v[72:75], a[232:235], a[180:183], v[72:75]
    ds_read_b64_tr_b16 a[254:255], v179 offset:9216
    v_mfma_f32_16x16x32_bf16 v[80:83], a[232:235], a[184:187], v[80:83]
    v_mfma_f32_16x16x32_bf16 v[88:91], a[232:235], a[188:191], v[88:91]
    v_mfma_f32_16x16x32_bf16 v[92:95], a[236:239], a[188:191], v[92:95]
    v_mfma_f32_16x16x32_bf16 v[84:87], a[236:239], a[184:187], v[84:87]
    v_mfma_f32_16x16x32_bf16 v[76:79], a[236:239], a[180:183], v[76:79]
    v_mfma_f32_16x16x32_bf16 v[68:71], a[236:239], a[176:179], v[68:71]
    s_waitcnt vmcnt(5) lgkmcnt(0)
    v_mfma_f32_16x16x32_bf16 v[64:67], a[240:243], a[192:195], v[64:67]
    ds_read_b64_tr_b16 a[224:225], v172 offset:32768
    v_mfma_f32_16x16x32_bf16 v[72:75], a[240:243], a[196:199], v[72:75]
    ds_read_b64_tr_b16 a[226:227], v172 offset:33792
    v_mfma_f32_16x16x32_bf16 v[80:83], a[240:243], a[200:203], v[80:83]
    ds_read_b64_tr_b16 a[228:229], v173 offset:32768
    s_mov_b32 s48, 65536
    v_mfma_f32_16x16x32_bf16 v[88:91], a[240:243], a[204:207], v[88:91]
    buffer_load_dwordx2 v[198:199], v18, s[44:47], s48 offen offset:384 sc1
    v_mfma_f32_16x16x32_bf16 v[92:95], a[244:247], a[204:207], v[92:95]
    ds_read_b64_tr_b16 a[230:231], v173 offset:33792
    v_mfma_f32_16x16x32_bf16 v[84:87], a[244:247], a[200:203], v[84:87]
    ds_read_b64_tr_b16 a[232:233], v172 offset:40960
    v_mfma_f32_16x16x32_bf16 v[76:79], a[244:247], a[196:199], v[76:79]
    ds_read_b64_tr_b16 a[234:235], v172 offset:41984
    v_mfma_f32_16x16x32_bf16 v[68:71], a[244:247], a[192:195], v[68:71]
    v_mfma_f32_16x16x32_bf16 v[64:67], a[248:251], a[208:211], v[64:67]
    ds_read_b64_tr_b16 a[236:237], v173 offset:40960
    v_mfma_f32_16x16x32_bf16 v[72:75], a[248:251], a[212:215], v[72:75]
    ds_read_b64_tr_b16 a[238:239], v173 offset:41984
    v_mfma_f32_16x16x32_bf16 v[80:83], a[248:251], a[216:219], v[80:83]
    v_mfma_f32_16x16x32_bf16 v[88:91], a[248:251], a[220:223], v[88:91]
    v_mfma_f32_16x16x32_bf16 v[92:95], a[252:255], a[220:223], v[92:95]
    v_mfma_f32_16x16x32_bf16 v[84:87], a[252:255], a[216:219], v[84:87]
    v_mfma_f32_16x16x32_bf16 v[76:79], a[252:255], a[212:215], v[76:79]
    v_mfma_f32_16x16x32_bf16 v[68:71], a[252:255], a[208:211], v[68:71]
    s_waitcnt vmcnt(56) lgkmcnt(0)
    v_mfma_f32_16x16x32_bf16 v[96:99], a[224:227], a[32:35], v[96:99]
    ds_read_b64_tr_b16 a[240:241], v172 offset:49152
    v_mfma_f32_16x16x32_bf16 v[104:107], a[224:227], a[36:39], v[104:107]
    ds_read_b64_tr_b16 a[242:243], v172 offset:50176
    v_mfma_f32_16x16x32_bf16 v[112:115], a[224:227], a[40:43], v[112:115]
    ds_read_b64_tr_b16 a[244:245], v173 offset:49152
    v_mfma_f32_16x16x32_bf16 v[120:123], a[224:227], a[44:47], v[120:123]
    v_mfma_f32_16x16x32_bf16 v[124:127], a[228:231], a[44:47], v[124:127]
    ds_read_b64_tr_b16 a[246:247], v173 offset:50176
    v_mfma_f32_16x16x32_bf16 v[116:119], a[228:231], a[40:43], v[116:119]
    ds_read_b64_tr_b16 a[248:249], v172 offset:57344
    v_cvt_pk_bf16_f32 v64, v64, v65
    v_mfma_f32_16x16x32_bf16 v[108:111], a[228:231], a[36:39], v[108:111]
    ds_read_b64_tr_b16 a[250:251], v172 offset:58368
    v_cvt_pk_bf16_f32 v65, v66, v67
    v_mfma_f32_16x16x32_bf16 v[100:103], a[228:231], a[32:35], v[100:103]
    v_cvt_pk_bf16_f32 v66, v68, v69
    v_cvt_pk_bf16_f32 v67, v70, v71
    v_mfma_f32_16x16x32_bf16 v[96:99], a[232:235], a[48:51], v[96:99]
    ds_read_b64_tr_b16 a[252:253], v173 offset:57344
    buffer_store_dwordx4 v[64:67], v17, s[36:39], s28 offen offset:0 sc1
    v_mfma_f32_16x16x32_bf16 v[104:107], a[232:235], a[52:55], v[104:107]
    ds_read_b64_tr_b16 a[254:255], v173 offset:58368
    v_cvt_pk_bf16_f32 v68, v72, v73
    v_mfma_f32_16x16x32_bf16 v[112:115], a[232:235], a[56:59], v[112:115]
    v_cvt_pk_bf16_f32 v69, v74, v75
    v_cvt_pk_bf16_f32 v70, v76, v77
    v_mfma_f32_16x16x32_bf16 v[120:123], a[232:235], a[60:63], v[120:123]
    v_cvt_pk_bf16_f32 v71, v78, v79
    buffer_store_dwordx4 v[68:71], v17, s[36:39], s28 offen offset:1024 sc1
    v_mfma_f32_16x16x32_bf16 v[124:127], a[236:239], a[60:63], v[124:127]
    v_cvt_pk_bf16_f32 v72, v80, v81
    v_cvt_pk_bf16_f32 v73, v82, v83
    v_mfma_f32_16x16x32_bf16 v[116:119], a[236:239], a[56:59], v[116:119]
    v_cvt_pk_bf16_f32 v74, v84, v85
    v_cvt_pk_bf16_f32 v75, v86, v87
    v_mfma_f32_16x16x32_bf16 v[108:111], a[236:239], a[52:55], v[108:111]
    buffer_store_dwordx4 v[72:75], v17, s[36:39], s28 offen offset:2048 sc1
    v_cvt_pk_bf16_f32 v76, v88, v89
    v_mfma_f32_16x16x32_bf16 v[100:103], a[236:239], a[48:51], v[100:103]
    v_cvt_pk_bf16_f32 v77, v90, v91
    v_cvt_pk_bf16_f32 v78, v92, v93
    s_waitcnt vmcnt(49) lgkmcnt(0)
    v_mfma_f32_16x16x32_bf16 v[96:99], a[240:243], a[64:67], v[96:99]
    ds_read_b64_tr_b16 a[224:225], v164 offset:0
    v_cvt_pk_bf16_f32 v79, v94, v95
    v_mfma_f32_16x16x32_bf16 v[104:107], a[240:243], a[68:71], v[104:107]
    ds_read_b64_tr_b16 a[226:227], v164 offset:1024
    buffer_store_dwordx4 v[76:79], v17, s[36:39], s28 offen offset:3072 sc1
    v_mfma_f32_16x16x32_bf16 v[112:115], a[240:243], a[72:75], v[112:115]
    ds_read_b64_tr_b16 a[228:229], v165 offset:0
    v_mfma_f32_16x16x32_bf16 v[120:123], a[240:243], a[76:79], v[120:123]
    v_mfma_f32_16x16x32_bf16 v[124:127], a[244:247], a[76:79], v[124:127]
    ds_read_b64_tr_b16 a[230:231], v165 offset:1024
    v_mfma_f32_16x16x32_bf16 v[116:119], a[244:247], a[72:75], v[116:119]
    ds_read_b64_tr_b16 a[232:233], v164 offset:8192
    v_mfma_f32_16x16x32_bf16 v[108:111], a[244:247], a[68:71], v[108:111]
    ds_read_b64_tr_b16 a[234:235], v164 offset:9216
    v_mfma_f32_16x16x32_bf16 v[100:103], a[244:247], a[64:67], v[100:103]
    v_mfma_f32_16x16x32_bf16 v[96:99], a[248:251], a[80:83], v[96:99]
    ds_read_b64_tr_b16 a[236:237], v165 offset:8192
    v_mfma_f32_16x16x32_bf16 v[104:107], a[248:251], a[84:87], v[104:107]
    ds_read_b64_tr_b16 a[238:239], v165 offset:9216
    v_mfma_f32_16x16x32_bf16 v[112:115], a[248:251], a[88:91], v[112:115]
    v_mfma_f32_16x16x32_bf16 v[120:123], a[248:251], a[92:95], v[120:123]
    v_mfma_f32_16x16x32_bf16 v[124:127], a[252:255], a[92:95], v[124:127]
    v_mfma_f32_16x16x32_bf16 v[116:119], a[252:255], a[88:91], v[116:119]
    v_mfma_f32_16x16x32_bf16 v[108:111], a[252:255], a[84:87], v[108:111]
    v_mfma_f32_16x16x32_bf16 v[100:103], a[252:255], a[80:83], v[100:103]
    s_waitcnt vmcnt(41) lgkmcnt(0)
    v_mfma_f32_16x16x32_bf16 v[96:99], a[224:227], a[96:99], v[96:99]
    ds_read_b64_tr_b16 a[240:241], v164 offset:16384
    v_mfma_f32_16x16x32_bf16 v[104:107], a[224:227], a[100:103], v[104:107]
    ds_read_b64_tr_b16 a[242:243], v164 offset:17408
    v_mfma_f32_16x16x32_bf16 v[112:115], a[224:227], a[104:107], v[112:115]
    ds_read_b64_tr_b16 a[244:245], v165 offset:16384
    v_mfma_f32_16x16x32_bf16 v[120:123], a[224:227], a[108:111], v[120:123]
    v_mfma_f32_16x16x32_bf16 v[124:127], a[228:231], a[108:111], v[124:127]
    ds_read_b64_tr_b16 a[246:247], v165 offset:17408
    v_mfma_f32_16x16x32_bf16 v[116:119], a[228:231], a[104:107], v[116:119]
    ds_read_b64_tr_b16 a[248:249], v164 offset:24576
    v_mfma_f32_16x16x32_bf16 v[108:111], a[228:231], a[100:103], v[108:111]
    ds_read_b64_tr_b16 a[250:251], v164 offset:25600
    v_mfma_f32_16x16x32_bf16 v[100:103], a[228:231], a[96:99], v[100:103]
    v_mfma_f32_16x16x32_bf16 v[96:99], a[232:235], a[112:115], v[96:99]
    ds_read_b64_tr_b16 a[252:253], v165 offset:24576
    v_mfma_f32_16x16x32_bf16 v[104:107], a[232:235], a[116:119], v[104:107]
    ds_read_b64_tr_b16 a[254:255], v165 offset:25600
    v_mfma_f32_16x16x32_bf16 v[112:115], a[232:235], a[120:123], v[112:115]
    v_mfma_f32_16x16x32_bf16 v[120:123], a[232:235], a[124:127], v[120:123]
    v_mfma_f32_16x16x32_bf16 v[124:127], a[236:239], a[124:127], v[124:127]
    v_mfma_f32_16x16x32_bf16 v[116:119], a[236:239], a[120:123], v[116:119]
    v_mfma_f32_16x16x32_bf16 v[108:111], a[236:239], a[116:119], v[108:111]
    v_mfma_f32_16x16x32_bf16 v[100:103], a[236:239], a[112:115], v[100:103]
    s_waitcnt vmcnt(4) lgkmcnt(0)
    v_mfma_f32_16x16x32_bf16 v[96:99], a[240:243], a[128:131], v[96:99]
    ds_read_b64_tr_b16 a[224:225], v164 offset:32768
    v_lshlrev_b32 v64, 16, v184
    v_mfma_f32_16x16x32_bf16 v[104:107], a[240:243], a[132:135], v[104:107]
    ds_read_b64_tr_b16 a[226:227], v164 offset:33792
    v_and_b32 v65, s3, v184
    v_mfma_f32_16x16x32_bf16 v[112:115], a[240:243], a[136:139], v[112:115]
    ds_read_b64_tr_b16 a[228:229], v165 offset:32768
    v_lshlrev_b32 v66, 16, v185
    v_mfma_f32_16x16x32_bf16 v[120:123], a[240:243], a[140:143], v[120:123]
    v_and_b32 v67, s3, v185
    v_mfma_f32_16x16x32_bf16 v[124:127], a[244:247], a[140:143], v[124:127]
    ds_read_b64_tr_b16 a[230:231], v165 offset:33792
    v_lshlrev_b32 v68, 16, v186
    v_mfma_f32_16x16x32_bf16 v[116:119], a[244:247], a[136:139], v[116:119]
    ds_read_b64_tr_b16 a[232:233], v164 offset:40960
    v_and_b32 v69, s3, v186
    v_mfma_f32_16x16x32_bf16 v[108:111], a[244:247], a[132:135], v[108:111]
    ds_read_b64_tr_b16 a[234:235], v164 offset:41984
    v_lshlrev_b32 v70, 16, v187
    v_mfma_f32_16x16x32_bf16 v[100:103], a[244:247], a[128:131], v[100:103]
    v_and_b32 v71, s3, v187
    v_mfma_f32_16x16x32_bf16 v[96:99], a[248:251], a[144:147], v[96:99]
    ds_read_b64_tr_b16 a[236:237], v165 offset:40960
    v_lshlrev_b32 v72, 16, v188
    v_mfma_f32_16x16x32_bf16 v[104:107], a[248:251], a[148:151], v[104:107]
    ds_read_b64_tr_b16 a[238:239], v165 offset:41984
    v_and_b32 v73, s3, v188
    v_mfma_f32_16x16x32_bf16 v[112:115], a[248:251], a[152:155], v[112:115]
    v_lshlrev_b32 v74, 16, v189
    v_mfma_f32_16x16x32_bf16 v[120:123], a[248:251], a[156:159], v[120:123]
    v_and_b32 v75, s3, v189
    v_mfma_f32_16x16x32_bf16 v[124:127], a[252:255], a[156:159], v[124:127]
    v_lshlrev_b32 v76, 16, v190
    v_mfma_f32_16x16x32_bf16 v[116:119], a[252:255], a[152:155], v[116:119]
    v_and_b32 v77, s3, v190
    v_mfma_f32_16x16x32_bf16 v[108:111], a[252:255], a[148:151], v[108:111]
    v_lshlrev_b32 v78, 16, v191
    v_mfma_f32_16x16x32_bf16 v[100:103], a[252:255], a[144:147], v[100:103]
    v_and_b32 v79, s3, v191
    s_waitcnt vmcnt(21) lgkmcnt(0)
    v_mfma_f32_16x16x32_bf16 v[96:99], a[224:227], a[160:163], v[96:99]
    ds_read_b64_tr_b16 a[240:241], v180 offset:0
    v_lshlrev_b32 v80, 16, v192
    v_mfma_f32_16x16x32_bf16 v[104:107], a[224:227], a[164:167], v[104:107]
    ds_read_b64_tr_b16 a[242:243], v180 offset:1024
    v_and_b32 v81, s3, v192
    v_mfma_f32_16x16x32_bf16 v[112:115], a[224:227], a[168:171], v[112:115]
    ds_read_b64_tr_b16 a[244:245], v181 offset:0
    v_lshlrev_b32 v82, 16, v193
    v_mfma_f32_16x16x32_bf16 v[120:123], a[224:227], a[172:175], v[120:123]
    v_and_b32 v83, s3, v193
    v_mfma_f32_16x16x32_bf16 v[124:127], a[228:231], a[172:175], v[124:127]
    ds_read_b64_tr_b16 a[246:247], v181 offset:1024
    v_lshlrev_b32 v84, 16, v194
    v_mfma_f32_16x16x32_bf16 v[116:119], a[228:231], a[168:171], v[116:119]
    ds_read_b64_tr_b16 a[248:249], v180 offset:8192
    v_and_b32 v85, s3, v194
    v_mfma_f32_16x16x32_bf16 v[108:111], a[228:231], a[164:167], v[108:111]
    ds_read_b64_tr_b16 a[250:251], v180 offset:9216
    v_lshlrev_b32 v86, 16, v195
    v_mfma_f32_16x16x32_bf16 v[100:103], a[228:231], a[160:163], v[100:103]
    v_and_b32 v87, s3, v195
    v_mfma_f32_16x16x32_bf16 v[96:99], a[232:235], a[176:179], v[96:99]
    ds_read_b64_tr_b16 a[252:253], v181 offset:8192
    v_lshlrev_b32 v88, 16, v196
    v_mfma_f32_16x16x32_bf16 v[104:107], a[232:235], a[180:183], v[104:107]
    ds_read_b64_tr_b16 a[254:255], v181 offset:9216
    v_and_b32 v89, s3, v196
    v_mfma_f32_16x16x32_bf16 v[112:115], a[232:235], a[184:187], v[112:115]
    v_lshlrev_b32 v90, 16, v197
    v_mfma_f32_16x16x32_bf16 v[120:123], a[232:235], a[188:191], v[120:123]
    v_and_b32 v91, s3, v197
    v_mfma_f32_16x16x32_bf16 v[124:127], a[236:239], a[188:191], v[124:127]
    v_lshlrev_b32 v92, 16, v198
    v_mfma_f32_16x16x32_bf16 v[116:119], a[236:239], a[184:187], v[116:119]
    v_and_b32 v93, s3, v198
    v_mfma_f32_16x16x32_bf16 v[108:111], a[236:239], a[180:183], v[108:111]
    v_lshlrev_b32 v94, 16, v199
    v_mfma_f32_16x16x32_bf16 v[100:103], a[236:239], a[176:179], v[100:103]
    v_and_b32 v95, s3, v199
    s_waitcnt vmcnt(0) lgkmcnt(0)
    v_mfma_f32_16x16x32_bf16 v[96:99], a[240:243], a[192:195], v[96:99]
    ds_read_b64_tr_b16 a[224:225], v174 offset:32768
    v_mfma_f32_16x16x32_bf16 v[104:107], a[240:243], a[196:199], v[104:107]
    ds_read_b64_tr_b16 a[226:227], v174 offset:33792
    v_mfma_f32_16x16x32_bf16 v[112:115], a[240:243], a[200:203], v[112:115]
    ds_read_b64_tr_b16 a[228:229], v175 offset:32768
    s_xor_b32 s50, s16, 512
    v_mfma_f32_16x16x32_bf16 v[120:123], a[240:243], a[204:207], v[120:123]
    buffer_store_dwordx2 v[14:15], v19, s[60:63], s50 offen offset:0 sc1
    v_mfma_f32_16x16x32_bf16 v[124:127], a[244:247], a[204:207], v[124:127]
    ds_read_b64_tr_b16 a[230:231], v175 offset:33792
    v_mfma_f32_16x16x32_bf16 v[116:119], a[244:247], a[200:203], v[116:119]
    ds_read_b64_tr_b16 a[232:233], v174 offset:40960
    v_mfma_f32_16x16x32_bf16 v[108:111], a[244:247], a[196:199], v[108:111]
    ds_read_b64_tr_b16 a[234:235], v174 offset:41984
    v_mfma_f32_16x16x32_bf16 v[100:103], a[244:247], a[192:195], v[100:103]
    v_mfma_f32_16x16x32_bf16 v[96:99], a[248:251], a[208:211], v[96:99]
    ds_read_b64_tr_b16 a[236:237], v175 offset:40960
    v_mfma_f32_16x16x32_bf16 v[104:107], a[248:251], a[212:215], v[104:107]
    ds_read_b64_tr_b16 a[238:239], v175 offset:41984
    v_mfma_f32_16x16x32_bf16 v[112:115], a[248:251], a[216:219], v[112:115]
    v_mfma_f32_16x16x32_bf16 v[120:123], a[248:251], a[220:223], v[120:123]
    v_mfma_f32_16x16x32_bf16 v[124:127], a[252:255], a[220:223], v[124:127]
    v_mfma_f32_16x16x32_bf16 v[116:119], a[252:255], a[216:219], v[116:119]
    v_mfma_f32_16x16x32_bf16 v[108:111], a[252:255], a[212:215], v[108:111]
    v_mfma_f32_16x16x32_bf16 v[100:103], a[252:255], a[208:211], v[100:103]
    s_waitcnt vmcnt(61) lgkmcnt(0)
    v_mfma_f32_16x16x32_bf16 v[128:131], a[224:227], a[32:35], v[128:131]
    ds_read_b64_tr_b16 a[240:241], v174 offset:49152
    v_mfma_f32_16x16x32_bf16 v[136:139], a[224:227], a[36:39], v[136:139]
    ds_read_b64_tr_b16 a[242:243], v174 offset:50176
    v_mfma_f32_16x16x32_bf16 v[144:147], a[224:227], a[40:43], v[144:147]
    ds_read_b64_tr_b16 a[244:245], v175 offset:49152
    v_mfma_f32_16x16x32_bf16 v[152:155], a[224:227], a[44:47], v[152:155]
    v_mfma_f32_16x16x32_bf16 v[156:159], a[228:231], a[44:47], v[156:159]
    ds_read_b64_tr_b16 a[246:247], v175 offset:50176
    v_mfma_f32_16x16x32_bf16 v[148:151], a[228:231], a[40:43], v[148:151]
    ds_read_b64_tr_b16 a[248:249], v174 offset:57344
    v_cvt_pk_bf16_f32 v96, v96, v97
    v_mfma_f32_16x16x32_bf16 v[140:143], a[228:231], a[36:39], v[140:143]
    ds_read_b64_tr_b16 a[250:251], v174 offset:58368
    v_cvt_pk_bf16_f32 v97, v98, v99
    v_mfma_f32_16x16x32_bf16 v[132:135], a[228:231], a[32:35], v[132:135]
    v_cvt_pk_bf16_f32 v98, v100, v101
    v_cvt_pk_bf16_f32 v99, v102, v103
    v_mfma_f32_16x16x32_bf16 v[128:131], a[232:235], a[48:51], v[128:131]
    ds_read_b64_tr_b16 a[252:253], v175 offset:57344
    buffer_store_dwordx4 v[96:99], v17, s[36:39], s29 offen offset:0 sc1
    v_mfma_f32_16x16x32_bf16 v[136:139], a[232:235], a[52:55], v[136:139]
    ds_read_b64_tr_b16 a[254:255], v175 offset:58368
    v_cvt_pk_bf16_f32 v100, v104, v105
    v_mfma_f32_16x16x32_bf16 v[144:147], a[232:235], a[56:59], v[144:147]
    v_cvt_pk_bf16_f32 v101, v106, v107
    v_cvt_pk_bf16_f32 v102, v108, v109
    v_mfma_f32_16x16x32_bf16 v[152:155], a[232:235], a[60:63], v[152:155]
    v_cvt_pk_bf16_f32 v103, v110, v111
    buffer_store_dwordx4 v[100:103], v17, s[36:39], s29 offen offset:1024 sc1
    v_mfma_f32_16x16x32_bf16 v[156:159], a[236:239], a[60:63], v[156:159]
    v_cvt_pk_bf16_f32 v104, v112, v113
    v_cvt_pk_bf16_f32 v105, v114, v115
    v_mfma_f32_16x16x32_bf16 v[148:151], a[236:239], a[56:59], v[148:151]
    v_cvt_pk_bf16_f32 v106, v116, v117
    v_cvt_pk_bf16_f32 v107, v118, v119
    v_mfma_f32_16x16x32_bf16 v[140:143], a[236:239], a[52:55], v[140:143]
    buffer_store_dwordx4 v[104:107], v17, s[36:39], s29 offen offset:2048 sc1
    v_cvt_pk_bf16_f32 v108, v120, v121
    v_mfma_f32_16x16x32_bf16 v[132:135], a[236:239], a[48:51], v[132:135]
    v_cvt_pk_bf16_f32 v109, v122, v123
    v_cvt_pk_bf16_f32 v110, v124, v125
    s_waitcnt vmcnt(54) lgkmcnt(0)
    v_mfma_f32_16x16x32_bf16 v[128:131], a[240:243], a[64:67], v[128:131]
    ds_read_b64_tr_b16 a[224:225], v166 offset:0
    v_cvt_pk_bf16_f32 v111, v126, v127
    v_mfma_f32_16x16x32_bf16 v[136:139], a[240:243], a[68:71], v[136:139]
    ds_read_b64_tr_b16 a[226:227], v166 offset:1024
    buffer_store_dwordx4 v[108:111], v17, s[36:39], s29 offen offset:3072 sc1
    v_mfma_f32_16x16x32_bf16 v[144:147], a[240:243], a[72:75], v[144:147]
    ds_read_b64_tr_b16 a[228:229], v167 offset:0
    v_mfma_f32_16x16x32_bf16 v[152:155], a[240:243], a[76:79], v[152:155]
    v_mfma_f32_16x16x32_bf16 v[156:159], a[244:247], a[76:79], v[156:159]
    ds_read_b64_tr_b16 a[230:231], v167 offset:1024
    v_mfma_f32_16x16x32_bf16 v[148:151], a[244:247], a[72:75], v[148:151]
    ds_read_b64_tr_b16 a[232:233], v166 offset:8192
    v_mfma_f32_16x16x32_bf16 v[140:143], a[244:247], a[68:71], v[140:143]
    ds_read_b64_tr_b16 a[234:235], v166 offset:9216
    v_mfma_f32_16x16x32_bf16 v[132:135], a[244:247], a[64:67], v[132:135]
    v_mfma_f32_16x16x32_bf16 v[128:131], a[248:251], a[80:83], v[128:131]
    ds_read_b64_tr_b16 a[236:237], v167 offset:8192
    v_mfma_f32_16x16x32_bf16 v[136:139], a[248:251], a[84:87], v[136:139]
    ds_read_b64_tr_b16 a[238:239], v167 offset:9216
    v_mfma_f32_16x16x32_bf16 v[144:147], a[248:251], a[88:91], v[144:147]
    v_mfma_f32_16x16x32_bf16 v[152:155], a[248:251], a[92:95], v[152:155]
    v_mfma_f32_16x16x32_bf16 v[156:159], a[252:255], a[92:95], v[156:159]
    v_mfma_f32_16x16x32_bf16 v[148:151], a[252:255], a[88:91], v[148:151]
    v_mfma_f32_16x16x32_bf16 v[140:143], a[252:255], a[84:87], v[140:143]
    v_mfma_f32_16x16x32_bf16 v[132:135], a[252:255], a[80:83], v[132:135]
    s_waitcnt vmcnt(46) lgkmcnt(0)
    v_mfma_f32_16x16x32_bf16 v[128:131], a[224:227], a[96:99], v[128:131]
    ds_read_b64_tr_b16 a[240:241], v166 offset:16384
    v_mfma_f32_16x16x32_bf16 v[136:139], a[224:227], a[100:103], v[136:139]
    ds_read_b64_tr_b16 a[242:243], v166 offset:17408
    v_mfma_f32_16x16x32_bf16 v[144:147], a[224:227], a[104:107], v[144:147]
    ds_read_b64_tr_b16 a[244:245], v167 offset:16384
    v_mfma_f32_16x16x32_bf16 v[152:155], a[224:227], a[108:111], v[152:155]
    buffer_load_dwordx2 v[24:25], off, s[60:63], s16 offset:0 sc1
    v_mfma_f32_16x16x32_bf16 v[156:159], a[228:231], a[108:111], v[156:159]
    ds_read_b64_tr_b16 a[246:247], v167 offset:17408
    v_mfma_f32_16x16x32_bf16 v[148:151], a[228:231], a[104:107], v[148:151]
    ds_read_b64_tr_b16 a[248:249], v166 offset:24576
    v_mfma_f32_16x16x32_bf16 v[140:143], a[228:231], a[100:103], v[140:143]
    ds_read_b64_tr_b16 a[250:251], v166 offset:25600
    v_mfma_f32_16x16x32_bf16 v[132:135], a[228:231], a[96:99], v[132:135]
    v_mfma_f32_16x16x32_bf16 v[128:131], a[232:235], a[112:115], v[128:131]
    ds_read_b64_tr_b16 a[252:253], v167 offset:24576
    v_mfma_f32_16x16x32_bf16 v[136:139], a[232:235], a[116:119], v[136:139]
    ds_read_b64_tr_b16 a[254:255], v167 offset:25600
    v_mfma_f32_16x16x32_bf16 v[144:147], a[232:235], a[120:123], v[144:147]
    v_mfma_f32_16x16x32_bf16 v[152:155], a[232:235], a[124:127], v[152:155]
    v_mfma_f32_16x16x32_bf16 v[156:159], a[236:239], a[124:127], v[156:159]
    v_mfma_f32_16x16x32_bf16 v[148:151], a[236:239], a[120:123], v[148:151]
    v_mfma_f32_16x16x32_bf16 v[140:143], a[236:239], a[116:119], v[140:143]
    v_mfma_f32_16x16x32_bf16 v[132:135], a[236:239], a[112:115], v[132:135]
    s_waitcnt vmcnt(38) lgkmcnt(0)
    v_mfma_f32_16x16x32_bf16 v[128:131], a[240:243], a[128:131], v[128:131]
    ds_read_b64_tr_b16 a[224:225], v166 offset:32768
    v_mfma_f32_16x16x32_bf16 v[136:139], a[240:243], a[132:135], v[136:139]
    ds_read_b64_tr_b16 a[226:227], v166 offset:33792
    v_mfma_f32_16x16x32_bf16 v[144:147], a[240:243], a[136:139], v[144:147]
    ds_read_b64_tr_b16 a[228:229], v167 offset:32768
    v_mfma_f32_16x16x32_bf16 v[152:155], a[240:243], a[140:143], v[152:155]
    v_mfma_f32_16x16x32_bf16 v[156:159], a[244:247], a[140:143], v[156:159]
    ds_read_b64_tr_b16 a[230:231], v167 offset:33792
    v_mfma_f32_16x16x32_bf16 v[148:151], a[244:247], a[136:139], v[148:151]
    ds_read_b64_tr_b16 a[232:233], v166 offset:40960
    v_mfma_f32_16x16x32_bf16 v[140:143], a[244:247], a[132:135], v[140:143]
    ds_read_b64_tr_b16 a[234:235], v166 offset:41984
    v_mfma_f32_16x16x32_bf16 v[132:135], a[244:247], a[128:131], v[132:135]
    v_mfma_f32_16x16x32_bf16 v[128:131], a[248:251], a[144:147], v[128:131]
    ds_read_b64_tr_b16 a[236:237], v167 offset:40960
    v_mfma_f32_16x16x32_bf16 v[136:139], a[248:251], a[148:151], v[136:139]
    ds_read_b64_tr_b16 a[238:239], v167 offset:41984
    v_mfma_f32_16x16x32_bf16 v[144:147], a[248:251], a[152:155], v[144:147]
    v_mfma_f32_16x16x32_bf16 v[152:155], a[248:251], a[156:159], v[152:155]
    v_mfma_f32_16x16x32_bf16 v[156:159], a[252:255], a[156:159], v[156:159]
    v_mfma_f32_16x16x32_bf16 v[148:151], a[252:255], a[152:155], v[148:151]
    v_mfma_f32_16x16x32_bf16 v[140:143], a[252:255], a[148:151], v[140:143]
    v_mfma_f32_16x16x32_bf16 v[132:135], a[252:255], a[144:147], v[132:135]
    s_waitcnt vmcnt(27) lgkmcnt(0)
    v_mfma_f32_16x16x32_bf16 v[128:131], a[224:227], a[160:163], v[128:131]
    ds_read_b64_tr_b16 a[240:241], v182 offset:0
    v_mfma_f32_16x16x32_bf16 v[136:139], a[224:227], a[164:167], v[136:139]
    ds_read_b64_tr_b16 a[242:243], v182 offset:1024
    v_mfma_f32_16x16x32_bf16 v[144:147], a[224:227], a[168:171], v[144:147]
    ds_read_b64_tr_b16 a[244:245], v183 offset:0
    v_mfma_f32_16x16x32_bf16 v[152:155], a[224:227], a[172:175], v[152:155]
    v_mfma_f32_16x16x32_bf16 v[156:159], a[228:231], a[172:175], v[156:159]
    ds_read_b64_tr_b16 a[246:247], v183 offset:1024
    v_mfma_f32_16x16x32_bf16 v[148:151], a[228:231], a[168:171], v[148:151]
    ds_read_b64_tr_b16 a[248:249], v182 offset:8192
    v_mfma_f32_16x16x32_bf16 v[140:143], a[228:231], a[164:167], v[140:143]
    ds_read_b64_tr_b16 a[250:251], v182 offset:9216
    v_mfma_f32_16x16x32_bf16 v[132:135], a[228:231], a[160:163], v[132:135]
    v_mfma_f32_16x16x32_bf16 v[128:131], a[232:235], a[176:179], v[128:131]
    ds_read_b64_tr_b16 a[252:253], v183 offset:8192
    v_mfma_f32_16x16x32_bf16 v[136:139], a[232:235], a[180:183], v[136:139]
    ds_read_b64_tr_b16 a[254:255], v183 offset:9216
    v_mfma_f32_16x16x32_bf16 v[144:147], a[232:235], a[184:187], v[144:147]
    v_mfma_f32_16x16x32_bf16 v[152:155], a[232:235], a[188:191], v[152:155]
    v_mfma_f32_16x16x32_bf16 v[156:159], a[236:239], a[188:191], v[156:159]
    v_mfma_f32_16x16x32_bf16 v[148:151], a[236:239], a[184:187], v[148:151]
    v_mfma_f32_16x16x32_bf16 v[140:143], a[236:239], a[180:183], v[140:143]
    v_mfma_f32_16x16x32_bf16 v[132:135], a[236:239], a[176:179], v[132:135]
    s_waitcnt vmcnt(0) lgkmcnt(0)
    v_mfma_f32_16x16x32_bf16 v[128:131], a[240:243], a[192:195], v[128:131]
    ds_read_b64_tr_b16 a[224:225], v168 offset:32768
    v_mfma_f32_16x16x32_bf16 v[136:139], a[240:243], a[196:199], v[136:139]
    ds_read_b64_tr_b16 a[226:227], v168 offset:33792
    v_mfma_f32_16x16x32_bf16 v[144:147], a[240:243], a[200:203], v[144:147]
    ds_read_b64_tr_b16 a[228:229], v169 offset:32768
    s_xor_b32 s50, s16, 1024
    v_mfma_f32_16x16x32_bf16 v[152:155], a[240:243], a[204:207], v[152:155]
    buffer_store_dwordx2 v[14:15], v19, s[60:63], s50 offen offset:16 sc1
    v_mfma_f32_16x16x32_bf16 v[156:159], a[244:247], a[204:207], v[156:159]
    ds_read_b64_tr_b16 a[230:231], v169 offset:33792
    v_mfma_f32_16x16x32_bf16 v[148:151], a[244:247], a[200:203], v[148:151]
    ds_read_b64_tr_b16 a[232:233], v168 offset:40960
    v_mfma_f32_16x16x32_bf16 v[140:143], a[244:247], a[196:199], v[140:143]
    ds_read_b64_tr_b16 a[234:235], v168 offset:41984
    s_add_u32 s28, s31, 0
    v_mfma_f32_16x16x32_bf16 v[132:135], a[244:247], a[192:195], v[132:135]
    buffer_load_dwordx4 v[200:203], v17, s[36:39], s28 offen offset:0 sc1
    v_mfma_f32_16x16x32_bf16 v[128:131], a[248:251], a[208:211], v[128:131]
    ds_read_b64_tr_b16 a[236:237], v169 offset:40960
    v_mfma_f32_16x16x32_bf16 v[136:139], a[248:251], a[212:215], v[136:139]
    ds_read_b64_tr_b16 a[238:239], v169 offset:41984
    v_mfma_f32_16x16x32_bf16 v[144:147], a[248:251], a[216:219], v[144:147]
    v_mfma_f32_16x16x32_bf16 v[152:155], a[248:251], a[220:223], v[152:155]
    buffer_load_dwordx4 v[204:207], v17, s[36:39], s28 offen offset:1024 sc1
    v_mfma_f32_16x16x32_bf16 v[156:159], a[252:255], a[220:223], v[156:159]
    v_mfma_f32_16x16x32_bf16 v[148:151], a[252:255], a[216:219], v[148:151]
    buffer_load_dwordx4 v[208:211], v17, s[36:39], s28 offen offset:2048 sc1
    v_mfma_f32_16x16x32_bf16 v[140:143], a[252:255], a[212:215], v[140:143]
    v_mfma_f32_16x16x32_bf16 v[132:135], a[252:255], a[208:211], v[132:135]
    buffer_load_dwordx4 v[212:215], v17, s[36:39], s28 offen offset:3072 sc1
    s_waitcnt vmcnt(63) lgkmcnt(0)
    v_mfma_f32_16x16x32_bf16 v[32:35], a[224:227], a[32:35], v[32:35]
    ds_read_b64_tr_b16 a[240:241], v168 offset:49152
    v_mfma_f32_16x16x32_bf16 v[40:43], a[224:227], a[36:39], v[40:43]
    ds_read_b64_tr_b16 a[242:243], v168 offset:50176
    v_mfma_f32_16x16x32_bf16 v[48:51], a[224:227], a[40:43], v[48:51]
    ds_read_b64_tr_b16 a[244:245], v169 offset:49152
    v_mfma_f32_16x16x32_bf16 v[56:59], a[224:227], a[44:47], v[56:59]
    v_mfma_f32_16x16x32_bf16 v[60:63], a[228:231], a[44:47], v[60:63]
    ds_read_b64_tr_b16 a[246:247], v169 offset:50176
    v_mfma_f32_16x16x32_bf16 v[52:55], a[228:231], a[40:43], v[52:55]
    ds_read_b64_tr_b16 a[248:249], v168 offset:57344
    v_cvt_pk_bf16_f32 v128, v128, v129
    v_mfma_f32_16x16x32_bf16 v[44:47], a[228:231], a[36:39], v[44:47]
    ds_read_b64_tr_b16 a[250:251], v168 offset:58368
    v_cvt_pk_bf16_f32 v129, v130, v131
    v_mfma_f32_16x16x32_bf16 v[36:39], a[228:231], a[32:35], v[36:39]
    v_cvt_pk_bf16_f32 v130, v132, v133
    v_cvt_pk_bf16_f32 v131, v134, v135
    v_mfma_f32_16x16x32_bf16 v[32:35], a[232:235], a[48:51], v[32:35]
    ds_read_b64_tr_b16 a[252:253], v169 offset:57344
    v_min_u32 v128, v128, v20
    v_mfma_f32_16x16x32_bf16 v[40:43], a[232:235], a[52:55], v[40:43]
    ds_read_b64_tr_b16 a[254:255], v169 offset:58368
    v_min_u32 v129, v129, v20
    v_mfma_f32_16x16x32_bf16 v[48:51], a[232:235], a[56:59], v[48:51]
    v_min_u32 v130, v130, v20
    v_min_u32 v131, v131, v20
    v_mfma_f32_16x16x32_bf16 v[56:59], a[232:235], a[60:63], v[56:59]
    buffer_store_dwordx4 v[128:131], v17, s[36:39], s30 offen offset:0 sc1
    v_cvt_pk_bf16_f32 v132, v136, v137
    v_mfma_f32_16x16x32_bf16 v[60:63], a[236:239], a[60:63], v[60:63]
    v_cvt_pk_bf16_f32 v133, v138, v139
    v_cvt_pk_bf16_f32 v134, v140, v141
    v_mfma_f32_16x16x32_bf16 v[52:55], a[236:239], a[56:59], v[52:55]
    v_cvt_pk_bf16_f32 v135, v142, v143
    v_min_u32 v132, v132, v20
    v_mfma_f32_16x16x32_bf16 v[44:47], a[236:239], a[52:55], v[44:47]
    v_min_u32 v133, v133, v20
    v_min_u32 v134, v134, v20
    v_mfma_f32_16x16x32_bf16 v[36:39], a[236:239], a[48:51], v[36:39]
    v_min_u32 v135, v135, v20
    buffer_store_dwordx4 v[132:135], v17, s[36:39], s30 offen offset:1024 sc1
    s_waitcnt vmcnt(63) lgkmcnt(0)
    v_mfma_f32_16x16x32_bf16 v[32:35], a[240:243], a[64:67], v[32:35]
    ds_read_b64_tr_b16 a[224:225], v160 offset:0
    v_cvt_pk_bf16_f32 v136, v144, v145
    v_mfma_f32_16x16x32_bf16 v[40:43], a[240:243], a[68:71], v[40:43]
    ds_read_b64_tr_b16 a[226:227], v160 offset:1024
    v_cvt_pk_bf16_f32 v137, v146, v147
    v_mfma_f32_16x16x32_bf16 v[48:51], a[240:243], a[72:75], v[48:51]
    ds_read_b64_tr_b16 a[228:229], v161 offset:0
    v_cvt_pk_bf16_f32 v138, v148, v149
    v_mfma_f32_16x16x32_bf16 v[56:59], a[240:243], a[76:79], v[56:59]
    v_cvt_pk_bf16_f32 v139, v150, v151
    v_min_u32 v136, v136, v20
    v_mfma_f32_16x16x32_bf16 v[60:63], a[244:247], a[76:79], v[60:63]
    ds_read_b64_tr_b16 a[230:231], v161 offset:1024
    v_min_u32 v137, v137, v20
    v_mfma_f32_16x16x32_bf16 v[52:55], a[244:247], a[72:75], v[52:55]
    ds_read_b64_tr_b16 a[232:233], v160 offset:8192
    v_min_u32 v138, v138, v20
    v_mfma_f32_16x16x32_bf16 v[44:47], a[244:247], a[68:71], v[44:47]
    ds_read_b64_tr_b16 a[234:235], v160 offset:9216
    v_min_u32 v139, v139, v20
    v_mfma_f32_16x16x32_bf16 v[36:39], a[244:247], a[64:67], v[36:39]
    buffer_store_dwordx4 v[136:139], v17, s[36:39], s30 offen offset:2048 sc1
    v_cvt_pk_bf16_f32 v140, v152, v153
    v_mfma_f32_16x16x32_bf16 v[32:35], a[248:251], a[80:83], v[32:35]
    ds_read_b64_tr_b16 a[236:237], v161 offset:8192
    v_cvt_pk_bf16_f32 v141, v154, v155
    v_mfma_f32_16x16x32_bf16 v[40:43], a[248:251], a[84:87], v[40:43]
    ds_read_b64_tr_b16 a[238:239], v161 offset:9216
    v_cvt_pk_bf16_f32 v142, v156, v157
    v_mfma_f32_16x16x32_bf16 v[48:51], a[248:251], a[88:91], v[48:51]
    v_cvt_pk_bf16_f32 v143, v158, v159
    v_min_u32 v140, v140, v20
    v_mfma_f32_16x16x32_bf16 v[56:59], a[248:251], a[92:95], v[56:59]
    v_min_u32 v141, v141, v20
    v_min_u32 v142, v142, v20
    v_mfma_f32_16x16x32_bf16 v[60:63], a[252:255], a[92:95], v[60:63]
    v_min_u32_e64 v143, v143, v20
    buffer_store_dwordx4 v[140:143], v17, s[36:39], s30 offen offset:3072 sc1
    v_mfma_f32_16x16x32_bf16 v[52:55], a[252:255], a[88:91], v[52:55]
    v_mfma_f32_16x16x32_bf16 v[44:47], a[252:255], a[84:87], v[44:47]
    v_mfma_f32_16x16x32_bf16 v[36:39], a[252:255], a[80:83], v[36:39]
    s_waitcnt vmcnt(56) lgkmcnt(0)
    v_mfma_f32_16x16x32_bf16 v[32:35], a[224:227], a[96:99], v[32:35]
    ds_read_b64_tr_b16 a[240:241], v160 offset:16384
    v_mfma_f32_16x16x32_bf16 v[40:43], a[224:227], a[100:103], v[40:43]
    ds_read_b64_tr_b16 a[242:243], v160 offset:17408
    v_mfma_f32_16x16x32_bf16 v[48:51], a[224:227], a[104:107], v[48:51]
    ds_read_b64_tr_b16 a[244:245], v161 offset:16384
    v_mfma_f32_16x16x32_bf16 v[56:59], a[224:227], a[108:111], v[56:59]
    buffer_load_dwordx2 v[26:27], off, s[60:63], s16 offset:16 sc1
    v_mfma_f32_16x16x32_bf16 v[60:63], a[228:231], a[108:111], v[60:63]
    ds_read_b64_tr_b16 a[246:247], v161 offset:17408
    v_mfma_f32_16x16x32_bf16 v[52:55], a[228:231], a[104:107], v[52:55]
    ds_read_b64_tr_b16 a[248:249], v160 offset:24576
    v_mfma_f32_16x16x32_bf16 v[44:47], a[228:231], a[100:103], v[44:47]
    ds_read_b64_tr_b16 a[250:251], v160 offset:25600
    v_mfma_f32_16x16x32_bf16 v[36:39], a[228:231], a[96:99], v[36:39]
    v_mfma_f32_16x16x32_bf16 v[32:35], a[232:235], a[112:115], v[32:35]
    ds_read_b64_tr_b16 a[252:253], v161 offset:24576
    v_mfma_f32_16x16x32_bf16 v[40:43], a[232:235], a[116:119], v[40:43]
    ds_read_b64_tr_b16 a[254:255], v161 offset:25600
    v_mfma_f32_16x16x32_bf16 v[48:51], a[232:235], a[120:123], v[48:51]
    v_mfma_f32_16x16x32_bf16 v[56:59], a[232:235], a[124:127], v[56:59]
    v_mfma_f32_16x16x32_bf16 v[60:63], a[236:239], a[124:127], v[60:63]
    v_mfma_f32_16x16x32_bf16 v[52:55], a[236:239], a[120:123], v[52:55]
    v_mfma_f32_16x16x32_bf16 v[44:47], a[236:239], a[116:119], v[44:47]
    v_mfma_f32_16x16x32_bf16 v[36:39], a[236:239], a[112:115], v[36:39]
    s_waitcnt vmcnt(48) lgkmcnt(0)
    v_mfma_f32_16x16x32_bf16 v[32:35], a[240:243], a[128:131], v[32:35]
    ds_read_b64_tr_b16 a[224:225], v160 offset:32768
    v_mfma_f32_16x16x32_bf16 v[40:43], a[240:243], a[132:135], v[40:43]
    ds_read_b64_tr_b16 a[226:227], v160 offset:33792
    v_mfma_f32_16x16x32_bf16 v[48:51], a[240:243], a[136:139], v[48:51]
    ds_read_b64_tr_b16 a[228:229], v161 offset:32768
    v_mfma_f32_16x16x32_bf16 v[56:59], a[240:243], a[140:143], v[56:59]
    v_mfma_f32_16x16x32_bf16 v[60:63], a[244:247], a[140:143], v[60:63]
    ds_read_b64_tr_b16 a[230:231], v161 offset:33792
    v_mfma_f32_16x16x32_bf16 v[52:55], a[244:247], a[136:139], v[52:55]
    ds_read_b64_tr_b16 a[232:233], v160 offset:40960
    v_mfma_f32_16x16x32_bf16 v[44:47], a[244:247], a[132:135], v[44:47]
    ds_read_b64_tr_b16 a[234:235], v160 offset:41984
    v_mfma_f32_16x16x32_bf16 v[36:39], a[244:247], a[128:131], v[36:39]
    v_mfma_f32_16x16x32_bf16 v[32:35], a[248:251], a[144:147], v[32:35]
    ds_read_b64_tr_b16 a[236:237], v161 offset:40960
    v_mfma_f32_16x16x32_bf16 v[40:43], a[248:251], a[148:151], v[40:43]
    ds_read_b64_tr_b16 a[238:239], v161 offset:41984
    v_mfma_f32_16x16x32_bf16 v[48:51], a[248:251], a[152:155], v[48:51]
    v_mfma_f32_16x16x32_bf16 v[56:59], a[248:251], a[156:159], v[56:59]
    v_mfma_f32_16x16x32_bf16 v[60:63], a[252:255], a[156:159], v[60:63]
    v_mfma_f32_16x16x32_bf16 v[52:55], a[252:255], a[152:155], v[52:55]
    v_mfma_f32_16x16x32_bf16 v[44:47], a[252:255], a[148:151], v[44:47]
    v_mfma_f32_16x16x32_bf16 v[36:39], a[252:255], a[144:147], v[36:39]
    s_waitcnt vmcnt(37) lgkmcnt(0)
    v_mfma_f32_16x16x32_bf16 v[32:35], a[224:227], a[160:163], v[32:35]
    ds_read_b64_tr_b16 a[240:241], v176 offset:0
    v_mfma_f32_16x16x32_bf16 v[40:43], a[224:227], a[164:167], v[40:43]
    ds_read_b64_tr_b16 a[242:243], v176 offset:1024
    v_mfma_f32_16x16x32_bf16 v[48:51], a[224:227], a[168:171], v[48:51]
    ds_read_b64_tr_b16 a[244:245], v177 offset:0
    v_mfma_f32_16x16x32_bf16 v[56:59], a[224:227], a[172:175], v[56:59]
    v_mfma_f32_16x16x32_bf16 v[60:63], a[228:231], a[172:175], v[60:63]
    ds_read_b64_tr_b16 a[246:247], v177 offset:1024
    v_mfma_f32_16x16x32_bf16 v[52:55], a[228:231], a[168:171], v[52:55]
    ds_read_b64_tr_b16 a[248:249], v176 offset:8192
    v_mfma_f32_16x16x32_bf16 v[44:47], a[228:231], a[164:167], v[44:47]
    ds_read_b64_tr_b16 a[250:251], v176 offset:9216
    v_mfma_f32_16x16x32_bf16 v[36:39], a[228:231], a[160:163], v[36:39]
    v_mfma_f32_16x16x32_bf16 v[32:35], a[232:235], a[176:179], v[32:35]
    ds_read_b64_tr_b16 a[252:253], v177 offset:8192
    v_mfma_f32_16x16x32_bf16 v[40:43], a[232:235], a[180:183], v[40:43]
    ds_read_b64_tr_b16 a[254:255], v177 offset:9216
    v_mfma_f32_16x16x32_bf16 v[48:51], a[232:235], a[184:187], v[48:51]
    v_mfma_f32_16x16x32_bf16 v[56:59], a[232:235], a[188:191], v[56:59]
    v_mfma_f32_16x16x32_bf16 v[60:63], a[236:239], a[188:191], v[60:63]
    v_mfma_f32_16x16x32_bf16 v[52:55], a[236:239], a[184:187], v[52:55]
    v_mfma_f32_16x16x32_bf16 v[44:47], a[236:239], a[180:183], v[44:47]
    v_mfma_f32_16x16x32_bf16 v[36:39], a[236:239], a[176:179], v[36:39]
    s_waitcnt vmcnt(0) lgkmcnt(0)
    v_mfma_f32_16x16x32_bf16 v[32:35], a[240:243], a[192:195], v[32:35]
    v_mfma_f32_16x16x32_bf16 v[40:43], a[240:243], a[196:199], v[40:43]
    v_mfma_f32_16x16x32_bf16 v[48:51], a[240:243], a[200:203], v[48:51]
    s_add_u32 s28, s31, 16384
    v_mfma_f32_16x16x32_bf16 v[56:59], a[240:243], a[204:207], v[56:59]
    buffer_load_dwordx4 v[216:219], v17, s[36:39], s28 offen offset:0 sc1
    v_mfma_f32_16x16x32_bf16 v[60:63], a[244:247], a[204:207], v[60:63]
    v_mfma_f32_16x16x32_bf16 v[52:55], a[244:247], a[200:203], v[52:55]
    v_mfma_f32_16x16x32_bf16 v[44:47], a[244:247], a[196:199], v[44:47]
    v_mfma_f32_16x16x32_bf16 v[36:39], a[244:247], a[192:195], v[36:39]
    buffer_load_dwordx4 v[220:223], v17, s[36:39], s28 offen offset:1024 sc1
    v_mfma_f32_16x16x32_bf16 v[32:35], a[248:251], a[208:211], v[32:35]
    v_mfma_f32_16x16x32_bf16 v[40:43], a[248:251], a[212:215], v[40:43]
    v_mfma_f32_16x16x32_bf16 v[48:51], a[248:251], a[216:219], v[48:51]
    v_mfma_f32_16x16x32_bf16 v[56:59], a[248:251], a[220:223], v[56:59]
    buffer_load_dwordx4 v[224:227], v17, s[36:39], s28 offen offset:2048 sc1
    v_mfma_f32_16x16x32_bf16 v[60:63], a[252:255], a[220:223], v[60:63]
    v_mfma_f32_16x16x32_bf16 v[52:55], a[252:255], a[216:219], v[52:55]
    buffer_load_dwordx4 v[228:231], v17, s[36:39], s28 offen offset:3072 sc1
    v_mfma_f32_16x16x32_bf16 v[44:47], a[252:255], a[212:215], v[44:47]
    v_mfma_f32_16x16x32_bf16 v[36:39], a[252:255], a[208:211], v[36:39]
    buffer_load_dwordx4 v[232:235], v17, s[36:39], s32 offen offset:0 sc1
    buffer_load_dwordx4 v[236:239], v17, s[36:39], s32 offen offset:1024 sc1
    buffer_load_dwordx4 v[240:243], v17, s[36:39], s32 offen offset:2048 sc1
    buffer_load_dwordx4 v[244:247], v17, s[36:39], s32 offen offset:3072 sc1
    s_mov_b32 s96, 0
    s_waitcnt vmcnt(8)
    v_cmp_ne_u64 vcc, s[92:93], v[24:25]
    s_cbranch_vccz L_mk_xd_39
L_mk_xp_38:
    buffer_load_dwordx2 v[24:25], off, s[60:63], s16 offset:0 sc1
    s_add_u32 s96, s96, 1
    s_cmp_ge_u32 s96, 400000
    s_waitcnt vmcnt(0)
    s_cbranch_scc1 L_mk_xd_39
    v_cmp_ne_u64_e64 vcc, s[92:93], v[24:25]
    s_cbranch_vccnz L_mk_xp_38
    buffer_load_dwordx4 v[200:203], v17, s[36:39], s31 offen offset:0 sc1
    buffer_load_dwordx4 v[204:207], v17, s[36:39], s31 offen offset:1024 sc1
    buffer_load_dwordx4 v[208:211], v17, s[36:39], s31 offen offset:2048 sc1
    buffer_load_dwordx4 v[212:215], v17, s[36:39], s31 offen offset:3072 sc1
    s_waitcnt vmcnt(0)
L_mk_xd_39:
    v_lshlrev_b32 v96, 16, v200
    v_and_b32 v97, s3, v200
    v_lshlrev_b32 v98, 16, v201
    v_and_b32 v99, s3, v201
    v_lshlrev_b32 v100, 16, v202
    v_and_b32 v101, s3, v202
    v_lshlrev_b32 v102, 16, v203
    v_and_b32 v103, s3, v203
    v_lshlrev_b32 v104, 16, v204
    v_and_b32 v105, s3, v204
    v_lshlrev_b32 v106, 16, v205
    v_and_b32 v107, s3, v205
    v_lshlrev_b32 v108, 16, v206
    v_and_b32 v109, s3, v206
    v_lshlrev_b32 v110, 16, v207
    v_and_b32 v111, s3, v207
    v_lshlrev_b32 v112, 16, v208
    v_and_b32 v113, s3, v208
    v_lshlrev_b32 v114, 16, v209
    v_and_b32 v115, s3, v209
    v_lshlrev_b32 v116, 16, v210
    v_and_b32 v117, s3, v210
    v_lshlrev_b32 v118, 16, v211
    v_and_b32 v119, s3, v211
    v_lshlrev_b32 v120, 16, v212
    v_and_b32 v121, s3, v212
    v_lshlrev_b32 v122, 16, v213
    v_and_b32 v123, s3, v213
    v_lshlrev_b32 v124, 16, v214
    v_and_b32 v125, s3, v214
    v_lshlrev_b32 v126, 16, v215
    v_and_b32_e64 v127, s3, v215
    v_pk_add_f32 v[32:33], v[32:33], v[96:97]
    v_pk_add_f32 v[34:35], v[34:35], v[98:99]
    v_pk_add_f32 v[36:37], v[36:37], v[100:101]
    v_pk_add_f32 v[38:39], v[38:39], v[102:103]
    v_pk_add_f32 v[40:41], v[40:41], v[104:105]
    v_pk_add_f32 v[42:43], v[42:43], v[106:107]
    v_pk_add_f32 v[44:45], v[44:45], v[108:109]
    v_pk_add_f32 v[46:47], v[46:47], v[110:111]
    v_pk_add_f32 v[48:49], v[48:49], v[112:113]
    v_pk_add_f32 v[50:51], v[50:51], v[114:115]
    v_pk_add_f32 v[52:53], v[52:53], v[116:117]
    v_pk_add_f32 v[54:55], v[54:55], v[118:119]
    v_pk_add_f32 v[56:57], v[56:57], v[120:121]
    v_pk_add_f32 v[58:59], v[58:59], v[122:123]
    v_pk_add_f32 v[60:61], v[60:61], v[124:125]
    v_pk_add_f32 v[62:63], v[62:63], v[126:127]
    s_waitcnt vmcnt(4)
    v_cmp_ne_u64_e64 vcc, s[92:93], v[26:27]
    s_cbranch_vccz L_mk_xd_41
L_mk_xp_40:
    buffer_load_dwordx2 v[26:27], off, s[60:63], s16 offset:16 sc1
    s_add_u32 s96, s96, 1
    s_cmp_ge_u32 s96, 400000
    s_waitcnt vmcnt(0)
    s_cbranch_scc1 L_mk_xd_41
    v_cmp_ne_u64_e64 vcc, s[92:93], v[26:27]
    s_cbranch_vccnz L_mk_xp_40
    buffer_load_dwordx4 v[216:219], v17, s[36:39], s28 offen offset:0 sc1
    buffer_load_dwordx4 v[220:223], v17, s[36:39], s28 offen offset:1024 sc1
    buffer_load_dwordx4 v[224:227], v17, s[36:39], s28 offen offset:2048 sc1
    buffer_load_dwordx4 v[228:231], v17, s[36:39], s28 offen offset:3072 sc1
    s_waitcnt vmcnt(0)
L_mk_xd_41:
    v_lshlrev_b32 v96, 16, v216
    v_and_b32 v97, s3, v216
    v_lshlrev_b32 v98, 16, v217
    v_and_b32 v99, s3, v217
    v_lshlrev_b32 v100, 16, v218
    v_and_b32 v101, s3, v218
    v_lshlrev_b32 v102, 16, v219
    v_and_b32 v103, s3, v219
    v_lshlrev_b32 v104, 16, v220
    v_and_b32 v105, s3, v220
    v_lshlrev_b32 v106, 16, v221
    v_and_b32 v107, s3, v221
    v_lshlrev_b32 v108, 16, v222
    v_and_b32 v109, s3, v222
    v_lshlrev_b32 v110, 16, v223
    v_and_b32 v111, s3, v223
    v_lshlrev_b32 v112, 16, v224
    v_and_b32 v113, s3, v224
    v_lshlrev_b32 v114, 16, v225
    v_and_b32 v115, s3, v225
    v_lshlrev_b32 v116, 16, v226
    v_and_b32 v117, s3, v226
    v_lshlrev_b32 v118, 16, v227
    v_and_b32 v119, s3, v227
    v_lshlrev_b32 v120, 16, v228
    v_and_b32 v121, s3, v228
    v_lshlrev_b32 v122, 16, v229
    v_and_b32 v123, s3, v229
    v_lshlrev_b32 v124, 16, v230
    v_and_b32 v125, s3, v230
    v_lshlrev_b32 v126, 16, v231
    v_and_b32_e64 v127, s3, v231
    v_pk_add_f32 v[32:33], v[32:33], v[96:97]
    v_pk_add_f32 v[34:35], v[34:35], v[98:99]
    v_pk_add_f32 v[36:37], v[36:37], v[100:101]
    v_pk_add_f32 v[38:39], v[38:39], v[102:103]
    v_pk_add_f32 v[40:41], v[40:41], v[104:105]
    v_pk_add_f32 v[42:43], v[42:43], v[106:107]
    v_pk_add_f32 v[44:45], v[44:45], v[108:109]
    v_pk_add_f32 v[46:47], v[46:47], v[110:111]
    v_pk_add_f32 v[48:49], v[48:49], v[112:113]
    v_pk_add_f32 v[50:51], v[50:51], v[114:115]
    v_pk_add_f32 v[52:53], v[52:53], v[116:117]
    v_pk_add_f32 v[54:55], v[54:55], v[118:119]
    v_pk_add_f32 v[56:57], v[56:57], v[120:121]
    v_pk_add_f32 v[58:59], v[58:59], v[122:123]
    v_pk_add_f32 v[60:61], v[60:61], v[124:125]
    v_pk_add_f32 v[62:63], v[62:63], v[126:127]
    s_waitcnt vmcnt(0)
L_mk_xp_42:
    s_nop 0
    v_max3_u32 v21, v232, v233, v234
    v_max3_u32 v22, v235, v236, v237
    v_max3_u32 v22, v22, v238, v239
    v_max3_u32 v21, v21, v240, v241
    v_max3_u32 v22, v22, v242, v243
    v_max3_u32 v21, v21, v244, v245
    v_max3_u32 v22, v22, v246, v247
    v_max_u32 v21, v21, v22
    v_cmp_eq_u32 vcc, -1, v21
    s_cbranch_vccz L_mk_xd_43
    s_sleep 4
    buffer_load_dwordx4 v[232:235], v17, s[36:39], s32 offen offset:0 sc1
    buffer_load_dwordx4 v[236:239], v17, s[36:39], s32 offen offset:1024 sc1
    buffer_load_dwordx4 v[240:243], v17, s[36:39], s32 offen offset:2048 sc1
    buffer_load_dwordx4 v[244:247], v17, s[36:39], s32 offen offset:3072 sc1
    s_add_u32 s96, s96, 1
    s_cmp_lt_u32 s96, 400000
    s_waitcnt vmcnt(0)
    s_cbranch_scc1 L_mk_xp_42
L_mk_xd_43:
    v_lshlrev_b32 v96, 16, v232
    v_and_b32 v97, s3, v232
    v_lshlrev_b32 v98, 16, v233
    v_and_b32 v99, s3, v233
    v_lshlrev_b32 v100, 16, v234
    v_and_b32 v101, s3, v234
    v_lshlrev_b32 v102, 16, v235
    v_and_b32_e64 v103, s3, v235
    v_pk_add_f32 v[32:33], v[32:33], v[96:97]
    v_pk_add_f32 v[34:35], v[34:35], v[98:99]
    v_pk_add_f32 v[36:37], v[36:37], v[100:101]
    v_pk_add_f32 v[38:39], v[38:39], v[102:103]
    v_cvt_pk_bf16_f32 v96, v32, v33
    v_cvt_pk_bf16_f32 v97, v34, v35
    v_cvt_pk_bf16_f32 v98, v36, v37
    v_cvt_pk_bf16_f32 v99, v38, v39
    v_lshlrev_b32 v32, 16, v96
    v_and_b32 v33, s3, v96
    v_lshlrev_b32 v34, 16, v97
    v_and_b32 v35, s3, v97
    v_lshlrev_b32 v36, 16, v98
    v_and_b32 v37, s3, v98
    v_lshlrev_b32 v38, 16, v99
    v_and_b32 v39, s3, v99
    v_pk_add_f32 v[32:33], v[32:33], v[64:65]
    v_pk_add_f32 v[34:35], v[34:35], v[66:67]
    v_pk_add_f32 v[36:37], v[36:37], v[68:69]
    v_pk_add_f32 v[38:39], v[38:39], v[70:71]
    v_cvt_pk_bf16_f32 v184, v32, v33
    v_cvt_pk_bf16_f32 v186, v36, v37
    v_cvt_pk_bf16_f32 v185, v34, v35
    v_cvt_pk_bf16_f32 v187, v38, v39
    v_permlane16_swap_b32 v184, v186
    s_mov_b32 s48, 0
    v_permlane16_swap_b32 v185, v187
    buffer_store_dwordx4 v[184:187], v16, s[4:7], s48 offen nt
    v_lshlrev_b32 v104, 16, v236
    v_and_b32 v105, s3, v236
    v_lshlrev_b32 v106, 16, v237
    v_and_b32 v107, s3, v237
    v_lshlrev_b32 v108, 16, v238
    v_and_b32 v109, s3, v238
    v_lshlrev_b32 v110, 16, v239
    v_and_b32_e64 v111, s3, v239
    v_pk_add_f32 v[40:41], v[40:41], v[104:105]
    v_pk_add_f32 v[42:43], v[42:43], v[106:107]
    v_pk_add_f32 v[44:45], v[44:45], v[108:109]
    v_pk_add_f32 v[46:47], v[46:47], v[110:111]
    v_cvt_pk_bf16_f32 v104, v40, v41
    v_cvt_pk_bf16_f32 v105, v42, v43
    v_cvt_pk_bf16_f32 v106, v44, v45
    v_cvt_pk_bf16_f32 v107, v46, v47
    v_lshlrev_b32 v40, 16, v104
    v_and_b32 v41, s3, v104
    v_lshlrev_b32 v42, 16, v105
    v_and_b32 v43, s3, v105
    v_lshlrev_b32 v44, 16, v106
    v_and_b32 v45, s3, v106
    v_lshlrev_b32 v46, 16, v107
    v_and_b32 v47, s3, v107
    v_pk_add_f32 v[40:41], v[40:41], v[72:73]
    v_pk_add_f32 v[42:43], v[42:43], v[74:75]
    v_pk_add_f32 v[44:45], v[44:45], v[76:77]
    v_pk_add_f32 v[46:47], v[46:47], v[78:79]
    v_cvt_pk_bf16_f32 v188, v40, v41
    v_cvt_pk_bf16_f32 v190, v44, v45
    v_cvt_pk_bf16_f32 v189, v42, v43
    v_cvt_pk_bf16_f32 v191, v46, v47
    v_permlane16_swap_b32 v188, v190
    s_mov_b32 s48, 32768
    v_permlane16_swap_b32 v189, v191
    buffer_store_dwordx4 v[188:191], v16, s[4:7], s48 offen nt
    v_lshlrev_b32 v96, 16, v240
    v_and_b32 v97, s3, v240
    v_lshlrev_b32 v98, 16, v241
    v_and_b32 v99, s3, v241
    v_lshlrev_b32 v100, 16, v242
    v_and_b32 v101, s3, v242
    v_lshlrev_b32 v102, 16, v243
    v_and_b32 v103, s3, v243
    v_pk_add_f32 v[48:49], v[48:49], v[96:97]
    v_pk_add_f32 v[50:51], v[50:51], v[98:99]
    v_pk_add_f32 v[52:53], v[52:53], v[100:101]
    v_pk_add_f32 v[54:55], v[54:55], v[102:103]
    v_cvt_pk_bf16_f32 v96, v48, v49
    v_cvt_pk_bf16_f32 v97, v50, v51
    v_cvt_pk_bf16_f32 v98, v52, v53
    v_cvt_pk_bf16_f32 v99, v54, v55
    v_lshlrev_b32 v48, 16, v96
    v_and_b32 v49, s3, v96
    v_lshlrev_b32 v50, 16, v97
    v_and_b32 v51, s3, v97
    v_lshlrev_b32 v52, 16, v98
    v_and_b32 v53, s3, v98
    v_lshlrev_b32 v54, 16, v99
    v_and_b32 v55, s3, v99
    v_pk_add_f32 v[48:49], v[48:49], v[80:81]
    v_pk_add_f32 v[50:51], v[50:51], v[82:83]
    v_pk_add_f32 v[52:53], v[52:53], v[84:85]
    v_pk_add_f32 v[54:55], v[54:55], v[86:87]
    v_cvt_pk_bf16_f32 v192, v48, v49
    v_cvt_pk_bf16_f32 v194, v52, v53
    v_cvt_pk_bf16_f32 v193, v50, v51
    v_cvt_pk_bf16_f32 v195, v54, v55
    v_permlane16_swap_b32 v192, v194
    s_mov_b32 s48, 2097152
    v_permlane16_swap_b32 v193, v195
    buffer_store_dwordx4 v[192:195], v16, s[4:7], s48 offen nt
    v_lshlrev_b32 v104, 16, v244
    v_and_b32 v105, s3, v244
    v_lshlrev_b32 v106, 16, v245
    v_and_b32 v107, s3, v245
    v_lshlrev_b32 v108, 16, v246
    v_and_b32 v109, s3, v246
    v_lshlrev_b32 v110, 16, v247
    v_and_b32 v111, s3, v247
    v_pk_add_f32 v[56:57], v[56:57], v[104:105]
    v_pk_add_f32 v[58:59], v[58:59], v[106:107]
    v_pk_add_f32 v[60:61], v[60:61], v[108:109]
    v_pk_add_f32 v[62:63], v[62:63], v[110:111]
    v_cvt_pk_bf16_f32 v104, v56, v57
    v_cvt_pk_bf16_f32 v105, v58, v59
    v_cvt_pk_bf16_f32 v106, v60, v61
    v_cvt_pk_bf16_f32 v107, v62, v63
    v_lshlrev_b32 v56, 16, v104
    v_and_b32 v57, s3, v104
    v_lshlrev_b32 v58, 16, v105
    v_and_b32 v59, s3, v105
    v_lshlrev_b32 v60, 16, v106
    v_and_b32 v61, s3, v106
    v_lshlrev_b32 v62, 16, v107
    v_and_b32 v63, s3, v107
    v_pk_add_f32 v[56:57], v[56:57], v[88:89]
    v_pk_add_f32 v[58:59], v[58:59], v[90:91]
    v_pk_add_f32 v[60:61], v[60:61], v[92:93]
    v_pk_add_f32 v[62:63], v[62:63], v[94:95]
    v_cvt_pk_bf16_f32 v196, v56, v57
    v_cvt_pk_bf16_f32 v198, v60, v61
    v_cvt_pk_bf16_f32 v197, v58, v59
    v_cvt_pk_bf16_f32 v199, v62, v63
    v_permlane16_swap_b32 v196, v198
    s_mov_b32 s48, 2129920
    v_permlane16_swap_b32 v197, v199
    buffer_store_dwordx4 v[196:199], v16, s[4:7], s48 offen nt
L_mk_end_1:
    s_endpgm
.section .rodata,"a"
.p2align 6
.amdhsa_kernel sequential_preLN__ssm_conv_s4d__geglu_ffn__prompt_kernel
  .amdhsa_next_free_vgpr 512
  .amdhsa_next_free_sgpr 102
  .amdhsa_accum_offset 256
  .amdhsa_group_segment_fixed_size 0
  .amdhsa_kernarg_size 112
  .amdhsa_user_sgpr_count 2
  .amdhsa_user_sgpr_kernarg_segment_ptr 1
  .amdhsa_system_sgpr_workgroup_id_x 1
  .amdhsa_float_denorm_mode_32 3
  .amdhsa_float_denorm_mode_16_64 3
.end_amdhsa_kernel
```
